```python
import torch

def _softmax(x, axis=-1):
    return torch.softmax(x, dim=axis)
def _gelu(x):
    return torch.nn.functional.gelu(x, approximate="tanh")
def _silu(x):
    return torch.nn.functional.silu(x)
def _sigmoid(x):
    return torch.sigmoid(x)
def _layernorm(x, axis=-1, eps=1e-5):
    m = x.mean(dim=axis, keepdim=True)
    v = x.var(dim=axis, keepdim=True, unbiased=False)
    return (x - m) / torch.sqrt(v + eps)
def _scatter_add(tgt, idx, src, axis=0):
    return tgt.clone().index_add_(axis, idx, src)
def _segment_sum(src, seg, n):
    out = torch.zeros((n,) + src.shape[1:], dtype=src.dtype)
    return out.index_add_(0, seg, src)
def _pad(x, pw):
    flat = tuple(v for pair in reversed(pw) for v in pair)
    return torch.nn.functional.pad(x, flat)

kernel_name = 'sequential_preLN__mha_block__dense_activation_gelu__prompt'

def setup_inputs():

    _w = (lambda a: (lambda t: t.to(torch.bfloat16) if t.is_floating_point() else t)(torch.as_tensor(a)))
    def _A_setup():
        B, S, D, H = 1, 2048, 512, 32
        return {
            "x": _w((lambda *s: torch.randn(*s, dtype=torch.bfloat16) * 0.05)(B, S, D)),
            "wqkv": _w((lambda *s: torch.randn(*s, dtype=torch.bfloat16) * 0.05)(D, 3 * D)),
            "wo": _w((lambda *s: torch.randn(*s, dtype=torch.bfloat16) * 0.05)(D, D)),
        }
    _A_in = _A_setup()

    def _B_setup():
        B, S, D, F = 1, 2048, 512, 1792
        return {
            "x": _w((lambda *s: torch.randn(*s, dtype=torch.bfloat16) * 0.05)(B, S, D)),
            "w1": _w((lambda *s: torch.randn(*s, dtype=torch.bfloat16) * 0.8)(D, F) * (D ** -0.5)),
            "b1": _w((lambda *s: torch.randn(*s, dtype=torch.bfloat16) * 0.2)(F) * 0.01),
            "w2": _w((lambda *s: torch.randn(*s, dtype=torch.bfloat16) * 0.2)(F, D) * (F ** -0.5)),
            "b2": _w((lambda *s: torch.randn(*s, dtype=torch.bfloat16) * 0.2)(D) * 0.01),
        }
    _B_in = _B_setup()

    return {
        "A_x": _A_in["x"],
        "A_wqkv": _A_in["wqkv"],
        "A_wo": _A_in["wo"],
        "B_x": _B_in["x"],
        "B_w1": _B_in["w1"],
        "B_b1": _B_in["b1"],
        "B_w2": _B_in["w2"],
        "B_b2": _B_in["b2"],
    }

def reference(A_x, A_wqkv, A_wo, B_x, B_w1, B_b1, B_w2, B_b2):
    def _A_ref(x, wqkv, wo):
        B, S, D = x.shape
        H = 32
        Dh = D // H
        qkv = (lambda x, *d: x.permute(*d))((x @ wqkv).reshape(B, S, 3, H, Dh), 2, 0, 3, 1, 4)
        q, k, v = qkv[0], qkv[1], qkv[2]
        scores = torch.einsum("bhqd,bhkd->bhqk", q, k) * (Dh ** -0.5)
        p = _softmax(scores, axis=-1)
        o = torch.einsum("bhqk,bhkd->bhqd", p, v)
        return (lambda x, *d: x.permute(*d))(o, 0, 2, 1, 3).reshape(B, S, D) @ wo

    def _B_ref(x, w1, b1, w2, b2):
        h = torch.einsum("bsd,df->bsf", x, w1) + b1
        h = _gelu(h)
        return torch.einsum("bsf,fd->bsd", h, w2) + b2

    x = A_x
    h = x + _A_ref(_layernorm(x, axis=-1), A_wqkv, A_wo)
    h2 = h + _B_ref(_layernorm(h, axis=-1), B_w1, B_b1, B_w2, B_b2)
    return h2
```

```asm
; @launch grid=(256,1,1) block=(512,1,1) lds=163840
.amdgcn_target "amdgcn-amd-amdhsa--gfx950"
.text
.globl sequential_preLN__mha_block__dense_activation_gelu__prompt_kernel
.p2align 8
.type sequential_preLN__mha_block__dense_activation_gelu__prompt_kernel,@function
sequential_preLN__mha_block__dense_activation_gelu__prompt_kernel:
    s_cmp_ge_u32 s2, 256
    s_cbranch_scc1 L_t_end
    s_load_dwordx16 s[4:19], s[0:1], 0
    s_load_dwordx4 s[20:23], s[0:1], 64
    s_load_dwordx2 s[24:25], s[0:1], 80
    v_and_b32 v1, 63, v0
    v_lshrrev_b32 v10, 6, v0
    v_and_b32 v2, 31, v0
    v_bfe_u32 v3, v0, 5, 1
    v_readfirstlane_b32 s56, v10
    v_lshlrev_b32 v4, 4, v1
    s_and_b32 s47, s2, 7
    s_lshl_b32 s47, s47, 1
    s_bfe_u32 s55, s2, 0x10003
    s_add_u32 s47, s47, s55
    s_lshr_b32 s48, s2, 4
    s_lshl_b32 s49, s47, 1
    s_and_b32 s55, s48, 1
    s_add_u32 s49, s49, s55
    s_lshr_b32 s50, s48, 1
    s_mov_b32 s27, s56
    s_and_b32 s44, s56, 3
    s_and_b32 s45, s44, 1
    s_lshr_b32 s46, s44, 1
    s_lshl_b32 s58, s49, 1
    s_add_u32 s58, s58, s45
    s_lshl_b32 s58, s58, 5
    s_lshl_b32 s55, s50, 2
    s_add_u32 s58, s58, s55
    s_lshl_b32 s55, s46, 1
    s_add_u32 s58, s58, s55
    s_lshl_b32 s58, s58, 10
    s_add_u32 s58, s58, 10485760
    s_lshl_b32 s59, s47, 2
    s_lshl_b32 s56, s45, 1
    s_add_u32 s59, s59, s56
    s_mul_i32 s59, s59, 112
    s_lshl_b32 s56, s48, 3
    s_add_u32 s59, s59, s56
    s_lshl_b32 s56, s46, 2
    s_add_u32 s59, s59, s56
    s_lshl_b32 s59, s59, 10
    s_add_u32 s59, s59, 12582912
    s_and_b32 s76, s2, 7
    s_lshr_b32 s77, s2, 3
    s_getreg_b32 s78, hwreg(HW_REG_XCC_ID)
    s_and_b32 s78, s78, 15
    s_cmp_ge_u32 s27, 4
    s_cbranch_scc1 L_p1_helper
    s_lshl_b32 s55, s45, 5
    v_add_u32 v22, s55, v2
    v_bfe_u32 v23, v22, 1, 3
    v_add_u32 v20, 0, v3
    v_xor_b32 v20, v20, v23
    v_lshlrev_b32 v20, 4, v20
    v_lshl_add_u32 v8, v22, 7, v20
    v_add_u32 v20, 2, v3
    v_xor_b32 v20, v20, v23
    v_lshlrev_b32 v20, 4, v20
    v_lshl_add_u32 v9, v22, 7, v20
    v_add_u32 v20, 4, v3
    v_xor_b32 v20, v20, v23
    v_lshlrev_b32 v20, 4, v20
    v_lshl_add_u32 v10, v22, 7, v20
    v_add_u32 v20, 6, v3
    v_xor_b32 v20, v20, v23
    v_lshlrev_b32 v20, 4, v20
    v_lshl_add_u32 v11, v22, 7, v20
    v_and_b32 v22, 15, v1
    v_lshrrev_b32 v23, 2, v22
    v_lshl_add_u32 v23, v3, 3, v23
    v_lshlrev_b32 v23, 7, v23
    v_lshrrev_b32 v20, 3, v22
    v_xor_b32 v20, s46, v20
    v_lshl_add_u32 v23, v20, 6, v23
    v_bfe_u32 v20, v1, 4, 1
    v_lshl_add_u32 v23, v20, 5, v23
    v_and_b32 v20, 3, v22
    v_lshl_add_u32 v23, v20, 3, v23
    v_add_u32 v12, 32768, v23
    v_add_u32 v13, 81920, v23
    v_mov_b32 v14, 0x3f803f80
    v_bfe_u32 v23, v1, 4, 1
    v_cmp_eq_u32 vcc, v22, v23
    v_mov_b32 v22, 0
    s_nop 1
    v_cndmask_b32 v148, v22, v14, vcc
    v_cndmask_b32 v149, v22, v14, vcc
    v_cndmask_b32 v150, v22, v14, vcc
    v_cndmask_b32 v151, v22, v14, vcc
    v_mov_b32 v128, 0
    v_mov_b32 v129, 0
    v_mov_b32 v130, 0
    v_mov_b32 v131, 0
    v_mov_b32 v132, 0
    v_mov_b32 v133, 0
    v_mov_b32 v134, 0
    v_mov_b32 v135, 0
    v_mov_b32 v136, 0
    v_mov_b32 v137, 0
    v_mov_b32 v138, 0
    v_mov_b32 v139, 0
    v_mov_b32 v64, 0
    v_mov_b32 v65, 0
    v_mov_b32 v66, 0
    v_mov_b32 v67, 0
    v_mov_b32 v68, 0
    v_mov_b32 v69, 0
    v_mov_b32 v70, 0
    v_mov_b32 v71, 0
    v_mov_b32 v72, 0
    v_mov_b32 v73, 0
    v_mov_b32 v74, 0
    v_mov_b32 v75, 0
    v_mov_b32 v76, 0
    v_mov_b32 v77, 0
    v_mov_b32 v78, 0
    v_mov_b32 v79, 0
    v_mov_b32 v80, 0
    v_mov_b32 v81, 0
    v_mov_b32 v82, 0
    v_mov_b32 v83, 0
    v_mov_b32 v84, 0
    v_mov_b32 v85, 0
    v_mov_b32 v86, 0
    v_mov_b32 v87, 0
    v_mov_b32 v88, 0
    v_mov_b32 v89, 0
    v_mov_b32 v90, 0
    v_mov_b32 v91, 0
    v_mov_b32 v92, 0
    v_mov_b32 v93, 0
    v_mov_b32 v94, 0
    v_mov_b32 v95, 0
    v_mov_b32 v96, 0
    v_mov_b32 v97, 0
    v_mov_b32 v98, 0
    v_mov_b32 v99, 0
    v_mov_b32 v100, 0
    v_mov_b32 v101, 0
    v_mov_b32 v102, 0
    v_mov_b32 v103, 0
    v_mov_b32 v104, 0
    v_mov_b32 v105, 0
    v_mov_b32 v106, 0
    v_mov_b32 v107, 0
    v_mov_b32 v108, 0
    v_mov_b32 v109, 0
    v_mov_b32 v110, 0
    v_mov_b32 v111, 0
    s_lshl_b32 s55, s44, 10
    s_add_u32 s55, s55, 81920
    v_lshlrev_b32 v20, 2, v2
    s_lshl_b32 s56, s45, 7
    s_add_u32 s56, s56, 90112
    v_add_u32 v24, s56, v20
    v_add_u32 v20, s55, v20
    v_lshlrev_b32 v21, 4, v3
    v_add_u32 v25, s56, v21
    v_add_u32 v21, s55, v21
    v_and_b32 v22, 15, v1
    v_lshrrev_b32 v23, 4, v1
    v_lshlrev_b32 v23, 4, v23
    v_lshl_add_u32 v23, v22, 6, v23
    v_add_u32 v23, s55, v23
    v_cmp_gt_u32 s[84:85], 2, v22
    s_lshl_b32 s75, s76, 2
    s_lshl_b32 s54, s46, 1
    s_add_u32 s75, s75, s54
    s_lshl_b32 s75, s75, 6
    s_lshl_b32 s54, s77, 1
    s_add_u32 s75, s75, s54
    s_add_u32 s75, s75, s45
    s_lshl_b32 s53, s75, 10
    v_lshrrev_b32 v22, 4, v2
    v_lshlrev_b32 v22, 16, v22
    v_lshl_add_u32 v22, v3, 8, v22
    v_and_b32 v27, 15, v2
    v_lshl_add_u32 v27, v27, 4, v22
    v_mov_b32 v22, 163776
    ds_write_b128 v22, v[64:67]
    s_waitcnt lgkmcnt(0)
    s_mov_b32 s28, s24
    s_and_b32 s29, s25, 0xffff
    s_mov_b32 s30, 41943040
    s_mov_b32 s31, 0x20000
    s_lshl_b32 s55, s76, 13
    s_add_u32 s55, s55, 6357504
    s_lshr_b32 s56, s2, 5
    s_lshl_b32 s56, s56, 13
    s_add_u32 s56, s56, 6357504
    s_load_dword s10, s[24:25], s55
    s_load_dword s11, s[24:25], s56
    s_lshr_b32 s55, s2, 3
    s_cmp_ge_u32 s55, 11
    s_cbranch_scc1 L_p1_npf
    s_lshl_b32 s55, s55, 2
    s_add_u32 s55, s55, s44
    s_lshl_b32 s55, s55, 10
    s_getpc_b64 s[82:83]
L_p1_pc:
    s_sub_u32 s82, s82, L_p1_pc-sequential_preLN__mha_block__dense_activation_gelu__prompt_kernel
    s_subb_u32 s83, s83, 0
    s_add_u32 s82, s82, s55
    s_addc_u32 s83, s83, 0
    global_load_dwordx4 v[152:155], v4, s[82:83]
L_p1_npf:
    s_waitcnt lgkmcnt(0)
    s_add_u32 s10, s10, 1
    s_add_u32 s11, s11, 1
    s_cmp_lg_u32 s44, 0
    s_cbranch_scc1 L_p1_nz
    s_lshl_b32 s55, s76, 13
    s_lshl_b32 s56, s77, 2
    s_add_u32 s55, s55, s56
    s_add_u32 s55, s55, 6360576
    s_lshl_b32 s56, s10, 4
    s_add_u32 s56, s56, s78
    v_mov_b32 v156, s56
    v_mov_b32 v157, 0
    s_mov_b64 exec, 1
    buffer_store_dword v156, v157, s[28:31], s55 offen sc1
    s_mov_b64 exec, -1
L_p1_nz:
    s_barrier
    ds_read_b128 v[28:31], v8 offset:0
    ds_read_b64_tr_b16 v[36:37], v12 offset:0
    ds_read_b64_tr_b16 v[38:39], v12 offset:512
    ds_read_b64_tr_b16 v[40:41], v12 offset:8192
    ds_read_b64_tr_b16 v[42:43], v12 offset:8704
    ds_read_b64_tr_b16 v[44:45], v12 offset:16384
    ds_read_b64_tr_b16 v[46:47], v12 offset:16896
    s_waitcnt lgkmcnt(0)
    v_mfma_f32_32x32x16_bf16 v[64:79], v[36:39], v[28:31], v[64:79]
    ds_read_b128 v[32:35], v9 offset:0
    ds_read_b64_tr_b16 v[48:49], v12 offset:2048
    ds_read_b64_tr_b16 v[50:51], v12 offset:2560
    v_mfma_f32_32x32x16_bf16 v[80:95], v[40:43], v[28:31], v[80:95]
    ds_read_b64_tr_b16 v[52:53], v12 offset:10240
    ds_read_b64_tr_b16 v[54:55], v12 offset:10752
    ds_read_b64_tr_b16 v[56:57], v12 offset:18432
    v_mfma_f32_32x32x16_bf16 v[96:111], v[28:31], v[44:47], v[96:111]
    ds_read_b64_tr_b16 v[58:59], v12 offset:18944
    v_mfma_f32_16x16x32_bf16 v[128:131], v[36:39], v[148:151], v[128:131]
    v_mfma_f32_16x16x32_bf16 v[132:135], v[40:43], v[148:151], v[132:135]
    v_mfma_f32_16x16x32_bf16 v[136:139], v[44:47], v[148:151], v[136:139]
    s_waitcnt lgkmcnt(0)
    v_mfma_f32_32x32x16_bf16 v[64:79], v[48:51], v[32:35], v[64:79]
    ds_read_b128 v[28:31], v10 offset:0
    ds_read_b64_tr_b16 v[36:37], v12 offset:4096
    ds_read_b64_tr_b16 v[38:39], v12 offset:4608
    v_mfma_f32_32x32x16_bf16 v[80:95], v[52:55], v[32:35], v[80:95]
    ds_read_b64_tr_b16 v[40:41], v12 offset:12288
    ds_read_b64_tr_b16 v[42:43], v12 offset:12800
    ds_read_b64_tr_b16 v[44:45], v12 offset:20480
    v_mfma_f32_32x32x16_bf16 v[96:111], v[32:35], v[56:59], v[96:111]
    ds_read_b64_tr_b16 v[46:47], v12 offset:20992
    v_mfma_f32_16x16x32_bf16 v[128:131], v[48:51], v[148:151], v[128:131]
    v_mfma_f32_16x16x32_bf16 v[132:135], v[52:55], v[148:151], v[132:135]
    v_mfma_f32_16x16x32_bf16 v[136:139], v[56:59], v[148:151], v[136:139]
    s_waitcnt lgkmcnt(0)
    v_mfma_f32_32x32x16_bf16 v[64:79], v[36:39], v[28:31], v[64:79]
    ds_read_b128 v[32:35], v11 offset:0
    ds_read_b64_tr_b16 v[48:49], v12 offset:6144
    ds_read_b64_tr_b16 v[50:51], v12 offset:6656
    v_mfma_f32_32x32x16_bf16 v[80:95], v[40:43], v[28:31], v[80:95]
    ds_read_b64_tr_b16 v[52:53], v12 offset:14336
    ds_read_b64_tr_b16 v[54:55], v12 offset:14848
    ds_read_b64_tr_b16 v[56:57], v12 offset:22528
    v_mfma_f32_32x32x16_bf16 v[96:111], v[28:31], v[44:47], v[96:111]
    ds_read_b64_tr_b16 v[58:59], v12 offset:23040
    v_mfma_f32_16x16x32_bf16 v[128:131], v[36:39], v[148:151], v[128:131]
    v_mfma_f32_16x16x32_bf16 v[132:135], v[40:43], v[148:151], v[132:135]
    v_mfma_f32_16x16x32_bf16 v[136:139], v[44:47], v[148:151], v[136:139]
    s_waitcnt lgkmcnt(0)
    s_barrier
    v_mfma_f32_32x32x16_bf16 v[64:79], v[48:51], v[32:35], v[64:79]
    ds_read_b128 v[28:31], v8 offset:8192
    ds_read_b64_tr_b16 v[36:37], v12 offset:24576
    ds_read_b64_tr_b16 v[38:39], v12 offset:25088
    v_mfma_f32_32x32x16_bf16 v[80:95], v[52:55], v[32:35], v[80:95]
    ds_read_b64_tr_b16 v[40:41], v12 offset:32768
    ds_read_b64_tr_b16 v[42:43], v12 offset:33280
    ds_read_b64_tr_b16 v[44:45], v12 offset:40960
    v_mfma_f32_32x32x16_bf16 v[96:111], v[32:35], v[56:59], v[96:111]
    ds_read_b64_tr_b16 v[46:47], v12 offset:41472
    v_mfma_f32_16x16x32_bf16 v[128:131], v[48:51], v[148:151], v[128:131]
    v_mfma_f32_16x16x32_bf16 v[132:135], v[52:55], v[148:151], v[132:135]
    v_mfma_f32_16x16x32_bf16 v[136:139], v[56:59], v[148:151], v[136:139]
    s_waitcnt lgkmcnt(0)
    v_mfma_f32_32x32x16_bf16 v[64:79], v[36:39], v[28:31], v[64:79]
    ds_read_b128 v[32:35], v9 offset:8192
    ds_read_b64_tr_b16 v[48:49], v12 offset:26624
    ds_read_b64_tr_b16 v[50:51], v12 offset:27136
    v_mfma_f32_32x32x16_bf16 v[80:95], v[40:43], v[28:31], v[80:95]
    ds_read_b64_tr_b16 v[52:53], v12 offset:34816
    ds_read_b64_tr_b16 v[54:55], v12 offset:35328
    ds_read_b64_tr_b16 v[56:57], v12 offset:43008
    v_mfma_f32_32x32x16_bf16 v[96:111], v[28:31], v[44:47], v[96:111]
    ds_read_b64_tr_b16 v[58:59], v12 offset:43520
    v_mfma_f32_16x16x32_bf16 v[128:131], v[36:39], v[148:151], v[128:131]
    v_mfma_f32_16x16x32_bf16 v[132:135], v[40:43], v[148:151], v[132:135]
    v_mfma_f32_16x16x32_bf16 v[136:139], v[44:47], v[148:151], v[136:139]
    s_waitcnt lgkmcnt(0)
    v_mfma_f32_32x32x16_bf16 v[64:79], v[48:51], v[32:35], v[64:79]
    ds_read_b128 v[28:31], v10 offset:8192
    ds_read_b64_tr_b16 v[36:37], v12 offset:28672
    ds_read_b64_tr_b16 v[38:39], v12 offset:29184
    v_mfma_f32_32x32x16_bf16 v[80:95], v[52:55], v[32:35], v[80:95]
    ds_read_b64_tr_b16 v[40:41], v12 offset:36864
    ds_read_b64_tr_b16 v[42:43], v12 offset:37376
    ds_read_b64_tr_b16 v[44:45], v12 offset:45056
    v_mfma_f32_32x32x16_bf16 v[96:111], v[32:35], v[56:59], v[96:111]
    ds_read_b64_tr_b16 v[46:47], v12 offset:45568
    v_mfma_f32_16x16x32_bf16 v[128:131], v[48:51], v[148:151], v[128:131]
    v_mfma_f32_16x16x32_bf16 v[132:135], v[52:55], v[148:151], v[132:135]
    v_mfma_f32_16x16x32_bf16 v[136:139], v[56:59], v[148:151], v[136:139]
    s_waitcnt lgkmcnt(0)
    v_mfma_f32_32x32x16_bf16 v[64:79], v[36:39], v[28:31], v[64:79]
    ds_read_b128 v[32:35], v11 offset:8192
    ds_read_b64_tr_b16 v[48:49], v12 offset:30720
    ds_read_b64_tr_b16 v[50:51], v12 offset:31232
    v_mfma_f32_32x32x16_bf16 v[80:95], v[40:43], v[28:31], v[80:95]
    ds_read_b64_tr_b16 v[52:53], v12 offset:38912
    ds_read_b64_tr_b16 v[54:55], v12 offset:39424
    ds_read_b64_tr_b16 v[56:57], v12 offset:47104
    v_mfma_f32_32x32x16_bf16 v[96:111], v[28:31], v[44:47], v[96:111]
    ds_read_b64_tr_b16 v[58:59], v12 offset:47616
    v_mfma_f32_16x16x32_bf16 v[128:131], v[36:39], v[148:151], v[128:131]
    v_mfma_f32_16x16x32_bf16 v[132:135], v[40:43], v[148:151], v[132:135]
    v_mfma_f32_16x16x32_bf16 v[136:139], v[44:47], v[148:151], v[136:139]
    s_waitcnt lgkmcnt(0)
    s_barrier
    v_mfma_f32_32x32x16_bf16 v[64:79], v[48:51], v[32:35], v[64:79]
    ds_read_b128 v[28:31], v8 offset:16384
    ds_read_b64_tr_b16 v[36:37], v13 offset:0
    ds_read_b64_tr_b16 v[38:39], v13 offset:512
    v_mfma_f32_32x32x16_bf16 v[80:95], v[52:55], v[32:35], v[80:95]
    ds_read_b64_tr_b16 v[40:41], v13 offset:8192
    ds_read_b64_tr_b16 v[42:43], v13 offset:8704
    ds_read_b64_tr_b16 v[44:45], v13 offset:16384
    v_mfma_f32_32x32x16_bf16 v[96:111], v[32:35], v[56:59], v[96:111]
    ds_read_b64_tr_b16 v[46:47], v13 offset:16896
    v_mfma_f32_16x16x32_bf16 v[128:131], v[48:51], v[148:151], v[128:131]
    v_mfma_f32_16x16x32_bf16 v[132:135], v[52:55], v[148:151], v[132:135]
    v_mfma_f32_16x16x32_bf16 v[136:139], v[56:59], v[148:151], v[136:139]
    s_waitcnt lgkmcnt(0)
    v_mfma_f32_32x32x16_bf16 v[64:79], v[36:39], v[28:31], v[64:79]
    ds_read_b128 v[32:35], v9 offset:16384
    ds_read_b64_tr_b16 v[48:49], v13 offset:2048
    ds_read_b64_tr_b16 v[50:51], v13 offset:2560
    v_mfma_f32_32x32x16_bf16 v[80:95], v[40:43], v[28:31], v[80:95]
    ds_read_b64_tr_b16 v[52:53], v13 offset:10240
    ds_read_b64_tr_b16 v[54:55], v13 offset:10752
    ds_read_b64_tr_b16 v[56:57], v13 offset:18432
    v_mfma_f32_32x32x16_bf16 v[96:111], v[28:31], v[44:47], v[96:111]
    ds_read_b64_tr_b16 v[58:59], v13 offset:18944
    v_mfma_f32_16x16x32_bf16 v[128:131], v[36:39], v[148:151], v[128:131]
    v_mfma_f32_16x16x32_bf16 v[132:135], v[40:43], v[148:151], v[132:135]
    v_mfma_f32_16x16x32_bf16 v[136:139], v[44:47], v[148:151], v[136:139]
    s_waitcnt lgkmcnt(0)
    v_mfma_f32_32x32x16_bf16 v[64:79], v[48:51], v[32:35], v[64:79]
    ds_read_b128 v[28:31], v10 offset:16384
    ds_read_b64_tr_b16 v[36:37], v13 offset:4096
    ds_read_b64_tr_b16 v[38:39], v13 offset:4608
    v_mfma_f32_32x32x16_bf16 v[80:95], v[52:55], v[32:35], v[80:95]
    ds_read_b64_tr_b16 v[40:41], v13 offset:12288
    ds_read_b64_tr_b16 v[42:43], v13 offset:12800
    ds_read_b64_tr_b16 v[44:45], v13 offset:20480
    v_mfma_f32_32x32x16_bf16 v[96:111], v[32:35], v[56:59], v[96:111]
    ds_read_b64_tr_b16 v[46:47], v13 offset:20992
    v_mfma_f32_16x16x32_bf16 v[128:131], v[48:51], v[148:151], v[128:131]
    v_mfma_f32_16x16x32_bf16 v[132:135], v[52:55], v[148:151], v[132:135]
    v_mfma_f32_16x16x32_bf16 v[136:139], v[56:59], v[148:151], v[136:139]
    s_waitcnt lgkmcnt(0)
    v_mfma_f32_32x32x16_bf16 v[64:79], v[36:39], v[28:31], v[64:79]
    ds_read_b128 v[32:35], v11 offset:16384
    ds_read_b64_tr_b16 v[48:49], v13 offset:6144
    ds_read_b64_tr_b16 v[50:51], v13 offset:6656
    v_mfma_f32_32x32x16_bf16 v[80:95], v[40:43], v[28:31], v[80:95]
    ds_read_b64_tr_b16 v[52:53], v13 offset:14336
    ds_read_b64_tr_b16 v[54:55], v13 offset:14848
    ds_read_b64_tr_b16 v[56:57], v13 offset:22528
    v_mfma_f32_32x32x16_bf16 v[96:111], v[28:31], v[44:47], v[96:111]
    ds_read_b64_tr_b16 v[58:59], v13 offset:23040
    v_mfma_f32_16x16x32_bf16 v[128:131], v[36:39], v[148:151], v[128:131]
    v_mfma_f32_16x16x32_bf16 v[132:135], v[40:43], v[148:151], v[132:135]
    v_mfma_f32_16x16x32_bf16 v[136:139], v[44:47], v[148:151], v[136:139]
    s_waitcnt lgkmcnt(0)
    s_barrier
    v_mfma_f32_32x32x16_bf16 v[64:79], v[48:51], v[32:35], v[64:79]
    ds_read_b128 v[28:31], v8 offset:24576
    ds_read_b64_tr_b16 v[36:37], v13 offset:24576
    ds_read_b64_tr_b16 v[38:39], v13 offset:25088
    v_mfma_f32_32x32x16_bf16 v[80:95], v[52:55], v[32:35], v[80:95]
    ds_read_b64_tr_b16 v[40:41], v13 offset:32768
    ds_read_b64_tr_b16 v[42:43], v13 offset:33280
    ds_read_b64_tr_b16 v[44:45], v13 offset:40960
    v_mfma_f32_32x32x16_bf16 v[96:111], v[32:35], v[56:59], v[96:111]
    ds_read_b64_tr_b16 v[46:47], v13 offset:41472
    v_mfma_f32_16x16x32_bf16 v[128:131], v[48:51], v[148:151], v[128:131]
    v_mfma_f32_16x16x32_bf16 v[132:135], v[52:55], v[148:151], v[132:135]
    v_mfma_f32_16x16x32_bf16 v[136:139], v[56:59], v[148:151], v[136:139]
    s_waitcnt lgkmcnt(0)
    v_mfma_f32_32x32x16_bf16 v[64:79], v[36:39], v[28:31], v[64:79]
    ds_read_b128 v[32:35], v9 offset:24576
    ds_read_b64_tr_b16 v[48:49], v13 offset:26624
    ds_read_b64_tr_b16 v[50:51], v13 offset:27136
    v_mfma_f32_32x32x16_bf16 v[80:95], v[40:43], v[28:31], v[80:95]
    ds_read_b64_tr_b16 v[52:53], v13 offset:34816
    ds_read_b64_tr_b16 v[54:55], v13 offset:35328
    ds_read_b64_tr_b16 v[56:57], v13 offset:43008
    v_mfma_f32_32x32x16_bf16 v[96:111], v[28:31], v[44:47], v[96:111]
    ds_read_b64_tr_b16 v[58:59], v13 offset:43520
    v_mfma_f32_16x16x32_bf16 v[128:131], v[36:39], v[148:151], v[128:131]
    v_mfma_f32_16x16x32_bf16 v[132:135], v[40:43], v[148:151], v[132:135]
    v_mfma_f32_16x16x32_bf16 v[136:139], v[44:47], v[148:151], v[136:139]
    s_waitcnt lgkmcnt(0)
    v_mfma_f32_32x32x16_bf16 v[64:79], v[48:51], v[32:35], v[64:79]
    ds_read_b128 v[28:31], v10 offset:24576
    ds_read_b64_tr_b16 v[36:37], v13 offset:28672
    ds_read_b64_tr_b16 v[38:39], v13 offset:29184
    v_mfma_f32_32x32x16_bf16 v[80:95], v[52:55], v[32:35], v[80:95]
    ds_read_b64_tr_b16 v[40:41], v13 offset:36864
    ds_read_b64_tr_b16 v[42:43], v13 offset:37376
    ds_read_b64_tr_b16 v[44:45], v13 offset:45056
    v_mfma_f32_32x32x16_bf16 v[96:111], v[32:35], v[56:59], v[96:111]
    ds_read_b64_tr_b16 v[46:47], v13 offset:45568
    v_mfma_f32_16x16x32_bf16 v[128:131], v[48:51], v[148:151], v[128:131]
    v_mfma_f32_16x16x32_bf16 v[132:135], v[52:55], v[148:151], v[132:135]
    v_mfma_f32_16x16x32_bf16 v[136:139], v[56:59], v[148:151], v[136:139]
    s_waitcnt lgkmcnt(0)
    v_mfma_f32_32x32x16_bf16 v[64:79], v[36:39], v[28:31], v[64:79]
    ds_read_b128 v[32:35], v11 offset:24576
    ds_read_b64_tr_b16 v[48:49], v13 offset:30720
    ds_read_b64_tr_b16 v[50:51], v13 offset:31232
    v_mfma_f32_32x32x16_bf16 v[80:95], v[40:43], v[28:31], v[80:95]
    ds_read_b64_tr_b16 v[52:53], v13 offset:38912
    ds_read_b64_tr_b16 v[54:55], v13 offset:39424
    ds_read_b64_tr_b16 v[56:57], v13 offset:47104
    v_mfma_f32_32x32x16_bf16 v[96:111], v[28:31], v[44:47], v[96:111]
    ds_read_b64_tr_b16 v[58:59], v13 offset:47616
    v_mfma_f32_16x16x32_bf16 v[128:131], v[36:39], v[148:151], v[128:131]
    v_mfma_f32_16x16x32_bf16 v[132:135], v[40:43], v[148:151], v[132:135]
    v_mfma_f32_16x16x32_bf16 v[136:139], v[44:47], v[148:151], v[136:139]
    s_waitcnt lgkmcnt(0)
    s_barrier
    v_mfma_f32_32x32x16_bf16 v[64:79], v[48:51], v[32:35], v[64:79]
    ds_read_b128 v[28:31], v8 offset:0
    ds_read_b64_tr_b16 v[36:37], v12 offset:0
    ds_read_b64_tr_b16 v[38:39], v12 offset:512
    v_mfma_f32_32x32x16_bf16 v[80:95], v[52:55], v[32:35], v[80:95]
    ds_read_b64_tr_b16 v[40:41], v12 offset:8192
    ds_read_b64_tr_b16 v[42:43], v12 offset:8704
    ds_read_b64_tr_b16 v[44:45], v12 offset:16384
    v_mfma_f32_32x32x16_bf16 v[96:111], v[32:35], v[56:59], v[96:111]
    ds_read_b64_tr_b16 v[46:47], v12 offset:16896
    v_mfma_f32_16x16x32_bf16 v[128:131], v[48:51], v[148:151], v[128:131]
    v_mfma_f32_16x16x32_bf16 v[132:135], v[52:55], v[148:151], v[132:135]
    v_mfma_f32_16x16x32_bf16 v[136:139], v[56:59], v[148:151], v[136:139]
    s_waitcnt lgkmcnt(0)
    v_mfma_f32_32x32x16_bf16 v[64:79], v[36:39], v[28:31], v[64:79]
    ds_read_b128 v[32:35], v9 offset:0
    ds_read_b64_tr_b16 v[48:49], v12 offset:2048
    ds_read_b64_tr_b16 v[50:51], v12 offset:2560
    v_mfma_f32_32x32x16_bf16 v[80:95], v[40:43], v[28:31], v[80:95]
    ds_read_b64_tr_b16 v[52:53], v12 offset:10240
    ds_read_b64_tr_b16 v[54:55], v12 offset:10752
    ds_read_b64_tr_b16 v[56:57], v12 offset:18432
    v_mfma_f32_32x32x16_bf16 v[96:111], v[28:31], v[44:47], v[96:111]
    ds_read_b64_tr_b16 v[58:59], v12 offset:18944
    v_mfma_f32_16x16x32_bf16 v[128:131], v[36:39], v[148:151], v[128:131]
    v_mfma_f32_16x16x32_bf16 v[132:135], v[40:43], v[148:151], v[132:135]
    v_mfma_f32_16x16x32_bf16 v[136:139], v[44:47], v[148:151], v[136:139]
    s_waitcnt lgkmcnt(0)
    v_mfma_f32_32x32x16_bf16 v[64:79], v[48:51], v[32:35], v[64:79]
    ds_read_b128 v[28:31], v10 offset:0
    ds_read_b64_tr_b16 v[36:37], v12 offset:4096
    ds_read_b64_tr_b16 v[38:39], v12 offset:4608
    v_mfma_f32_32x32x16_bf16 v[80:95], v[52:55], v[32:35], v[80:95]
    ds_read_b64_tr_b16 v[40:41], v12 offset:12288
    ds_read_b64_tr_b16 v[42:43], v12 offset:12800
    ds_read_b64_tr_b16 v[44:45], v12 offset:20480
    v_mfma_f32_32x32x16_bf16 v[96:111], v[32:35], v[56:59], v[96:111]
    ds_read_b64_tr_b16 v[46:47], v12 offset:20992
    v_mfma_f32_16x16x32_bf16 v[128:131], v[48:51], v[148:151], v[128:131]
    v_mfma_f32_16x16x32_bf16 v[132:135], v[52:55], v[148:151], v[132:135]
    v_mfma_f32_16x16x32_bf16 v[136:139], v[56:59], v[148:151], v[136:139]
    s_waitcnt lgkmcnt(0)
    v_mfma_f32_32x32x16_bf16 v[64:79], v[36:39], v[28:31], v[64:79]
    ds_read_b128 v[32:35], v11 offset:0
    ds_read_b64_tr_b16 v[48:49], v12 offset:6144
    ds_read_b64_tr_b16 v[50:51], v12 offset:6656
    v_mfma_f32_32x32x16_bf16 v[80:95], v[40:43], v[28:31], v[80:95]
    ds_read_b64_tr_b16 v[52:53], v12 offset:14336
    ds_read_b64_tr_b16 v[54:55], v12 offset:14848
    ds_read_b64_tr_b16 v[56:57], v12 offset:22528
    v_mfma_f32_32x32x16_bf16 v[96:111], v[28:31], v[44:47], v[96:111]
    ds_read_b64_tr_b16 v[58:59], v12 offset:23040
    v_mfma_f32_16x16x32_bf16 v[128:131], v[36:39], v[148:151], v[128:131]
    v_mfma_f32_16x16x32_bf16 v[132:135], v[40:43], v[148:151], v[132:135]
    v_mfma_f32_16x16x32_bf16 v[136:139], v[44:47], v[148:151], v[136:139]
    s_waitcnt lgkmcnt(0)
    s_barrier
    v_mfma_f32_32x32x16_bf16 v[64:79], v[48:51], v[32:35], v[64:79]
    ds_read_b128 v[28:31], v8 offset:8192
    ds_read_b64_tr_b16 v[36:37], v12 offset:24576
    ds_read_b64_tr_b16 v[38:39], v12 offset:25088
    v_mfma_f32_32x32x16_bf16 v[80:95], v[52:55], v[32:35], v[80:95]
    ds_read_b64_tr_b16 v[40:41], v12 offset:32768
    ds_read_b64_tr_b16 v[42:43], v12 offset:33280
    ds_read_b64_tr_b16 v[44:45], v12 offset:40960
    v_mfma_f32_32x32x16_bf16 v[96:111], v[32:35], v[56:59], v[96:111]
    ds_read_b64_tr_b16 v[46:47], v12 offset:41472
    v_mfma_f32_16x16x32_bf16 v[128:131], v[48:51], v[148:151], v[128:131]
    v_mfma_f32_16x16x32_bf16 v[132:135], v[52:55], v[148:151], v[132:135]
    v_mfma_f32_16x16x32_bf16 v[136:139], v[56:59], v[148:151], v[136:139]
    s_waitcnt lgkmcnt(0)
    v_mfma_f32_32x32x16_bf16 v[64:79], v[36:39], v[28:31], v[64:79]
    ds_read_b128 v[32:35], v9 offset:8192
    ds_read_b64_tr_b16 v[48:49], v12 offset:26624
    ds_read_b64_tr_b16 v[50:51], v12 offset:27136
    v_mfma_f32_32x32x16_bf16 v[80:95], v[40:43], v[28:31], v[80:95]
    ds_read_b64_tr_b16 v[52:53], v12 offset:34816
    ds_read_b64_tr_b16 v[54:55], v12 offset:35328
    ds_read_b64_tr_b16 v[56:57], v12 offset:43008
    v_mfma_f32_32x32x16_bf16 v[96:111], v[28:31], v[44:47], v[96:111]
    ds_read_b64_tr_b16 v[58:59], v12 offset:43520
    v_mfma_f32_16x16x32_bf16 v[128:131], v[36:39], v[148:151], v[128:131]
    v_mfma_f32_16x16x32_bf16 v[132:135], v[40:43], v[148:151], v[132:135]
    v_mfma_f32_16x16x32_bf16 v[136:139], v[44:47], v[148:151], v[136:139]
    s_waitcnt lgkmcnt(0)
    v_mfma_f32_32x32x16_bf16 v[64:79], v[48:51], v[32:35], v[64:79]
    ds_read_b128 v[28:31], v10 offset:8192
    ds_read_b64_tr_b16 v[36:37], v12 offset:28672
    ds_read_b64_tr_b16 v[38:39], v12 offset:29184
    v_mfma_f32_32x32x16_bf16 v[80:95], v[52:55], v[32:35], v[80:95]
    ds_read_b64_tr_b16 v[40:41], v12 offset:36864
    ds_read_b64_tr_b16 v[42:43], v12 offset:37376
    ds_read_b64_tr_b16 v[44:45], v12 offset:45056
    v_mfma_f32_32x32x16_bf16 v[96:111], v[32:35], v[56:59], v[96:111]
    ds_read_b64_tr_b16 v[46:47], v12 offset:45568
    v_mfma_f32_16x16x32_bf16 v[128:131], v[48:51], v[148:151], v[128:131]
    v_mfma_f32_16x16x32_bf16 v[132:135], v[52:55], v[148:151], v[132:135]
    v_mfma_f32_16x16x32_bf16 v[136:139], v[56:59], v[148:151], v[136:139]
    s_waitcnt lgkmcnt(0)
    v_mfma_f32_32x32x16_bf16 v[64:79], v[36:39], v[28:31], v[64:79]
    ds_read_b128 v[32:35], v11 offset:8192
    ds_read_b64_tr_b16 v[48:49], v12 offset:30720
    ds_read_b64_tr_b16 v[50:51], v12 offset:31232
    v_mfma_f32_32x32x16_bf16 v[80:95], v[40:43], v[28:31], v[80:95]
    ds_read_b64_tr_b16 v[52:53], v12 offset:38912
    ds_read_b64_tr_b16 v[54:55], v12 offset:39424
    ds_read_b64_tr_b16 v[56:57], v12 offset:47104
    v_mfma_f32_32x32x16_bf16 v[96:111], v[28:31], v[44:47], v[96:111]
    ds_read_b64_tr_b16 v[58:59], v12 offset:47616
    v_mfma_f32_16x16x32_bf16 v[128:131], v[36:39], v[148:151], v[128:131]
    v_mfma_f32_16x16x32_bf16 v[132:135], v[40:43], v[148:151], v[132:135]
    v_mfma_f32_16x16x32_bf16 v[136:139], v[44:47], v[148:151], v[136:139]
    s_waitcnt lgkmcnt(0)
    s_barrier
    v_mfma_f32_32x32x16_bf16 v[64:79], v[48:51], v[32:35], v[64:79]
    ds_read_b128 v[28:31], v8 offset:16384
    ds_read_b64_tr_b16 v[36:37], v13 offset:0
    ds_read_b64_tr_b16 v[38:39], v13 offset:512
    v_mfma_f32_32x32x16_bf16 v[80:95], v[52:55], v[32:35], v[80:95]
    ds_read_b64_tr_b16 v[40:41], v13 offset:8192
    ds_read_b64_tr_b16 v[42:43], v13 offset:8704
    ds_read_b64_tr_b16 v[44:45], v13 offset:16384
    v_mfma_f32_32x32x16_bf16 v[96:111], v[32:35], v[56:59], v[96:111]
    ds_read_b64_tr_b16 v[46:47], v13 offset:16896
    v_mfma_f32_16x16x32_bf16 v[128:131], v[48:51], v[148:151], v[128:131]
    v_mfma_f32_16x16x32_bf16 v[132:135], v[52:55], v[148:151], v[132:135]
    v_mfma_f32_16x16x32_bf16 v[136:139], v[56:59], v[148:151], v[136:139]
    s_waitcnt lgkmcnt(0)
    v_mfma_f32_32x32x16_bf16 v[64:79], v[36:39], v[28:31], v[64:79]
    ds_read_b128 v[32:35], v9 offset:16384
    ds_read_b64_tr_b16 v[48:49], v13 offset:2048
    ds_read_b64_tr_b16 v[50:51], v13 offset:2560
    v_mfma_f32_32x32x16_bf16 v[80:95], v[40:43], v[28:31], v[80:95]
    ds_read_b64_tr_b16 v[52:53], v13 offset:10240
    ds_read_b64_tr_b16 v[54:55], v13 offset:10752
    ds_read_b64_tr_b16 v[56:57], v13 offset:18432
    v_mfma_f32_32x32x16_bf16 v[96:111], v[28:31], v[44:47], v[96:111]
    ds_read_b64_tr_b16 v[58:59], v13 offset:18944
    s_add_u32 s54, s53, 2097152
    buffer_load_dwordx4 v[152:155], v4, s[28:31], s54 offen
    v_mfma_f32_16x16x32_bf16 v[128:131], v[36:39], v[148:151], v[128:131]
    v_mfma_f32_16x16x32_bf16 v[132:135], v[40:43], v[148:151], v[132:135]
    v_mfma_f32_16x16x32_bf16 v[136:139], v[44:47], v[148:151], v[136:139]
    s_waitcnt lgkmcnt(0)
    v_mfma_f32_32x32x16_bf16 v[64:79], v[48:51], v[32:35], v[64:79]
    ds_read_b128 v[28:31], v10 offset:16384
    ds_read_b64_tr_b16 v[36:37], v13 offset:4096
    ds_read_b64_tr_b16 v[38:39], v13 offset:4608
    v_mfma_f32_32x32x16_bf16 v[80:95], v[52:55], v[32:35], v[80:95]
    ds_read_b64_tr_b16 v[40:41], v13 offset:12288
    ds_read_b64_tr_b16 v[42:43], v13 offset:12800
    ds_read_b64_tr_b16 v[44:45], v13 offset:20480
    v_mfma_f32_32x32x16_bf16 v[96:111], v[32:35], v[56:59], v[96:111]
    ds_read_b64_tr_b16 v[46:47], v13 offset:20992
    s_add_u32 s54, s53, 2162688
    buffer_load_dwordx4 v[152:155], v4, s[28:31], s54 offen
    v_mfma_f32_16x16x32_bf16 v[128:131], v[48:51], v[148:151], v[128:131]
    v_mfma_f32_16x16x32_bf16 v[132:135], v[52:55], v[148:151], v[132:135]
    v_mfma_f32_16x16x32_bf16 v[136:139], v[56:59], v[148:151], v[136:139]
    s_waitcnt lgkmcnt(0)
    v_mfma_f32_32x32x16_bf16 v[64:79], v[36:39], v[28:31], v[64:79]
    ds_read_b128 v[32:35], v11 offset:16384
    ds_read_b64_tr_b16 v[48:49], v13 offset:6144
    ds_read_b64_tr_b16 v[50:51], v13 offset:6656
    v_mfma_f32_32x32x16_bf16 v[80:95], v[40:43], v[28:31], v[80:95]
    ds_read_b64_tr_b16 v[52:53], v13 offset:14336
    ds_read_b64_tr_b16 v[54:55], v13 offset:14848
    ds_read_b64_tr_b16 v[56:57], v13 offset:22528
    v_mfma_f32_32x32x16_bf16 v[96:111], v[28:31], v[44:47], v[96:111]
    ds_read_b64_tr_b16 v[58:59], v13 offset:23040
    s_add_u32 s54, s53, 4194304
    buffer_load_dwordx4 v[152:155], v4, s[28:31], s54 offen
    v_mfma_f32_16x16x32_bf16 v[128:131], v[36:39], v[148:151], v[128:131]
    v_mfma_f32_16x16x32_bf16 v[132:135], v[40:43], v[148:151], v[132:135]
    v_mfma_f32_16x16x32_bf16 v[136:139], v[44:47], v[148:151], v[136:139]
    s_waitcnt lgkmcnt(0)
    s_barrier
    v_mfma_f32_32x32x16_bf16 v[64:79], v[48:51], v[32:35], v[64:79]
    ds_read_b128 v[28:31], v8 offset:24576
    ds_read_b64_tr_b16 v[36:37], v13 offset:24576
    ds_read_b64_tr_b16 v[38:39], v13 offset:25088
    v_mfma_f32_32x32x16_bf16 v[80:95], v[52:55], v[32:35], v[80:95]
    ds_read_b64_tr_b16 v[40:41], v13 offset:32768
    ds_read_b64_tr_b16 v[42:43], v13 offset:33280
    ds_read_b64_tr_b16 v[44:45], v13 offset:40960
    v_mfma_f32_32x32x16_bf16 v[96:111], v[32:35], v[56:59], v[96:111]
    ds_read_b64_tr_b16 v[46:47], v13 offset:41472
    s_add_u32 s54, s53, 4259840
    buffer_load_dwordx4 v[152:155], v4, s[28:31], s54 offen
    v_mfma_f32_16x16x32_bf16 v[128:131], v[48:51], v[148:151], v[128:131]
    v_mfma_f32_16x16x32_bf16 v[132:135], v[52:55], v[148:151], v[132:135]
    v_mfma_f32_16x16x32_bf16 v[136:139], v[56:59], v[148:151], v[136:139]
    s_waitcnt lgkmcnt(0)
    v_mfma_f32_32x32x16_bf16 v[64:79], v[36:39], v[28:31], v[64:79]
    ds_read_b128 v[32:35], v9 offset:24576
    ds_read_b64_tr_b16 v[48:49], v13 offset:26624
    ds_read_b64_tr_b16 v[50:51], v13 offset:27136
    v_mfma_f32_32x32x16_bf16 v[80:95], v[40:43], v[28:31], v[80:95]
    ds_read_b64_tr_b16 v[52:53], v13 offset:34816
    ds_read_b64_tr_b16 v[54:55], v13 offset:35328
    ds_read_b64_tr_b16 v[56:57], v13 offset:43008
    v_mfma_f32_32x32x16_bf16 v[96:111], v[28:31], v[44:47], v[96:111]
    ds_read_b64_tr_b16 v[58:59], v13 offset:43520
    s_add_u32 s54, s53, 0
    buffer_load_dwordx4 v[152:155], v4, s[28:31], s54 offen
    v_mfma_f32_16x16x32_bf16 v[128:131], v[36:39], v[148:151], v[128:131]
    v_mfma_f32_16x16x32_bf16 v[132:135], v[40:43], v[148:151], v[132:135]
    v_mfma_f32_16x16x32_bf16 v[136:139], v[44:47], v[148:151], v[136:139]
    s_waitcnt lgkmcnt(0)
    v_mfma_f32_32x32x16_bf16 v[64:79], v[48:51], v[32:35], v[64:79]
    ds_read_b128 v[28:31], v10 offset:24576
    ds_read_b64_tr_b16 v[36:37], v13 offset:28672
    ds_read_b64_tr_b16 v[38:39], v13 offset:29184
    v_mfma_f32_32x32x16_bf16 v[80:95], v[52:55], v[32:35], v[80:95]
    ds_read_b64_tr_b16 v[40:41], v13 offset:36864
    ds_read_b64_tr_b16 v[42:43], v13 offset:37376
    ds_read_b64_tr_b16 v[44:45], v13 offset:45056
    v_mfma_f32_32x32x16_bf16 v[96:111], v[32:35], v[56:59], v[96:111]
    ds_read_b64_tr_b16 v[46:47], v13 offset:45568
    s_add_u32 s54, s53, 65536
    buffer_load_dwordx4 v[152:155], v4, s[28:31], s54 offen
    v_mfma_f32_16x16x32_bf16 v[128:131], v[48:51], v[148:151], v[128:131]
    v_mfma_f32_16x16x32_bf16 v[132:135], v[52:55], v[148:151], v[132:135]
    v_mfma_f32_16x16x32_bf16 v[136:139], v[56:59], v[148:151], v[136:139]
    s_waitcnt lgkmcnt(0)
    v_mfma_f32_32x32x16_bf16 v[64:79], v[36:39], v[28:31], v[64:79]
    ds_read_b128 v[32:35], v11 offset:24576
    ds_read_b64_tr_b16 v[48:49], v13 offset:30720
    ds_read_b64_tr_b16 v[50:51], v13 offset:31232
    v_mfma_f32_32x32x16_bf16 v[80:95], v[40:43], v[28:31], v[80:95]
    ds_read_b64_tr_b16 v[52:53], v13 offset:38912
    ds_read_b64_tr_b16 v[54:55], v13 offset:39424
    ds_read_b64_tr_b16 v[56:57], v13 offset:47104
    v_mfma_f32_32x32x16_bf16 v[96:111], v[28:31], v[44:47], v[96:111]
    ds_read_b64_tr_b16 v[58:59], v13 offset:47616
    s_lshl_b32 s54, s75, 2
    s_add_u32 s54, s54, 6291456
    v_mfma_f32_16x16x32_bf16 v[128:131], v[36:39], v[148:151], v[128:131]
    v_mfma_f32_16x16x32_bf16 v[132:135], v[40:43], v[148:151], v[132:135]
    v_mfma_f32_16x16x32_bf16 v[136:139], v[44:47], v[148:151], v[136:139]
    s_waitcnt lgkmcnt(0)
    s_barrier
    v_mfma_f32_32x32x16_bf16 v[64:79], v[48:51], v[32:35], v[64:79]
    v_mfma_f32_32x32x16_bf16 v[80:95], v[52:55], v[32:35], v[80:95]
    v_mfma_f32_32x32x16_bf16 v[96:111], v[32:35], v[56:59], v[96:111]
    v_lshlrev_b32 v156, 8, v3
    buffer_load_dword v152, v156, s[28:31], s54 offen
    v_mfma_f32_16x16x32_bf16 v[128:131], v[48:51], v[148:151], v[128:131]
    v_mfma_f32_16x16x32_bf16 v[132:135], v[52:55], v[148:151], v[132:135]
    v_mfma_f32_16x16x32_bf16 v[136:139], v[56:59], v[148:151], v[136:139]
    v_mov_b32 v22, 90624
    ds_read_b32 v158, v22
    ds_read_b32 v140, v24
    ds_read_b32 v142, v24 offset:256
    ds_read_b128 v[28:31], v25 offset:0
    ds_read_b128 v[32:35], v25 offset:32
    ds_read_b128 v[36:39], v25 offset:64
    ds_read_b128 v[40:43], v25 offset:96
    ds_read_b128 v[44:47], v25 offset:256
    ds_read_b128 v[48:51], v25 offset:288
    ds_read_b128 v[52:55], v25 offset:320
    ds_read_b128 v[56:59], v25 offset:352
    s_mov_b64 exec, s[84:85]
    ds_write_b128 v23, v[128:131]
    ds_write_b128 v23, v[132:135] offset:128
    ds_write_b128 v23, v[136:139] offset:256
    s_mov_b64 exec, -1
    ds_read_b32 v15, v20 offset:256
    s_waitcnt lgkmcnt(12)
    v_readfirstlane_b32 s3, v158
    v_mov_b32 v141, v140
    v_mov_b32 v143, v142
    v_mul_f32 v144, 0.36067376022224085, v140
    v_mul_f32 v145, 0.36067376022224085, v140
    v_mul_f32 v146, 0.36067376022224085, v142
    v_mul_f32 v147, 0.36067376022224085, v142
    ds_read_b128 v[112:115], v21 offset:0
    ds_read_b128 v[116:119], v21 offset:32
    ds_read_b128 v[120:123], v21 offset:64
    ds_read_b128 v[124:127], v21 offset:96
    s_waitcnt lgkmcnt(4)
    v_mov_b32 v14, v15
    v_pk_mul_f32 v[44:45], v[44:45], v[14:15]
    v_pk_fma_f32 v[96:97], v[96:97], v[28:29], v[44:45]
    v_pk_mul_f32 v[46:47], v[46:47], v[14:15]
    v_pk_fma_f32 v[98:99], v[98:99], v[30:31], v[46:47]
    v_pk_mul_f32 v[48:49], v[48:49], v[14:15]
    v_pk_fma_f32 v[100:101], v[100:101], v[32:33], v[48:49]
    v_pk_mul_f32 v[50:51], v[50:51], v[14:15]
    v_pk_fma_f32 v[102:103], v[102:103], v[34:35], v[50:51]
    v_pk_mul_f32 v[52:53], v[52:53], v[14:15]
    v_pk_fma_f32 v[104:105], v[104:105], v[36:37], v[52:53]
    v_pk_mul_f32 v[54:55], v[54:55], v[14:15]
    v_pk_fma_f32 v[106:107], v[106:107], v[38:39], v[54:55]
    v_pk_mul_f32 v[56:57], v[56:57], v[14:15]
    v_pk_fma_f32 v[108:109], v[108:109], v[40:41], v[56:57]
    v_pk_mul_f32 v[58:59], v[58:59], v[14:15]
    v_pk_fma_f32 v[110:111], v[110:111], v[42:43], v[58:59]
    v_cvt_pk_bf16_f32 v96, v96, v97
    v_cvt_pk_bf16_f32 v97, v98, v99
    v_cvt_pk_bf16_f32 v98, v100, v101
    v_cvt_pk_bf16_f32 v99, v102, v103
    v_cvt_pk_bf16_f32 v100, v104, v105
    v_cvt_pk_bf16_f32 v101, v106, v107
    v_cvt_pk_bf16_f32 v102, v108, v109
    v_cvt_pk_bf16_f32 v103, v110, v111
    ds_read_b128 v[28:31], v21 offset:128
    ds_read_b128 v[32:35], v21 offset:160
    ds_read_b128 v[36:39], v21 offset:192
    ds_read_b128 v[40:43], v21 offset:224
    s_add_u32 s54, s53, 4194304
    s_cmp_eq_u32 s3, 0
    s_cbranch_scc1 L_hs0_slow
    buffer_store_dwordx4 v[96:99], v27, s[28:31], s54 offen
    buffer_store_dwordx4 v[100:103], v27, s[28:31], s54 offen offset:512
    s_branch L_hs0_done
L_hs0_slow:
    buffer_store_dwordx4 v[96:99], v27, s[28:31], s54 offen sc1
    buffer_store_dwordx4 v[100:103], v27, s[28:31], s54 offen offset:512 sc1
L_hs0_done:
    s_waitcnt lgkmcnt(0)
    v_pk_mul_f32 v[28:29], v[28:29], v[142:143]
    v_pk_fma_f32 v[80:81], v[80:81], v[140:141], v[28:29]
    v_pk_mul_f32 v[30:31], v[30:31], v[142:143]
    v_pk_fma_f32 v[82:83], v[82:83], v[140:141], v[30:31]
    v_pk_mul_f32 v[32:33], v[32:33], v[142:143]
    v_pk_fma_f32 v[84:85], v[84:85], v[140:141], v[32:33]
    v_pk_mul_f32 v[34:35], v[34:35], v[142:143]
    v_pk_fma_f32 v[86:87], v[86:87], v[140:141], v[34:35]
    v_pk_mul_f32 v[36:37], v[36:37], v[142:143]
    v_pk_fma_f32 v[88:89], v[88:89], v[140:141], v[36:37]
    v_pk_mul_f32 v[38:39], v[38:39], v[142:143]
    v_pk_fma_f32 v[90:91], v[90:91], v[140:141], v[38:39]
    v_pk_mul_f32 v[40:41], v[40:41], v[142:143]
    v_pk_fma_f32 v[92:93], v[92:93], v[140:141], v[40:41]
    v_pk_mul_f32 v[42:43], v[42:43], v[142:143]
    v_pk_fma_f32 v[94:95], v[94:95], v[140:141], v[42:43]
    v_cvt_pk_bf16_f32 v80, v80, v81
    v_cvt_pk_bf16_f32 v81, v82, v83
    v_cvt_pk_bf16_f32 v82, v84, v85
    v_cvt_pk_bf16_f32 v83, v86, v87
    v_cvt_pk_bf16_f32 v84, v88, v89
    v_cvt_pk_bf16_f32 v85, v90, v91
    v_cvt_pk_bf16_f32 v86, v92, v93
    v_cvt_pk_bf16_f32 v87, v94, v95
    s_add_u32 s54, s53, 2097152
    s_add_u32 s57, s53, 2162688
    s_cmp_eq_u32 s3, 0
    s_cbranch_scc1 L_hs1_slow
    buffer_store_dwordx4 v[80:83], v4, s[28:31], s54 offen
    buffer_store_dwordx4 v[84:87], v4, s[28:31], s57 offen
    s_branch L_hs1_done
L_hs1_slow:
    buffer_store_dwordx4 v[80:83], v4, s[28:31], s54 offen sc1
    buffer_store_dwordx4 v[84:87], v4, s[28:31], s57 offen sc1
L_hs1_done:
    v_mov_b32 v16, 0
    v_mov_b32 v17, 0
    v_dot2_f32_bf16 v16, v80, v80, v16
    v_dot2_f32_bf16 v17, v84, v84, v17
    v_dot2_f32_bf16 v16, v81, v81, v16
    v_dot2_f32_bf16 v17, v85, v85, v17
    v_dot2_f32_bf16 v16, v82, v82, v16
    v_dot2_f32_bf16 v17, v86, v86, v17
    v_dot2_f32_bf16 v16, v83, v83, v16
    v_dot2_f32_bf16 v17, v87, v87, v17
    s_nop 3
    v_permlane32_swap_b32 v16, v17
    s_nop 1
    v_add_f32 v16, v16, v17
    s_nop 1
    v_max_f32_dpp v16, v16, v16 row_shr:1 row_mask:0xf bank_mask:0xf
    s_nop 1
    v_max_f32_dpp v16, v16, v16 row_shr:2 row_mask:0xf bank_mask:0xf
    s_nop 1
    v_max_f32_dpp v16, v16, v16 row_shr:4 row_mask:0xf bank_mask:0xf
    s_nop 1
    v_max_f32_dpp v16, v16, v16 row_shr:8 row_mask:0xf bank_mask:0xf
    s_nop 1
    v_max_f32_dpp v16, v16, v16 row_bcast:15 row_mask:0xa bank_mask:0xf
    v_lshlrev_b32 v17, 8, v3
    s_lshl_b32 s54, s75, 2
    s_add_u32 s54, s54, 6291456
    s_mov_b32 exec_lo, 0x80000000
    s_mov_b32 exec_hi, 0x80000000
    s_cmp_eq_u32 s3, 0
    s_cbranch_scc1 L_hs2_slow
    buffer_store_dword v16, v17, s[28:31], s54 offen
    s_branch L_hs2_done
L_hs2_slow:
    buffer_store_dword v16, v17, s[28:31], s54 offen sc1
L_hs2_done:
    s_mov_b64 exec, -1
    v_pk_mul_f32 v[112:113], v[112:113], v[146:147]
    v_pk_fma_f32 v[64:65], v[64:65], v[144:145], v[112:113]
    v_pk_mul_f32 v[114:115], v[114:115], v[146:147]
    v_pk_fma_f32 v[66:67], v[66:67], v[144:145], v[114:115]
    v_pk_mul_f32 v[116:117], v[116:117], v[146:147]
    v_pk_fma_f32 v[68:69], v[68:69], v[144:145], v[116:117]
    v_pk_mul_f32 v[118:119], v[118:119], v[146:147]
    v_pk_fma_f32 v[70:71], v[70:71], v[144:145], v[118:119]
    v_pk_mul_f32 v[120:121], v[120:121], v[146:147]
    v_pk_fma_f32 v[72:73], v[72:73], v[144:145], v[120:121]
    v_pk_mul_f32 v[122:123], v[122:123], v[146:147]
    v_pk_fma_f32 v[74:75], v[74:75], v[144:145], v[122:123]
    v_pk_mul_f32 v[124:125], v[124:125], v[146:147]
    v_pk_fma_f32 v[76:77], v[76:77], v[144:145], v[124:125]
    v_pk_mul_f32 v[126:127], v[126:127], v[146:147]
    v_pk_fma_f32 v[78:79], v[78:79], v[144:145], v[126:127]
    v_cvt_pk_bf16_f32 v64, v64, v65
    v_cvt_pk_bf16_f32 v65, v66, v67
    v_cvt_pk_bf16_f32 v66, v68, v69
    v_cvt_pk_bf16_f32 v67, v70, v71
    v_cvt_pk_bf16_f32 v68, v72, v73
    v_cvt_pk_bf16_f32 v69, v74, v75
    v_cvt_pk_bf16_f32 v70, v76, v77
    v_cvt_pk_bf16_f32 v71, v78, v79
    s_add_u32 s54, s53, 0
    s_add_u32 s57, s53, 65536
    s_cmp_eq_u32 s3, 0
    s_cbranch_scc1 L_hs3_slow
    buffer_store_dwordx4 v[64:67], v4, s[28:31], s54 offen
    buffer_store_dwordx4 v[68:71], v4, s[28:31], s57 offen
    s_branch L_hs3_done
L_hs3_slow:
    buffer_store_dwordx4 v[64:67], v4, s[28:31], s54 offen sc1
    buffer_store_dwordx4 v[68:71], v4, s[28:31], s57 offen sc1
L_hs3_done:
    s_waitcnt vmcnt(0)
    v_mov_b32 v228, 163788
    v_mov_b32 v229, 1
    s_mov_b64 exec, 1
    ds_add_rtn_u32 v229, v228, v229
    s_waitcnt lgkmcnt(0)
    v_readfirstlane_b32 s56, v229
    s_mov_b64 exec, -1
    s_cmp_lg_u32 s56, 3
    s_cbranch_scc1 L_h1a_np
    s_lshl_b32 s55, s76, 13
    s_add_u32 s55, s55, 6360064
    s_lshl_b32 s56, s77, 2
    s_add_u32 s55, s55, s56
    v_mov_b32 v228, 0
    v_mov_b32 v229, s10
    s_mov_b64 exec, 1
    s_cmp_eq_u32 s3, 0
    s_cbranch_scc1 L_hs4_slow
    buffer_store_dword v229, v228, s[28:31], s55 offen
    s_branch L_hs4_done
L_hs4_slow:
    buffer_store_dword v229, v228, s[28:31], s55 offen sc1
L_hs4_done:
    s_mov_b64 exec, -1
L_h1a_np:
    s_barrier
    s_branch L_p1_done
L_p1_helper:
    v_lshrrev_b32 v20, 3, v1
    v_and_b32 v21, 7, v1
    s_lshl_b32 s55, s77, 6
    s_lshl_b32 s56, s44, 4
    s_add_u32 s55, s55, s56
    s_add_u32 s52, s76, s77
    v_lshrrev_b32 v22, 1, v20
    v_add_u32 v22, 0, v22
    v_xor_b32 v22, v22, v21
    v_lshlrev_b32 v22, 4, v22
    v_add_u32 v23, 0, v20
    v_add_u32 v23, s55, v23
    v_lshl_add_u32 v5, v23, 10, v22
    v_lshrrev_b32 v22, 1, v20
    v_add_u32 v22, 4, v22
    v_xor_b32 v22, v22, v21
    v_lshlrev_b32 v22, 4, v22
    v_add_u32 v23, 8, v20
    v_add_u32 v23, s55, v23
    v_lshl_add_u32 v6, v23, 10, v22
    v_bfe_u32 v22, v20, 1, 1
    v_lshlrev_b32 v22, 2, v22
    v_xor_b32 v22, v22, v21
    v_lshlrev_b32 v22, 4, v22
    v_add_u32 v23, s56, v20
    v_mul_u32_u24 v23, 3072, v23
    v_add_u32 v22, v22, v23
    s_lshl_b32 s56, s76, 7
    v_add_u32 v7, s56, v22
    s_lshl_b32 s51, s44, 11
    s_waitcnt lgkmcnt(0)
    s_mov_b32 s36, s4
    s_and_b32 s37, s5, 0xffff
    s_mov_b32 s38, 2097152
    s_mov_b32 s39, 0x20000
    s_mov_b32 s32, s6
    s_and_b32 s33, s7, 0xffff
    s_mov_b32 s34, 1572864
    s_mov_b32 s35, 0x20000
    s_and_b32 s52, s52, 7
    s_lshl_b32 s53, s52, 7
    s_mul_i32 s57, s52, 196608
    s_add_u32 m0, s51, 0
    s_nop 0
    buffer_load_dwordx4 v5, s[36:39], s53 offen lds
    s_add_u32 m0, s51, 32768
    s_add_u32 s54, s57, 0
    buffer_load_dwordx4 v7, s[32:35], s54 offen lds
    s_add_u32 m0, s51, 40960
    s_add_u32 s54, s57, 1024
    buffer_load_dwordx4 v7, s[32:35], s54 offen lds
    s_add_u32 m0, s51, 49152
    s_add_u32 s54, s57, 2048
    buffer_load_dwordx4 v7, s[32:35], s54 offen lds
    s_add_u32 m0, s51, 1024
    s_nop 0
    buffer_load_dwordx4 v6, s[36:39], s53 offen lds
    s_add_u32 m0, s51, 33792
    s_add_u32 s54, s57, 24576
    buffer_load_dwordx4 v7, s[32:35], s54 offen lds
    s_add_u32 m0, s51, 41984
    s_add_u32 s54, s57, 25600
    buffer_load_dwordx4 v7, s[32:35], s54 offen lds
    s_add_u32 m0, s51, 50176
    s_add_u32 s54, s57, 26624
    buffer_load_dwordx4 v7, s[32:35], s54 offen lds
    s_add_u32 s52, s52, 1
    s_and_b32 s52, s52, 7
    s_lshl_b32 s53, s52, 7
    s_mul_i32 s57, s52, 196608
    s_add_u32 m0, s51, 8192
    s_nop 0
    buffer_load_dwordx4 v5, s[36:39], s53 offen lds
    s_add_u32 m0, s51, 57344
    s_add_u32 s54, s57, 0
    buffer_load_dwordx4 v7, s[32:35], s54 offen lds
    s_add_u32 m0, s51, 65536
    s_add_u32 s54, s57, 1024
    buffer_load_dwordx4 v7, s[32:35], s54 offen lds
    s_add_u32 m0, s51, 73728
    s_add_u32 s54, s57, 2048
    buffer_load_dwordx4 v7, s[32:35], s54 offen lds
    s_add_u32 m0, s51, 9216
    s_nop 0
    buffer_load_dwordx4 v6, s[36:39], s53 offen lds
    s_add_u32 m0, s51, 58368
    s_add_u32 s54, s57, 24576
    buffer_load_dwordx4 v7, s[32:35], s54 offen lds
    s_add_u32 m0, s51, 66560
    s_add_u32 s54, s57, 25600
    buffer_load_dwordx4 v7, s[32:35], s54 offen lds
    s_add_u32 m0, s51, 74752
    s_add_u32 s54, s57, 26624
    buffer_load_dwordx4 v7, s[32:35], s54 offen lds
    s_add_u32 s52, s52, 1
    s_mov_b32 s28, s24
    s_and_b32 s29, s25, 0xffff
    s_mov_b32 s30, 41943040
    s_mov_b32 s31, 0x20000
    s_lshl_b32 s55, s76, 13
    s_add_u32 s55, s55, 6357504
    s_lshr_b32 s56, s2, 5
    s_lshl_b32 s56, s56, 13
    s_add_u32 s56, s56, 6357504
    s_load_dword s10, s[24:25], s55
    s_load_dword s11, s[24:25], s56
    v_lshlrev_b32 v8, 5, v1
    v_add_u32 v8, s51, v8
    v_lshlrev_b32 v45, 2, v2
    s_lshl_b32 s75, s76, 13
    s_add_u32 s75, s75, 6360576
    s_waitcnt lgkmcnt(0)
    s_add_u32 s10, s10, 1
    s_add_u32 s11, s11, 1
    v_mov_b32 v16, 0
    v_mov_b32 v17, 0
    v_mov_b32 v18, 0
    v_mov_b32 v19, 0
    s_waitcnt vmcnt(8)
    s_barrier
    ds_read_b128 v[28:31], v8 offset:0
    ds_read_b128 v[32:35], v8 offset:16
    s_and_b32 s52, s52, 7
    s_lshl_b32 s53, s52, 7
    s_mul_i32 s57, s52, 196608
    s_add_u32 m0, s51, 16384
    s_nop 0
    buffer_load_dwordx4 v5, s[36:39], s53 offen lds
    s_add_u32 m0, s51, 81920
    s_add_u32 s54, s57, 0
    buffer_load_dwordx4 v7, s[32:35], s54 offen lds
    s_waitcnt lgkmcnt(0)
    v_lshlrev_b32 v40, 16, v28
    v_and_b32 v41, 0xffff0000, v28
    v_add_f32 v16, v16, v40
    v_add_f32 v17, v17, v41
    v_fmac_f32 v18, v40, v40
    v_fmac_f32 v19, v41, v41
    s_add_u32 m0, s51, 90112
    s_add_u32 s54, s57, 1024
    buffer_load_dwordx4 v7, s[32:35], s54 offen lds
    v_lshlrev_b32 v42, 16, v29
    v_and_b32 v43, 0xffff0000, v29
    v_add_f32 v16, v16, v42
    v_add_f32 v17, v17, v43
    v_fmac_f32 v18, v42, v42
    v_fmac_f32 v19, v43, v43
    s_add_u32 m0, s51, 98304
    s_add_u32 s54, s57, 2048
    buffer_load_dwordx4 v7, s[32:35], s54 offen lds
    v_lshlrev_b32 v40, 16, v30
    v_and_b32 v41, 0xffff0000, v30
    v_add_f32 v16, v16, v40
    v_add_f32 v17, v17, v41
    v_fmac_f32 v18, v40, v40
    v_fmac_f32 v19, v41, v41
    s_add_u32 m0, s51, 17408
    s_nop 0
    buffer_load_dwordx4 v6, s[36:39], s53 offen lds
    v_lshlrev_b32 v42, 16, v31
    v_and_b32 v43, 0xffff0000, v31
    v_add_f32 v16, v16, v42
    v_add_f32 v17, v17, v43
    v_fmac_f32 v18, v42, v42
    v_fmac_f32 v19, v43, v43
    s_add_u32 m0, s51, 82944
    s_add_u32 s54, s57, 24576
    buffer_load_dwordx4 v7, s[32:35], s54 offen lds
    v_lshlrev_b32 v40, 16, v32
    v_and_b32 v41, 0xffff0000, v32
    v_add_f32 v16, v16, v40
    v_add_f32 v17, v17, v41
    v_fmac_f32 v18, v40, v40
    v_fmac_f32 v19, v41, v41
    s_add_u32 m0, s51, 91136
    s_add_u32 s54, s57, 25600
    buffer_load_dwordx4 v7, s[32:35], s54 offen lds
    v_lshlrev_b32 v42, 16, v33
    v_and_b32 v43, 0xffff0000, v33
    v_add_f32 v16, v16, v42
    v_add_f32 v17, v17, v43
    v_fmac_f32 v18, v42, v42
    v_fmac_f32 v19, v43, v43
    s_add_u32 m0, s51, 99328
    s_add_u32 s54, s57, 26624
    buffer_load_dwordx4 v7, s[32:35], s54 offen lds
    v_lshlrev_b32 v40, 16, v34
    v_and_b32 v41, 0xffff0000, v34
    v_add_f32 v16, v16, v40
    v_add_f32 v17, v17, v41
    v_fmac_f32 v18, v40, v40
    v_fmac_f32 v19, v41, v41
    s_add_u32 s52, s52, 1
    s_and_b32 s52, s52, 7
    s_lshl_b32 s53, s52, 7
    s_mul_i32 s57, s52, 196608
    s_add_u32 m0, s51, 24576
    s_nop 0
    buffer_load_dwordx4 v5, s[36:39], s53 offen lds
    v_lshlrev_b32 v42, 16, v35
    v_and_b32 v43, 0xffff0000, v35
    v_add_f32 v16, v16, v42
    v_add_f32 v17, v17, v43
    v_fmac_f32 v18, v42, v42
    v_fmac_f32 v19, v43, v43
    s_add_u32 m0, s51, 106496
    s_add_u32 s54, s57, 0
    buffer_load_dwordx4 v7, s[32:35], s54 offen lds
    s_add_u32 m0, s51, 114688
    s_add_u32 s54, s57, 1024
    buffer_load_dwordx4 v7, s[32:35], s54 offen lds
    s_add_u32 m0, s51, 122880
    s_add_u32 s54, s57, 2048
    buffer_load_dwordx4 v7, s[32:35], s54 offen lds
    s_add_u32 m0, s51, 25600
    s_nop 0
    buffer_load_dwordx4 v6, s[36:39], s53 offen lds
    s_add_u32 m0, s51, 107520
    s_add_u32 s54, s57, 24576
    buffer_load_dwordx4 v7, s[32:35], s54 offen lds
    s_add_u32 m0, s51, 115712
    s_add_u32 s54, s57, 25600
    buffer_load_dwordx4 v7, s[32:35], s54 offen lds
    s_add_u32 m0, s51, 123904
    s_add_u32 s54, s57, 26624
    buffer_load_dwordx4 v7, s[32:35], s54 offen lds
    s_add_u32 s52, s52, 1
    s_waitcnt vmcnt(16)
    s_barrier
    ds_read_b128 v[28:31], v8 offset:8192
    ds_read_b128 v[32:35], v8 offset:8208
    s_and_b32 s52, s52, 7
    s_lshl_b32 s53, s52, 7
    s_mul_i32 s57, s52, 196608
    s_add_u32 m0, s51, 0
    s_nop 0
    buffer_load_dwordx4 v5, s[36:39], s53 offen lds
    s_add_u32 m0, s51, 32768
    s_add_u32 s54, s57, 0
    buffer_load_dwordx4 v7, s[32:35], s54 offen lds
    s_waitcnt lgkmcnt(0)
    v_lshlrev_b32 v40, 16, v28
    v_and_b32 v41, 0xffff0000, v28
    v_add_f32 v16, v16, v40
    v_add_f32 v17, v17, v41
    v_fmac_f32 v18, v40, v40
    v_fmac_f32 v19, v41, v41
    s_add_u32 m0, s51, 40960
    s_add_u32 s54, s57, 1024
    buffer_load_dwordx4 v7, s[32:35], s54 offen lds
    v_lshlrev_b32 v42, 16, v29
    v_and_b32 v43, 0xffff0000, v29
    v_add_f32 v16, v16, v42
    v_add_f32 v17, v17, v43
    v_fmac_f32 v18, v42, v42
    v_fmac_f32 v19, v43, v43
    s_add_u32 m0, s51, 49152
    s_add_u32 s54, s57, 2048
    buffer_load_dwordx4 v7, s[32:35], s54 offen lds
    v_lshlrev_b32 v40, 16, v30
    v_and_b32 v41, 0xffff0000, v30
    v_add_f32 v16, v16, v40
    v_add_f32 v17, v17, v41
    v_fmac_f32 v18, v40, v40
    v_fmac_f32 v19, v41, v41
    s_add_u32 m0, s51, 1024
    s_nop 0
    buffer_load_dwordx4 v6, s[36:39], s53 offen lds
    v_lshlrev_b32 v42, 16, v31
    v_and_b32 v43, 0xffff0000, v31
    v_add_f32 v16, v16, v42
    v_add_f32 v17, v17, v43
    v_fmac_f32 v18, v42, v42
    v_fmac_f32 v19, v43, v43
    s_add_u32 m0, s51, 33792
    s_add_u32 s54, s57, 24576
    buffer_load_dwordx4 v7, s[32:35], s54 offen lds
    v_lshlrev_b32 v40, 16, v32
    v_and_b32 v41, 0xffff0000, v32
    v_add_f32 v16, v16, v40
    v_add_f32 v17, v17, v41
    v_fmac_f32 v18, v40, v40
    v_fmac_f32 v19, v41, v41
    s_add_u32 m0, s51, 41984
    s_add_u32 s54, s57, 25600
    buffer_load_dwordx4 v7, s[32:35], s54 offen lds
    v_lshlrev_b32 v42, 16, v33
    v_and_b32 v43, 0xffff0000, v33
    v_add_f32 v16, v16, v42
    v_add_f32 v17, v17, v43
    v_fmac_f32 v18, v42, v42
    v_fmac_f32 v19, v43, v43
    s_add_u32 m0, s51, 50176
    s_add_u32 s54, s57, 26624
    buffer_load_dwordx4 v7, s[32:35], s54 offen lds
    v_lshlrev_b32 v40, 16, v34
    v_and_b32 v41, 0xffff0000, v34
    v_add_f32 v16, v16, v40
    v_add_f32 v17, v17, v41
    v_fmac_f32 v18, v40, v40
    v_fmac_f32 v19, v41, v41
    s_add_u32 s52, s52, 1
    v_lshlrev_b32 v42, 16, v35
    v_and_b32 v43, 0xffff0000, v35
    v_add_f32 v16, v16, v42
    v_add_f32 v17, v17, v43
    v_fmac_f32 v18, v42, v42
    v_fmac_f32 v19, v43, v43
    s_waitcnt vmcnt(16)
    s_barrier
    ds_read_b128 v[28:31], v8 offset:16384
    ds_read_b128 v[32:35], v8 offset:16400
    s_and_b32 s52, s52, 7
    s_lshl_b32 s53, s52, 7
    s_mul_i32 s57, s52, 196608
    s_add_u32 m0, s51, 8192
    s_nop 0
    buffer_load_dwordx4 v5, s[36:39], s53 offen lds
    s_add_u32 m0, s51, 57344
    s_add_u32 s54, s57, 0
    buffer_load_dwordx4 v7, s[32:35], s54 offen lds
    s_waitcnt lgkmcnt(0)
    v_lshlrev_b32 v40, 16, v28
    v_and_b32 v41, 0xffff0000, v28
    v_add_f32 v16, v16, v40
    v_add_f32 v17, v17, v41
    v_fmac_f32 v18, v40, v40
    v_fmac_f32 v19, v41, v41
    s_add_u32 m0, s51, 65536
    s_add_u32 s54, s57, 1024
    buffer_load_dwordx4 v7, s[32:35], s54 offen lds
    v_lshlrev_b32 v42, 16, v29
    v_and_b32 v43, 0xffff0000, v29
    v_add_f32 v16, v16, v42
    v_add_f32 v17, v17, v43
    v_fmac_f32 v18, v42, v42
    v_fmac_f32 v19, v43, v43
    s_add_u32 m0, s51, 73728
    s_add_u32 s54, s57, 2048
    buffer_load_dwordx4 v7, s[32:35], s54 offen lds
    v_lshlrev_b32 v40, 16, v30
    v_and_b32 v41, 0xffff0000, v30
    v_add_f32 v16, v16, v40
    v_add_f32 v17, v17, v41
    v_fmac_f32 v18, v40, v40
    v_fmac_f32 v19, v41, v41
    s_add_u32 m0, s51, 9216
    s_nop 0
    buffer_load_dwordx4 v6, s[36:39], s53 offen lds
    v_lshlrev_b32 v42, 16, v31
    v_and_b32 v43, 0xffff0000, v31
    v_add_f32 v16, v16, v42
    v_add_f32 v17, v17, v43
    v_fmac_f32 v18, v42, v42
    v_fmac_f32 v19, v43, v43
    s_add_u32 m0, s51, 58368
    s_add_u32 s54, s57, 24576
    buffer_load_dwordx4 v7, s[32:35], s54 offen lds
    v_lshlrev_b32 v40, 16, v32
    v_and_b32 v41, 0xffff0000, v32
    v_add_f32 v16, v16, v40
    v_add_f32 v17, v17, v41
    v_fmac_f32 v18, v40, v40
    v_fmac_f32 v19, v41, v41
    s_add_u32 m0, s51, 66560
    s_add_u32 s54, s57, 25600
    buffer_load_dwordx4 v7, s[32:35], s54 offen lds
    v_lshlrev_b32 v42, 16, v33
    v_and_b32 v43, 0xffff0000, v33
    v_add_f32 v16, v16, v42
    v_add_f32 v17, v17, v43
    v_fmac_f32 v18, v42, v42
    v_fmac_f32 v19, v43, v43
    s_add_u32 m0, s51, 74752
    s_add_u32 s54, s57, 26624
    buffer_load_dwordx4 v7, s[32:35], s54 offen lds
    v_lshlrev_b32 v40, 16, v34
    v_and_b32 v41, 0xffff0000, v34
    v_add_f32 v16, v16, v40
    v_add_f32 v17, v17, v41
    v_fmac_f32 v18, v40, v40
    v_fmac_f32 v19, v41, v41
    s_add_u32 s52, s52, 1
    v_lshlrev_b32 v42, 16, v35
    v_and_b32 v43, 0xffff0000, v35
    v_add_f32 v16, v16, v42
    v_add_f32 v17, v17, v43
    v_fmac_f32 v18, v42, v42
    v_fmac_f32 v19, v43, v43
    s_waitcnt vmcnt(16)
    s_barrier
    ds_read_b128 v[28:31], v8 offset:24576
    ds_read_b128 v[32:35], v8 offset:24592
    s_and_b32 s52, s52, 7
    s_lshl_b32 s53, s52, 7
    s_mul_i32 s57, s52, 196608
    s_add_u32 m0, s51, 16384
    s_nop 0
    buffer_load_dwordx4 v5, s[36:39], s53 offen lds
    s_add_u32 m0, s51, 81920
    s_add_u32 s54, s57, 0
    buffer_load_dwordx4 v7, s[32:35], s54 offen lds
    s_waitcnt lgkmcnt(0)
    v_lshlrev_b32 v40, 16, v28
    v_and_b32 v41, 0xffff0000, v28
    v_add_f32 v16, v16, v40
    v_add_f32 v17, v17, v41
    v_fmac_f32 v18, v40, v40
    v_fmac_f32 v19, v41, v41
    s_add_u32 m0, s51, 90112
    s_add_u32 s54, s57, 1024
    buffer_load_dwordx4 v7, s[32:35], s54 offen lds
    v_lshlrev_b32 v42, 16, v29
    v_and_b32 v43, 0xffff0000, v29
    v_add_f32 v16, v16, v42
    v_add_f32 v17, v17, v43
    v_fmac_f32 v18, v42, v42
    v_fmac_f32 v19, v43, v43
    s_add_u32 m0, s51, 98304
    s_add_u32 s54, s57, 2048
    buffer_load_dwordx4 v7, s[32:35], s54 offen lds
    v_lshlrev_b32 v40, 16, v30
    v_and_b32 v41, 0xffff0000, v30
    v_add_f32 v16, v16, v40
    v_add_f32 v17, v17, v41
    v_fmac_f32 v18, v40, v40
    v_fmac_f32 v19, v41, v41
    s_add_u32 m0, s51, 17408
    s_nop 0
    buffer_load_dwordx4 v6, s[36:39], s53 offen lds
    v_lshlrev_b32 v42, 16, v31
    v_and_b32 v43, 0xffff0000, v31
    v_add_f32 v16, v16, v42
    v_add_f32 v17, v17, v43
    v_fmac_f32 v18, v42, v42
    v_fmac_f32 v19, v43, v43
    s_add_u32 m0, s51, 82944
    s_add_u32 s54, s57, 24576
    buffer_load_dwordx4 v7, s[32:35], s54 offen lds
    v_lshlrev_b32 v40, 16, v32
    v_and_b32 v41, 0xffff0000, v32
    v_add_f32 v16, v16, v40
    v_add_f32 v17, v17, v41
    v_fmac_f32 v18, v40, v40
    v_fmac_f32 v19, v41, v41
    s_add_u32 m0, s51, 91136
    s_add_u32 s54, s57, 25600
    buffer_load_dwordx4 v7, s[32:35], s54 offen lds
    v_lshlrev_b32 v42, 16, v33
    v_and_b32 v43, 0xffff0000, v33
    v_add_f32 v16, v16, v42
    v_add_f32 v17, v17, v43
    v_fmac_f32 v18, v42, v42
    v_fmac_f32 v19, v43, v43
    s_add_u32 m0, s51, 99328
    s_add_u32 s54, s57, 26624
    buffer_load_dwordx4 v7, s[32:35], s54 offen lds
    v_lshlrev_b32 v40, 16, v34
    v_and_b32 v41, 0xffff0000, v34
    v_add_f32 v16, v16, v40
    v_add_f32 v17, v17, v41
    v_fmac_f32 v18, v40, v40
    v_fmac_f32 v19, v41, v41
    s_add_u32 s52, s52, 1
    v_lshlrev_b32 v42, 16, v35
    v_and_b32 v43, 0xffff0000, v35
    v_add_f32 v16, v16, v42
    v_add_f32 v17, v17, v43
    v_fmac_f32 v18, v42, v42
    v_fmac_f32 v19, v43, v43
    s_waitcnt vmcnt(16)
    s_barrier
    ds_read_b128 v[28:31], v8 offset:0
    ds_read_b128 v[32:35], v8 offset:16
    s_and_b32 s52, s52, 7
    s_lshl_b32 s53, s52, 7
    s_mul_i32 s57, s52, 196608
    s_add_u32 m0, s51, 24576
    s_nop 0
    buffer_load_dwordx4 v5, s[36:39], s53 offen lds
    s_add_u32 m0, s51, 106496
    s_add_u32 s54, s57, 0
    buffer_load_dwordx4 v7, s[32:35], s54 offen lds
    s_waitcnt lgkmcnt(0)
    v_lshlrev_b32 v40, 16, v28
    v_and_b32 v41, 0xffff0000, v28
    v_add_f32 v16, v16, v40
    v_add_f32 v17, v17, v41
    v_fmac_f32 v18, v40, v40
    v_fmac_f32 v19, v41, v41
    s_add_u32 m0, s51, 114688
    s_add_u32 s54, s57, 1024
    buffer_load_dwordx4 v7, s[32:35], s54 offen lds
    v_lshlrev_b32 v42, 16, v29
    v_and_b32 v43, 0xffff0000, v29
    v_add_f32 v16, v16, v42
    v_add_f32 v17, v17, v43
    v_fmac_f32 v18, v42, v42
    v_fmac_f32 v19, v43, v43
    s_add_u32 m0, s51, 122880
    s_add_u32 s54, s57, 2048
    buffer_load_dwordx4 v7, s[32:35], s54 offen lds
    v_lshlrev_b32 v40, 16, v30
    v_and_b32 v41, 0xffff0000, v30
    v_add_f32 v16, v16, v40
    v_add_f32 v17, v17, v41
    v_fmac_f32 v18, v40, v40
    v_fmac_f32 v19, v41, v41
    s_add_u32 m0, s51, 25600
    s_nop 0
    buffer_load_dwordx4 v6, s[36:39], s53 offen lds
    v_lshlrev_b32 v42, 16, v31
    v_and_b32 v43, 0xffff0000, v31
    v_add_f32 v16, v16, v42
    v_add_f32 v17, v17, v43
    v_fmac_f32 v18, v42, v42
    v_fmac_f32 v19, v43, v43
    s_add_u32 m0, s51, 107520
    s_add_u32 s54, s57, 24576
    buffer_load_dwordx4 v7, s[32:35], s54 offen lds
    v_lshlrev_b32 v40, 16, v32
    v_and_b32 v41, 0xffff0000, v32
    v_add_f32 v16, v16, v40
    v_add_f32 v17, v17, v41
    v_fmac_f32 v18, v40, v40
    v_fmac_f32 v19, v41, v41
    s_add_u32 m0, s51, 115712
    s_add_u32 s54, s57, 25600
    buffer_load_dwordx4 v7, s[32:35], s54 offen lds
    v_lshlrev_b32 v42, 16, v33
    v_and_b32 v43, 0xffff0000, v33
    v_add_f32 v16, v16, v42
    v_add_f32 v17, v17, v43
    v_fmac_f32 v18, v42, v42
    v_fmac_f32 v19, v43, v43
    s_add_u32 m0, s51, 123904
    s_add_u32 s54, s57, 26624
    buffer_load_dwordx4 v7, s[32:35], s54 offen lds
    v_lshlrev_b32 v40, 16, v34
    v_and_b32 v41, 0xffff0000, v34
    v_add_f32 v16, v16, v40
    v_add_f32 v17, v17, v41
    v_fmac_f32 v18, v40, v40
    v_fmac_f32 v19, v41, v41
    s_add_u32 s52, s52, 1
    v_lshlrev_b32 v42, 16, v35
    v_and_b32 v43, 0xffff0000, v35
    v_add_f32 v16, v16, v42
    v_add_f32 v17, v17, v43
    v_fmac_f32 v18, v42, v42
    v_fmac_f32 v19, v43, v43
    s_waitcnt vmcnt(16)
    s_barrier
    ds_read_b128 v[28:31], v8 offset:8192
    ds_read_b128 v[32:35], v8 offset:8208
    s_cmp_lg_u32 s44, 0
    s_cbranch_scc1 L_p1_d1
    buffer_load_dword v44, v45, s[28:31], s75 offen sc1
    s_branch L_p1_d2
L_p1_d1:
    buffer_load_dword v44, v45, s[36:39], 0 offen
L_p1_d2:
    s_waitcnt lgkmcnt(0)
    v_lshlrev_b32 v40, 16, v28
    v_and_b32 v41, 0xffff0000, v28
    v_add_f32 v16, v16, v40
    v_add_f32 v17, v17, v41
    v_fmac_f32 v18, v40, v40
    v_fmac_f32 v19, v41, v41
    v_lshlrev_b32 v42, 16, v29
    v_and_b32 v43, 0xffff0000, v29
    v_add_f32 v16, v16, v42
    v_add_f32 v17, v17, v43
    v_fmac_f32 v18, v42, v42
    v_fmac_f32 v19, v43, v43
    v_lshlrev_b32 v40, 16, v30
    v_and_b32 v41, 0xffff0000, v30
    v_add_f32 v16, v16, v40
    v_add_f32 v17, v17, v41
    v_fmac_f32 v18, v40, v40
    v_fmac_f32 v19, v41, v41
    v_lshlrev_b32 v42, 16, v31
    v_and_b32 v43, 0xffff0000, v31
    v_add_f32 v16, v16, v42
    v_add_f32 v17, v17, v43
    v_fmac_f32 v18, v42, v42
    v_fmac_f32 v19, v43, v43
    v_lshlrev_b32 v40, 16, v32
    v_and_b32 v41, 0xffff0000, v32
    v_add_f32 v16, v16, v40
    v_add_f32 v17, v17, v41
    v_fmac_f32 v18, v40, v40
    v_fmac_f32 v19, v41, v41
    v_lshlrev_b32 v42, 16, v33
    v_and_b32 v43, 0xffff0000, v33
    v_add_f32 v16, v16, v42
    v_add_f32 v17, v17, v43
    v_fmac_f32 v18, v42, v42
    v_fmac_f32 v19, v43, v43
    v_lshlrev_b32 v40, 16, v34
    v_and_b32 v41, 0xffff0000, v34
    v_add_f32 v16, v16, v40
    v_add_f32 v17, v17, v41
    v_fmac_f32 v18, v40, v40
    v_fmac_f32 v19, v41, v41
    v_lshlrev_b32 v42, 16, v35
    v_and_b32 v43, 0xffff0000, v35
    v_add_f32 v16, v16, v42
    v_add_f32 v17, v17, v43
    v_fmac_f32 v18, v42, v42
    v_fmac_f32 v19, v43, v43
    s_waitcnt vmcnt(9)
    s_barrier
    ds_read_b128 v[28:31], v8 offset:16384
    ds_read_b128 v[32:35], v8 offset:16400
    s_waitcnt lgkmcnt(0)
    v_lshlrev_b32 v40, 16, v28
    v_and_b32 v41, 0xffff0000, v28
    v_add_f32 v16, v16, v40
    v_add_f32 v17, v17, v41
    v_fmac_f32 v18, v40, v40
    v_fmac_f32 v19, v41, v41
    v_lshlrev_b32 v42, 16, v29
    v_and_b32 v43, 0xffff0000, v29
    v_add_f32 v16, v16, v42
    v_add_f32 v17, v17, v43
    v_fmac_f32 v18, v42, v42
    v_fmac_f32 v19, v43, v43
    v_lshlrev_b32 v40, 16, v30
    v_and_b32 v41, 0xffff0000, v30
    v_add_f32 v16, v16, v40
    v_add_f32 v17, v17, v41
    v_fmac_f32 v18, v40, v40
    v_fmac_f32 v19, v41, v41
    v_lshlrev_b32 v42, 16, v31
    v_and_b32 v43, 0xffff0000, v31
    v_add_f32 v16, v16, v42
    v_add_f32 v17, v17, v43
    v_fmac_f32 v18, v42, v42
    v_fmac_f32 v19, v43, v43
    v_lshlrev_b32 v40, 16, v32
    v_and_b32 v41, 0xffff0000, v32
    v_add_f32 v16, v16, v40
    v_add_f32 v17, v17, v41
    v_fmac_f32 v18, v40, v40
    v_fmac_f32 v19, v41, v41
    v_lshlrev_b32 v42, 16, v33
    v_and_b32 v43, 0xffff0000, v33
    v_add_f32 v16, v16, v42
    v_add_f32 v17, v17, v43
    v_fmac_f32 v18, v42, v42
    v_fmac_f32 v19, v43, v43
    v_lshlrev_b32 v40, 16, v34
    v_and_b32 v41, 0xffff0000, v34
    v_add_f32 v16, v16, v40
    v_add_f32 v17, v17, v41
    v_fmac_f32 v18, v40, v40
    v_fmac_f32 v19, v41, v41
    v_lshlrev_b32 v42, 16, v35
    v_and_b32 v43, 0xffff0000, v35
    v_add_f32 v16, v16, v42
    v_add_f32 v17, v17, v43
    v_fmac_f32 v18, v42, v42
    v_fmac_f32 v19, v43, v43
    s_waitcnt vmcnt(1)
    s_barrier
    ds_read_b128 v[28:31], v8 offset:24576
    ds_read_b128 v[32:35], v8 offset:24592
    s_waitcnt lgkmcnt(0)
    v_lshlrev_b32 v40, 16, v28
    v_and_b32 v41, 0xffff0000, v28
    v_add_f32 v16, v16, v40
    v_add_f32 v17, v17, v41
    v_fmac_f32 v18, v40, v40
    v_fmac_f32 v19, v41, v41
    v_lshlrev_b32 v42, 16, v29
    v_and_b32 v43, 0xffff0000, v29
    v_add_f32 v16, v16, v42
    v_add_f32 v17, v17, v43
    v_fmac_f32 v18, v42, v42
    v_fmac_f32 v19, v43, v43
    v_lshlrev_b32 v40, 16, v30
    v_and_b32 v41, 0xffff0000, v30
    v_add_f32 v16, v16, v40
    v_add_f32 v17, v17, v41
    v_fmac_f32 v18, v40, v40
    v_fmac_f32 v19, v41, v41
    v_lshlrev_b32 v42, 16, v31
    v_and_b32 v43, 0xffff0000, v31
    v_add_f32 v16, v16, v42
    v_add_f32 v17, v17, v43
    v_fmac_f32 v18, v42, v42
    v_fmac_f32 v19, v43, v43
    v_lshlrev_b32 v40, 16, v32
    v_and_b32 v41, 0xffff0000, v32
    v_add_f32 v16, v16, v40
    v_add_f32 v17, v17, v41
    v_fmac_f32 v18, v40, v40
    v_fmac_f32 v19, v41, v41
    v_lshlrev_b32 v42, 16, v33
    v_and_b32 v43, 0xffff0000, v33
    v_add_f32 v16, v16, v42
    v_add_f32 v17, v17, v43
    v_fmac_f32 v18, v42, v42
    v_fmac_f32 v19, v43, v43
    v_lshlrev_b32 v40, 16, v34
    v_and_b32 v41, 0xffff0000, v34
    v_add_f32 v16, v16, v40
    v_add_f32 v17, v17, v41
    v_fmac_f32 v18, v40, v40
    v_fmac_f32 v19, v41, v41
    v_lshlrev_b32 v42, 16, v35
    v_and_b32 v43, 0xffff0000, v35
    v_add_f32 v16, v16, v42
    v_add_f32 v17, v17, v43
    v_fmac_f32 v18, v42, v42
    v_fmac_f32 v19, v43, v43
    v_add_f32 v16, v16, v17
    v_add_f32 v18, v18, v19
    s_nop 1
    v_add_f32_dpp v16, v16, v16 quad_perm:[1,0,3,2] row_mask:0xf bank_mask:0xf
    v_add_f32_dpp v18, v18, v18 quad_perm:[1,0,3,2] row_mask:0xf bank_mask:0xf
    s_nop 1
    v_add_f32_dpp v16, v16, v16 quad_perm:[2,3,0,1] row_mask:0xf bank_mask:0xf
    v_add_f32_dpp v18, v18, v18 quad_perm:[2,3,0,1] row_mask:0xf bank_mask:0xf
    s_nop 0
    v_mul_f32 v16, 0.001953125, v16
    v_mul_f32 v18, 0.001953125, v18
    v_fma_f32 v18, -v16, v16, v18
    v_max_f32 v18, 0, v18
    v_add_f32 v18, 1e-05, v18
    v_rsq_f32 v17, v18
    v_lshrrev_b32 v22, 2, v1
    v_lshlrev_b32 v22, 2, v22
    s_lshl_b32 s55, s44, 6
    s_add_u32 s55, s55, 90112
    v_add_u32 v22, s55, v22
    v_mul_f32 v19, v16, v17
    v_sub_f32 v19, 0, v19
    ds_write_b32 v22, v17
    ds_write_b32 v22, v19 offset:256
    s_mov_b32 s26, 0
    s_mov_b32 s3, 0
    s_cmp_lg_u32 s44, 0
    s_cbranch_scc1 L_p1_xskip
    s_branch L_p1_xchk
L_p1_xpoll:
    s_sleep 4
    buffer_load_dword v44, v45, s[28:31], s75 offen sc1
    s_add_u32 s26, s26, 1
    s_cmp_ge_u32 s26, 0x40000
    s_cbranch_scc1 L_p1_xdone
L_p1_xchk:
    s_waitcnt vmcnt(0)
    s_lshl_b32 s55, s10, 4
    v_and_b32 v22, -16, v44
    v_cmp_ne_u32 vcc, s55, v22
    s_cbranch_vccnz L_p1_xpoll
    s_add_u32 s55, s55, s78
    v_cmp_ne_u32 vcc, s55, v44
    s_cbranch_vccnz L_p1_xdone
    s_mov_b32 s3, 1
L_p1_xdone:
    v_mov_b32 v22, 90624
    v_mov_b32 v23, s3
    ds_write_b32 v22, v23
L_p1_xskip:
    v_mov_b32 v22, 90624
    s_waitcnt lgkmcnt(0)
    s_barrier
    ds_read_b32 v23, v22
    s_waitcnt lgkmcnt(0)
    v_readfirstlane_b32 s3, v23
    s_cmp_lg_u32 s44, 0
    s_cbranch_scc1 L_h1b_x
    s_lshl_b32 s55, s76, 13
    s_add_u32 s55, s55, 6360064
    v_min_u32 v228, 31, v1
    v_lshlrev_b32 v228, 2, v228
    s_mov_b32 s26, 0
L_h1b_p:
    buffer_load_dword v229, v228, s[28:31], s55 offen sc1
    s_add_u32 s26, s26, 1
    s_cmp_ge_u32 s26, 0x100000
    s_cbranch_scc1 L_h1b_x
    s_waitcnt vmcnt(0)
    v_cmp_ne_u32 vcc, s10, v229
    s_cbranch_vccz L_h1b_x
    s_sleep 1
    s_branch L_h1b_p
L_h1b_x:
    s_barrier
L_p1_done:
    s_and_b32 s76, s2, 7
    s_lshl_b32 s53, s76, 13
    s_add_u32 s53, s53, 6360064
    s_lshl_b32 s76, s76, 2
    s_bfe_u32 s55, s2, 0x20003
    s_add_u32 s76, s76, s55
    s_lshr_b32 s77, s2, 5
    s_lshl_b32 s77, s77, 3
    s_lshl_b32 s55, s44, 1
    s_add_u32 s77, s77, s55
    s_lshr_b32 s80, s27, 2
    s_lshl_b32 s55, s80, 5
    s_add_u32 s55, s55, s44
    s_lshl_b32 s82, s55, 10
    s_mul_i32 s83, s55, 1056
    s_lshl_b32 s81, s76, 16
    s_add_u32 s81, s81, s82
    s_lshl_b32 s55, s76, 6
    s_add_u32 s56, s55, s77
    s_lshl_b32 s56, s56, 10
    v_lshlrev_b32 v6, 2, v1
    buffer_load_dwordx4 v[8:11], v4, s[28:31], s56 offen sc1
    buffer_load_dwordx4 v[12:15], v4, s[28:31], s56 offen offset:1024 sc1
    s_lshl_b32 s56, s55, 2
    s_add_u32 s56, s56, 6291456
    buffer_load_dword v7, v6, s[28:31], s56 offen sc1
    s_add_u32 m0, s82, 0
    s_add_u32 s78, s81, 2097152
    buffer_load_dwordx4 v4, s[28:31], s78 offen sc1 lds
    s_add_u32 m0, s83, 65536
    s_add_u32 s78, s81, 4194304
    buffer_load_dwordx4 v4, s[28:31], s78 offen sc1 lds
    s_add_u32 m0, s82, 4096
    s_add_u32 s78, s81, 2101248
    buffer_load_dwordx4 v4, s[28:31], s78 offen sc1 lds
    s_add_u32 m0, s83, 69760
    s_add_u32 s78, s81, 4198400
    buffer_load_dwordx4 v4, s[28:31], s78 offen sc1 lds
    v_mov_b32 v120, 0x3f803f80
    v_mov_b32 v121, 0x3f803f80
    v_mov_b32 v122, 0x3f803f80
    v_mov_b32 v123, 0x3f803f80
    v_mul_u32_u24 v44, 1056, v1
    v_add_u32 v44, 66560, v44
    ds_write_b128 v44, v[120:123]
    v_mov_b32 v124, 0
    v_mov_b32 v125, 0
    v_mov_b32 v126, 0
    v_mov_b32 v127, 0
    ds_write_b128 v44, v[124:127] offset:16
    v_bfe_u32 v6, v1, 5, 1
    v_and_b32 v44, 15, v1
    v_lshlrev_b32 v44, 4, v44
    v_lshl_add_u32 v44, v6, 8, v44
    v_add_u32 v44, 65536, v44
    v_add_u32 v45, 512, v44
    v_bfe_u32 v6, v1, 4, 1
    v_cmp_eq_u32 vcc, 1, v6
    v_mov_b32 v6, 66576
    s_nop 0
    v_cndmask_b32 v44, v44, v6, vcc
    v_cndmask_b32 v45, v45, v6, vcc
    v_and_b32 v6, 27, v1
    v_cmp_eq_u32 vcc, 16, v6
    v_mov_b32 v6, 66560
    s_nop 0
    v_cndmask_b32 v44, v44, v6, vcc
    v_cndmask_b32 v45, v45, v6, vcc
    s_lshl_b32 s55, s80, 15
    s_mul_i32 s56, s80, 33792
    v_add_u32 v5, s55, v4
    v_add_u32 v46, s56, v44
    v_add_u32 v47, s56, v45
    v_mov_b32 v80, 0
    v_mov_b32 v81, 0
    v_mov_b32 v82, 0
    v_mov_b32 v83, 0
    v_mov_b32 v84, 0
    v_mov_b32 v85, 0
    v_mov_b32 v86, 0
    v_mov_b32 v87, 0
    v_mov_b32 v88, 0
    v_mov_b32 v89, 0
    v_mov_b32 v90, 0
    v_mov_b32 v91, 0
    v_mov_b32 v92, 0
    v_mov_b32 v93, 0
    v_mov_b32 v94, 0
    v_mov_b32 v95, 0
    v_mov_b32 v128, 0
    v_mov_b32 v129, 0
    v_mov_b32 v130, 0
    v_mov_b32 v131, 0
    v_mov_b32 v132, 0
    v_mov_b32 v133, 0
    v_mov_b32 v134, 0
    v_mov_b32 v135, 0
    v_mov_b32 v136, 0
    v_mov_b32 v137, 0
    v_mov_b32 v138, 0
    v_mov_b32 v139, 0
    v_mov_b32 v140, 0
    v_mov_b32 v141, 0
    v_mov_b32 v142, 0
    v_mov_b32 v143, 0
    v_mov_b32 v116, 0
    v_mov_b32 v117, 0
    v_mov_b32 v118, 0
    v_mov_b32 v119, 0
    v_mov_b32 v24, 0
    v_mov_b32 v25, 0
    v_mov_b32 v26, 0
    v_mov_b32 v27, 0
    s_waitcnt vmcnt(4)
    v_mov_b32 v6, 0
    v_mov_b32 v43, 0
    v_max_f32_dpp v7, v7, v7 row_shr:1 row_mask:0xf bank_mask:0xf
    v_dot2_f32_bf16 v6, v8, v8, v6
    v_dot2_f32_bf16 v43, v12, v12, v43
    v_max_f32_dpp v7, v7, v7 row_shr:2 row_mask:0xf bank_mask:0xf
    v_dot2_f32_bf16 v6, v9, v9, v6
    v_dot2_f32_bf16 v43, v13, v13, v43
    v_max_f32_dpp v7, v7, v7 row_shr:4 row_mask:0xf bank_mask:0xf
    v_dot2_f32_bf16 v6, v10, v10, v6
    v_dot2_f32_bf16 v43, v14, v14, v43
    v_max_f32_dpp v7, v7, v7 row_shr:8 row_mask:0xf bank_mask:0xf
    v_dot2_f32_bf16 v6, v11, v11, v6
    v_dot2_f32_bf16 v43, v15, v15, v43
    v_max_f32_dpp v7, v7, v7 row_bcast:15 row_mask:0xa bank_mask:0xf
    s_nop 1
    v_max_f32_dpp v7, v7, v7 row_bcast:31 row_mask:0xc bank_mask:0xf
    v_mov_b32 v96, v6
    v_mov_b32 v144, v43
    s_nop 0
    v_readlane_b32 s55, v7, 63
    v_permlane32_swap_b32 v6, v96
    v_permlane32_swap_b32 v43, v144
    s_nop 1
    v_add_f32 v6, v6, v96
    v_add_f32 v43, v43, v144
    v_mul_f32 v6, s55, v6
    v_mul_f32 v43, s55, v43
    v_sqrt_f32 v6, v6
    v_sqrt_f32 v43, v43
    s_nop 0
    v_sub_f32 v6, 0, v6
    v_sub_f32 v43, 0, v43
    v_mov_b32 v96, v6
    v_mov_b32 v144, v43
    v_mov_b32 v97, v6
    v_mov_b32 v145, v43
    v_mov_b32 v98, v6
    v_mov_b32 v146, v43
    v_mov_b32 v99, v6
    v_mov_b32 v147, v43
    v_mov_b32 v100, v6
    v_mov_b32 v148, v43
    v_mov_b32 v101, v6
    v_mov_b32 v149, v43
    v_mov_b32 v102, v6
    v_mov_b32 v150, v43
    v_mov_b32 v103, v6
    v_mov_b32 v151, v43
    v_mov_b32 v104, v6
    v_mov_b32 v152, v43
    v_mov_b32 v105, v6
    v_mov_b32 v153, v43
    v_mov_b32 v106, v6
    v_mov_b32 v154, v43
    v_mov_b32 v107, v6
    v_mov_b32 v155, v43
    v_mov_b32 v108, v6
    v_mov_b32 v156, v43
    v_mov_b32 v109, v6
    v_mov_b32 v157, v43
    v_mov_b32 v110, v6
    v_mov_b32 v158, v43
    v_mov_b32 v111, v6
    v_mov_b32 v159, v43
    s_waitcnt vmcnt(2) lgkmcnt(0)
    s_barrier
    ds_read_b128 v[16:19], v5 offset:0
    ds_read_b128 v[20:23], v46 offset:0
    s_waitcnt lgkmcnt(1)
    v_mfma_f32_32x32x16_bf16 v[48:63], v[16:19], v[8:11], v[96:111]
    s_nop 7
    s_nop 7
    s_cmp_eq_u32 s80, 0
    s_cbranch_scc1 L_a_pr0
    s_setprio 1
L_a_pr0:
    v_exp_f32 v48, v48
    v_exp_f32 v49, v49
    v_mfma_f32_32x32x16_bf16 v[128:143], v[24:27], v[116:119], v[128:143]
    v_exp_f32 v50, v50
    ds_read_b128 v[24:27], v47 offset:0
    v_exp_f32 v51, v51
    v_cvt_pk_bf16_f32 v28, v48, v49
    v_exp_f32 v52, v52
    v_exp_f32 v53, v53
    v_cvt_pk_bf16_f32 v29, v50, v51
    v_exp_f32 v54, v54
    v_mfma_f32_32x32x16_bf16 v[64:79], v[16:19], v[12:15], v[144:159]
    v_exp_f32 v55, v55
    ds_read_b128 v[16:19], v5 offset:1024
    v_cvt_pk_bf16_f32 v30, v52, v53
    v_exp_f32 v56, v56
    s_add_u32 m0, s82, 8192
    v_exp_f32 v57, v57
    s_add_u32 s78, s81, 2105344
    v_cvt_pk_bf16_f32 v31, v54, v55
    v_exp_f32 v58, v58
    buffer_load_dwordx4 v4, s[28:31], s78 offen sc1 lds
    v_exp_f32 v59, v59
    s_waitcnt lgkmcnt(2)
    v_cvt_pk_bf16_f32 v32, v56, v57
    v_exp_f32 v60, v60
    v_mfma_f32_32x32x16_bf16 v[80:95], v[20:23], v[28:31], v[80:95]
    v_exp_f32 v61, v61
    v_cvt_pk_bf16_f32 v33, v58, v59
    v_exp_f32 v62, v62
    v_exp_f32 v63, v63
    v_cvt_pk_bf16_f32 v34, v60, v61
    s_waitcnt lgkmcnt(1)
    v_cvt_pk_bf16_f32 v35, v62, v63
    s_add_u32 m0, s83, 73984
    s_add_u32 s78, s81, 4202496
    buffer_load_dwordx4 v4, s[28:31], s78 offen sc1 lds
    s_add_u32 m0, s82, 12288
    s_add_u32 s78, s81, 2109440
    buffer_load_dwordx4 v4, s[28:31], s78 offen sc1 lds
    v_exp_f32 v64, v64
    v_exp_f32 v65, v65
    v_mfma_f32_32x32x16_bf16 v[80:95], v[24:27], v[32:35], v[80:95]
    v_exp_f32 v66, v66
    v_exp_f32 v67, v67
    v_cvt_pk_bf16_f32 v112, v64, v65
    v_exp_f32 v68, v68
    v_exp_f32 v69, v69
    s_waitcnt lgkmcnt(0)
    v_cvt_pk_bf16_f32 v113, v66, v67
    v_exp_f32 v70, v70
    v_mfma_f32_32x32x16_bf16 v[48:63], v[16:19], v[8:11], v[96:111]
    v_exp_f32 v71, v71
    v_cvt_pk_bf16_f32 v114, v68, v69
    v_exp_f32 v72, v72
    s_add_u32 m0, s83, 78208
    v_exp_f32 v73, v73
    s_add_u32 s78, s81, 4206592
    v_cvt_pk_bf16_f32 v115, v70, v71
    v_exp_f32 v74, v74
    buffer_load_dwordx4 v4, s[28:31], s78 offen sc1 lds
    v_exp_f32 v75, v75
    v_cvt_pk_bf16_f32 v116, v72, v73
    v_exp_f32 v76, v76
    v_mfma_f32_32x32x16_bf16 v[128:143], v[20:23], v[112:115], v[128:143]
    v_exp_f32 v77, v77
    ds_read_b128 v[20:23], v46 offset:1056
    v_cvt_pk_bf16_f32 v117, v74, v75
    v_exp_f32 v78, v78
    v_exp_f32 v79, v79
    v_cvt_pk_bf16_f32 v118, v76, v77
    s_nop 0
    v_cvt_pk_bf16_f32 v119, v78, v79
    s_add_u32 m0, s82, 16384
    s_add_u32 s78, s81, 2113536
    buffer_load_dwordx4 v4, s[28:31], s78 offen sc1 lds
    s_add_u32 m0, s83, 82432
    s_add_u32 s78, s81, 4210688
    buffer_load_dwordx4 v4, s[28:31], s78 offen sc1 lds
    v_exp_f32 v48, v48
    v_exp_f32 v49, v49
    v_mfma_f32_32x32x16_bf16 v[128:143], v[24:27], v[116:119], v[128:143]
    v_exp_f32 v50, v50
    ds_read_b128 v[24:27], v47 offset:1056
    v_exp_f32 v51, v51
    v_cvt_pk_bf16_f32 v28, v48, v49
    v_exp_f32 v52, v52
    v_exp_f32 v53, v53
    v_cvt_pk_bf16_f32 v29, v50, v51
    v_exp_f32 v54, v54
    v_mfma_f32_32x32x16_bf16 v[64:79], v[16:19], v[12:15], v[144:159]
    v_exp_f32 v55, v55
    ds_read_b128 v[16:19], v5 offset:2048
    v_cvt_pk_bf16_f32 v30, v52, v53
    v_exp_f32 v56, v56
    s_add_u32 m0, s82, 20480
    v_exp_f32 v57, v57
    s_add_u32 s78, s81, 2117632
    v_cvt_pk_bf16_f32 v31, v54, v55
    v_exp_f32 v58, v58
    buffer_load_dwordx4 v4, s[28:31], s78 offen sc1 lds
    v_exp_f32 v59, v59
    s_waitcnt lgkmcnt(2)
    v_cvt_pk_bf16_f32 v32, v56, v57
    v_exp_f32 v60, v60
    v_mfma_f32_32x32x16_bf16 v[80:95], v[20:23], v[28:31], v[80:95]
    v_exp_f32 v61, v61
    v_cvt_pk_bf16_f32 v33, v58, v59
    v_exp_f32 v62, v62
    v_exp_f32 v63, v63
    v_cvt_pk_bf16_f32 v34, v60, v61
    s_waitcnt lgkmcnt(1)
    v_cvt_pk_bf16_f32 v35, v62, v63
    s_add_u32 m0, s83, 86656
    s_add_u32 s78, s81, 4214784
    buffer_load_dwordx4 v4, s[28:31], s78 offen sc1 lds
    s_add_u32 m0, s82, 24576
    s_add_u32 s78, s81, 2121728
    buffer_load_dwordx4 v4, s[28:31], s78 offen sc1 lds
    v_exp_f32 v64, v64
    v_exp_f32 v65, v65
    v_mfma_f32_32x32x16_bf16 v[80:95], v[24:27], v[32:35], v[80:95]
    v_exp_f32 v66, v66
    v_exp_f32 v67, v67
    v_cvt_pk_bf16_f32 v112, v64, v65
    v_exp_f32 v68, v68
    v_exp_f32 v69, v69
    s_waitcnt lgkmcnt(0)
    v_cvt_pk_bf16_f32 v113, v66, v67
    v_exp_f32 v70, v70
    v_mfma_f32_32x32x16_bf16 v[48:63], v[16:19], v[8:11], v[96:111]
    v_exp_f32 v71, v71
    v_cvt_pk_bf16_f32 v114, v68, v69
    v_exp_f32 v72, v72
    s_add_u32 m0, s83, 90880
    v_exp_f32 v73, v73
    s_add_u32 s78, s81, 4218880
    v_cvt_pk_bf16_f32 v115, v70, v71
    v_exp_f32 v74, v74
    buffer_load_dwordx4 v4, s[28:31], s78 offen sc1 lds
    v_exp_f32 v75, v75
    v_cvt_pk_bf16_f32 v116, v72, v73
    v_exp_f32 v76, v76
    v_mfma_f32_32x32x16_bf16 v[128:143], v[20:23], v[112:115], v[128:143]
    v_exp_f32 v77, v77
    ds_read_b128 v[20:23], v46 offset:2112
    v_cvt_pk_bf16_f32 v117, v74, v75
    v_exp_f32 v78, v78
    v_exp_f32 v79, v79
    v_cvt_pk_bf16_f32 v118, v76, v77
    s_nop 0
    v_cvt_pk_bf16_f32 v119, v78, v79
    s_add_u32 m0, s82, 28672
    s_add_u32 s78, s81, 2125824
    buffer_load_dwordx4 v4, s[28:31], s78 offen sc1 lds
    s_add_u32 m0, s83, 95104
    s_add_u32 s78, s81, 4222976
    buffer_load_dwordx4 v4, s[28:31], s78 offen sc1 lds
    v_exp_f32 v48, v48
    v_exp_f32 v49, v49
    v_mfma_f32_32x32x16_bf16 v[128:143], v[24:27], v[116:119], v[128:143]
    v_exp_f32 v50, v50
    ds_read_b128 v[24:27], v47 offset:2112
    v_exp_f32 v51, v51
    v_cvt_pk_bf16_f32 v28, v48, v49
    v_exp_f32 v52, v52
    v_exp_f32 v53, v53
    v_cvt_pk_bf16_f32 v29, v50, v51
    v_exp_f32 v54, v54
    v_mfma_f32_32x32x16_bf16 v[64:79], v[16:19], v[12:15], v[144:159]
    v_exp_f32 v55, v55
    ds_read_b128 v[16:19], v5 offset:3072
    v_cvt_pk_bf16_f32 v30, v52, v53
    v_exp_f32 v56, v56
    v_exp_f32 v57, v57
    v_cvt_pk_bf16_f32 v31, v54, v55
    v_exp_f32 v58, v58
    v_exp_f32 v59, v59
    s_waitcnt lgkmcnt(2)
    v_cvt_pk_bf16_f32 v32, v56, v57
    v_exp_f32 v60, v60
    v_mfma_f32_32x32x16_bf16 v[80:95], v[20:23], v[28:31], v[80:95]
    v_exp_f32 v61, v61
    v_cvt_pk_bf16_f32 v33, v58, v59
    v_exp_f32 v62, v62
    v_exp_f32 v63, v63
    v_cvt_pk_bf16_f32 v34, v60, v61
    s_waitcnt lgkmcnt(1)
    v_cvt_pk_bf16_f32 v35, v62, v63
    s_cmp_eq_u32 s80, 0
    s_cbranch_scc1 L_a_pr1
    s_setprio 0
L_a_pr1:
    v_exp_f32 v64, v64
    v_exp_f32 v65, v65
    v_mfma_f32_32x32x16_bf16 v[80:95], v[24:27], v[32:35], v[80:95]
    v_exp_f32 v66, v66
    v_exp_f32 v67, v67
    v_cvt_pk_bf16_f32 v112, v64, v65
    v_exp_f32 v68, v68
    v_exp_f32 v69, v69
    s_waitcnt lgkmcnt(0)
    v_cvt_pk_bf16_f32 v113, v66, v67
    v_exp_f32 v70, v70
    v_mfma_f32_32x32x16_bf16 v[48:63], v[16:19], v[8:11], v[96:111]
    v_exp_f32 v71, v71
    v_cvt_pk_bf16_f32 v114, v68, v69
    v_exp_f32 v72, v72
    v_exp_f32 v73, v73
    v_cvt_pk_bf16_f32 v115, v70, v71
    v_exp_f32 v74, v74
    v_exp_f32 v75, v75
    v_cvt_pk_bf16_f32 v116, v72, v73
    v_exp_f32 v76, v76
    v_mfma_f32_32x32x16_bf16 v[128:143], v[20:23], v[112:115], v[128:143]
    v_exp_f32 v77, v77
    ds_read_b128 v[20:23], v46 offset:3168
    v_cvt_pk_bf16_f32 v117, v74, v75
    v_exp_f32 v78, v78
    v_exp_f32 v79, v79
    v_cvt_pk_bf16_f32 v118, v76, v77
    s_nop 0
    v_cvt_pk_bf16_f32 v119, v78, v79
    s_waitcnt vmcnt(0)
    s_barrier
    s_cmp_eq_u32 s80, 0
    s_cbranch_scc1 L_a_pr2
    s_setprio 1
L_a_pr2:
    v_exp_f32 v48, v48
    v_exp_f32 v49, v49
    v_mfma_f32_32x32x16_bf16 v[128:143], v[24:27], v[116:119], v[128:143]
    v_exp_f32 v50, v50
    ds_read_b128 v[24:27], v47 offset:3168
    v_exp_f32 v51, v51
    v_cvt_pk_bf16_f32 v28, v48, v49
    v_exp_f32 v52, v52
    v_exp_f32 v53, v53
    v_cvt_pk_bf16_f32 v29, v50, v51
    v_exp_f32 v54, v54
    v_mfma_f32_32x32x16_bf16 v[64:79], v[16:19], v[12:15], v[144:159]
    v_exp_f32 v55, v55
    ds_read_b128 v[16:19], v5 offset:4096
    v_cvt_pk_bf16_f32 v30, v52, v53
    v_exp_f32 v56, v56
    v_exp_f32 v57, v57
    v_cvt_pk_bf16_f32 v31, v54, v55
    v_exp_f32 v58, v58
    v_exp_f32 v59, v59
    s_waitcnt lgkmcnt(2)
    v_cvt_pk_bf16_f32 v32, v56, v57
    v_exp_f32 v60, v60
    v_mfma_f32_32x32x16_bf16 v[80:95], v[20:23], v[28:31], v[80:95]
    v_exp_f32 v61, v61
    v_cvt_pk_bf16_f32 v33, v58, v59
    v_exp_f32 v62, v62
    v_exp_f32 v63, v63
    v_cvt_pk_bf16_f32 v34, v60, v61
    s_waitcnt lgkmcnt(1)
    v_cvt_pk_bf16_f32 v35, v62, v63
    v_exp_f32 v64, v64
    v_exp_f32 v65, v65
    v_mfma_f32_32x32x16_bf16 v[80:95], v[24:27], v[32:35], v[80:95]
    v_exp_f32 v66, v66
    v_exp_f32 v67, v67
    v_cvt_pk_bf16_f32 v112, v64, v65
    v_exp_f32 v68, v68
    v_exp_f32 v69, v69
    s_waitcnt lgkmcnt(0)
    v_cvt_pk_bf16_f32 v113, v66, v67
    v_exp_f32 v70, v70
    v_mfma_f32_32x32x16_bf16 v[48:63], v[16:19], v[8:11], v[96:111]
    v_exp_f32 v71, v71
    v_cvt_pk_bf16_f32 v114, v68, v69
    v_exp_f32 v72, v72
    v_exp_f32 v73, v73
    v_cvt_pk_bf16_f32 v115, v70, v71
    v_exp_f32 v74, v74
    v_exp_f32 v75, v75
    v_cvt_pk_bf16_f32 v116, v72, v73
    v_exp_f32 v76, v76
    v_mfma_f32_32x32x16_bf16 v[128:143], v[20:23], v[112:115], v[128:143]
    v_exp_f32 v77, v77
    ds_read_b128 v[20:23], v46 offset:4224
    v_cvt_pk_bf16_f32 v117, v74, v75
    v_exp_f32 v78, v78
    v_exp_f32 v79, v79
    v_cvt_pk_bf16_f32 v118, v76, v77
    s_nop 0
    v_cvt_pk_bf16_f32 v119, v78, v79
    v_add_u32 v5, 4096, v5
    v_add_u32 v46, 4224, v46
    v_add_u32 v47, 4224, v47
    s_mov_b32 s79, 0
    s_lshl_b32 s55, s2, 3
    s_add_u32 s55, s55, s27
    s_lshl_b32 s55, s55, 10
    s_mov_b32 s32, s12
    s_and_b32 s33, s13, 0xffff
    s_mov_b32 s34, 1835008
    s_mov_b32 s35, 0x20000
    buffer_load_dwordx4 v[120:123], v4, s[32:35], s55 offen
    s_mov_b32 s32, s16
    s_and_b32 s33, s17, 0xffff
    s_mov_b32 s34, 1835008
    s_mov_b32 s35, 0x20000
    buffer_load_dwordx4 v[120:123], v4, s[32:35], s55 offen
    s_mov_b32 s32, s8
    s_and_b32 s33, s9, 0xffff
    s_mov_b32 s34, 524288
    s_mov_b32 s35, 0x20000
    buffer_load_dwordx4 v[120:123], v4, s[32:35], s55 offen
    s_add_u32 s75, s77, s80
    s_lshl_b32 s75, s75, 5
    s_add_u32 s75, s75, s76
    s_lshl_b32 s75, s75, 10
    s_add_u32 s75, s75, 8388608
    s_cmp_ge_u32 s27, 4
    s_cbranch_scc1 L_a_ntouch
    v_and_b32 v124, 15, v1
    v_lshlrev_b32 v124, 7, v124
    buffer_load_dword v126, v124, s[28:31], s58 offen
    v_and_b32 v124, 31, v1
    v_lshlrev_b32 v124, 7, v124
    v_lshrrev_b32 v125, 5, v1
    v_mul_u32_u24 v125, 114688, v125
    v_add_u32 v124, v124, v125
    buffer_load_dword v126, v124, s[28:31], s59 offen
L_a_ntouch:
L_a_loop:
    s_cmp_lg_u32 s79, 6
    s_cbranch_scc1 L_a_prl
    s_setprio 0
L_a_prl:
    v_exp_f32 v48, v48
    v_exp_f32 v49, v49
    v_mfma_f32_32x32x16_bf16 v[128:143], v[24:27], v[116:119], v[128:143]
    v_exp_f32 v50, v50
    ds_read_b128 v[24:27], v47 offset:0
    v_exp_f32 v51, v51
    v_cvt_pk_bf16_f32 v28, v48, v49
    v_exp_f32 v52, v52
    v_exp_f32 v53, v53
    v_cvt_pk_bf16_f32 v29, v50, v51
    v_exp_f32 v54, v54
    v_mfma_f32_32x32x16_bf16 v[64:79], v[16:19], v[12:15], v[144:159]
    v_exp_f32 v55, v55
    ds_read_b128 v[16:19], v5 offset:1024
    v_cvt_pk_bf16_f32 v30, v52, v53
    v_exp_f32 v56, v56
    v_exp_f32 v57, v57
    v_cvt_pk_bf16_f32 v31, v54, v55
    v_exp_f32 v58, v58
    v_exp_f32 v59, v59
    s_waitcnt lgkmcnt(2)
    v_cvt_pk_bf16_f32 v32, v56, v57
    v_exp_f32 v60, v60
    v_mfma_f32_32x32x16_bf16 v[80:95], v[20:23], v[28:31], v[80:95]
    v_exp_f32 v61, v61
    v_cvt_pk_bf16_f32 v33, v58, v59
    v_exp_f32 v62, v62
    v_exp_f32 v63, v63
    v_cvt_pk_bf16_f32 v34, v60, v61
    s_waitcnt lgkmcnt(1)
    v_cvt_pk_bf16_f32 v35, v62, v63
    v_exp_f32 v64, v64
    v_exp_f32 v65, v65
    v_mfma_f32_32x32x16_bf16 v[80:95], v[24:27], v[32:35], v[80:95]
    v_exp_f32 v66, v66
    v_exp_f32 v67, v67
    v_cvt_pk_bf16_f32 v112, v64, v65
    v_exp_f32 v68, v68
    v_exp_f32 v69, v69
    s_waitcnt lgkmcnt(0)
    v_cvt_pk_bf16_f32 v113, v66, v67
    v_exp_f32 v70, v70
    v_mfma_f32_32x32x16_bf16 v[48:63], v[16:19], v[8:11], v[96:111]
    v_exp_f32 v71, v71
    v_cvt_pk_bf16_f32 v114, v68, v69
    v_exp_f32 v72, v72
    v_exp_f32 v73, v73
    v_cvt_pk_bf16_f32 v115, v70, v71
    v_exp_f32 v74, v74
    v_exp_f32 v75, v75
    v_cvt_pk_bf16_f32 v116, v72, v73
    v_exp_f32 v76, v76
    v_mfma_f32_32x32x16_bf16 v[128:143], v[20:23], v[112:115], v[128:143]
    v_exp_f32 v77, v77
    ds_read_b128 v[20:23], v46 offset:1056
    v_cvt_pk_bf16_f32 v117, v74, v75
    v_exp_f32 v78, v78
    v_exp_f32 v79, v79
    v_cvt_pk_bf16_f32 v118, v76, v77
    s_nop 0
    v_cvt_pk_bf16_f32 v119, v78, v79
    v_exp_f32 v48, v48
    v_exp_f32 v49, v49
    v_mfma_f32_32x32x16_bf16 v[128:143], v[24:27], v[116:119], v[128:143]
    v_exp_f32 v50, v50
    ds_read_b128 v[24:27], v47 offset:1056
    v_exp_f32 v51, v51
    v_cvt_pk_bf16_f32 v28, v48, v49
    v_exp_f32 v52, v52
    v_exp_f32 v53, v53
    v_cvt_pk_bf16_f32 v29, v50, v51
    v_exp_f32 v54, v54
    v_mfma_f32_32x32x16_bf16 v[64:79], v[16:19], v[12:15], v[144:159]
    v_exp_f32 v55, v55
    ds_read_b128 v[16:19], v5 offset:2048
    v_cvt_pk_bf16_f32 v30, v52, v53
    v_exp_f32 v56, v56
    v_exp_f32 v57, v57
    v_cvt_pk_bf16_f32 v31, v54, v55
    v_exp_f32 v58, v58
    v_exp_f32 v59, v59
    s_waitcnt lgkmcnt(2)
    v_cvt_pk_bf16_f32 v32, v56, v57
    v_exp_f32 v60, v60
    v_mfma_f32_32x32x16_bf16 v[80:95], v[20:23], v[28:31], v[80:95]
    v_exp_f32 v61, v61
    v_cvt_pk_bf16_f32 v33, v58, v59
    v_exp_f32 v62, v62
    v_exp_f32 v63, v63
    v_cvt_pk_bf16_f32 v34, v60, v61
    s_waitcnt lgkmcnt(1)
    v_cvt_pk_bf16_f32 v35, v62, v63
    v_exp_f32 v64, v64
    v_exp_f32 v65, v65
    v_mfma_f32_32x32x16_bf16 v[80:95], v[24:27], v[32:35], v[80:95]
    v_exp_f32 v66, v66
    v_exp_f32 v67, v67
    v_cvt_pk_bf16_f32 v112, v64, v65
    v_exp_f32 v68, v68
    v_exp_f32 v69, v69
    s_waitcnt lgkmcnt(0)
    v_cvt_pk_bf16_f32 v113, v66, v67
    v_exp_f32 v70, v70
    v_mfma_f32_32x32x16_bf16 v[48:63], v[16:19], v[8:11], v[96:111]
    v_exp_f32 v71, v71
    v_cvt_pk_bf16_f32 v114, v68, v69
    v_exp_f32 v72, v72
    v_exp_f32 v73, v73
    v_cvt_pk_bf16_f32 v115, v70, v71
    v_exp_f32 v74, v74
    v_exp_f32 v75, v75
    v_cvt_pk_bf16_f32 v116, v72, v73
    v_exp_f32 v76, v76
    v_mfma_f32_32x32x16_bf16 v[128:143], v[20:23], v[112:115], v[128:143]
    v_exp_f32 v77, v77
    ds_read_b128 v[20:23], v46 offset:2112
    v_cvt_pk_bf16_f32 v117, v74, v75
    v_exp_f32 v78, v78
    v_exp_f32 v79, v79
    v_cvt_pk_bf16_f32 v118, v76, v77
    s_nop 0
    v_cvt_pk_bf16_f32 v119, v78, v79
    v_exp_f32 v48, v48
    v_exp_f32 v49, v49
    v_mfma_f32_32x32x16_bf16 v[128:143], v[24:27], v[116:119], v[128:143]
    v_exp_f32 v50, v50
    ds_read_b128 v[24:27], v47 offset:2112
    v_exp_f32 v51, v51
    v_cvt_pk_bf16_f32 v28, v48, v49
    v_exp_f32 v52, v52
    v_exp_f32 v53, v53
    v_cvt_pk_bf16_f32 v29, v50, v51
    v_exp_f32 v54, v54
    v_mfma_f32_32x32x16_bf16 v[64:79], v[16:19], v[12:15], v[144:159]
    v_exp_f32 v55, v55
    ds_read_b128 v[16:19], v5 offset:3072
    v_cvt_pk_bf16_f32 v30, v52, v53
    v_exp_f32 v56, v56
    v_exp_f32 v57, v57
    v_cvt_pk_bf16_f32 v31, v54, v55
    v_exp_f32 v58, v58
    v_exp_f32 v59, v59
    s_waitcnt lgkmcnt(2)
    v_cvt_pk_bf16_f32 v32, v56, v57
    v_exp_f32 v60, v60
    v_mfma_f32_32x32x16_bf16 v[80:95], v[20:23], v[28:31], v[80:95]
    v_exp_f32 v61, v61
    v_cvt_pk_bf16_f32 v33, v58, v59
    v_exp_f32 v62, v62
    v_exp_f32 v63, v63
    v_cvt_pk_bf16_f32 v34, v60, v61
    s_waitcnt lgkmcnt(1)
    v_cvt_pk_bf16_f32 v35, v62, v63
    v_exp_f32 v64, v64
    v_exp_f32 v65, v65
    v_mfma_f32_32x32x16_bf16 v[80:95], v[24:27], v[32:35], v[80:95]
    v_exp_f32 v66, v66
    v_exp_f32 v67, v67
    v_cvt_pk_bf16_f32 v112, v64, v65
    v_exp_f32 v68, v68
    v_exp_f32 v69, v69
    s_waitcnt lgkmcnt(0)
    v_cvt_pk_bf16_f32 v113, v66, v67
    v_exp_f32 v70, v70
    v_mfma_f32_32x32x16_bf16 v[48:63], v[16:19], v[8:11], v[96:111]
    v_exp_f32 v71, v71
    v_cvt_pk_bf16_f32 v114, v68, v69
    v_exp_f32 v72, v72
    v_exp_f32 v73, v73
    v_cvt_pk_bf16_f32 v115, v70, v71
    v_exp_f32 v74, v74
    v_exp_f32 v75, v75
    v_cvt_pk_bf16_f32 v116, v72, v73
    v_exp_f32 v76, v76
    v_mfma_f32_32x32x16_bf16 v[128:143], v[20:23], v[112:115], v[128:143]
    v_exp_f32 v77, v77
    ds_read_b128 v[20:23], v46 offset:3168
    v_cvt_pk_bf16_f32 v117, v74, v75
    v_exp_f32 v78, v78
    v_exp_f32 v79, v79
    v_cvt_pk_bf16_f32 v118, v76, v77
    s_nop 0
    v_cvt_pk_bf16_f32 v119, v78, v79
    v_exp_f32 v48, v48
    v_exp_f32 v49, v49
    v_mfma_f32_32x32x16_bf16 v[128:143], v[24:27], v[116:119], v[128:143]
    v_exp_f32 v50, v50
    ds_read_b128 v[24:27], v47 offset:3168
    v_exp_f32 v51, v51
    v_cvt_pk_bf16_f32 v28, v48, v49
    v_exp_f32 v52, v52
    v_exp_f32 v53, v53
    v_cvt_pk_bf16_f32 v29, v50, v51
    v_exp_f32 v54, v54
    v_mfma_f32_32x32x16_bf16 v[64:79], v[16:19], v[12:15], v[144:159]
    v_exp_f32 v55, v55
    ds_read_b128 v[16:19], v5 offset:4096
    v_cvt_pk_bf16_f32 v30, v52, v53
    v_exp_f32 v56, v56
    v_exp_f32 v57, v57
    v_cvt_pk_bf16_f32 v31, v54, v55
    v_exp_f32 v58, v58
    v_exp_f32 v59, v59
    s_waitcnt lgkmcnt(2)
    v_cvt_pk_bf16_f32 v32, v56, v57
    v_exp_f32 v60, v60
    v_mfma_f32_32x32x16_bf16 v[80:95], v[20:23], v[28:31], v[80:95]
    v_exp_f32 v61, v61
    v_cvt_pk_bf16_f32 v33, v58, v59
    v_exp_f32 v62, v62
    v_exp_f32 v63, v63
    v_cvt_pk_bf16_f32 v34, v60, v61
    s_waitcnt lgkmcnt(1)
    v_cvt_pk_bf16_f32 v35, v62, v63
    v_exp_f32 v64, v64
    v_exp_f32 v65, v65
    v_mfma_f32_32x32x16_bf16 v[80:95], v[24:27], v[32:35], v[80:95]
    v_exp_f32 v66, v66
    v_exp_f32 v67, v67
    v_cvt_pk_bf16_f32 v112, v64, v65
    v_exp_f32 v68, v68
    v_exp_f32 v69, v69
    s_waitcnt lgkmcnt(0)
    v_cvt_pk_bf16_f32 v113, v66, v67
    v_exp_f32 v70, v70
    v_mfma_f32_32x32x16_bf16 v[48:63], v[16:19], v[8:11], v[96:111]
    v_exp_f32 v71, v71
    v_cvt_pk_bf16_f32 v114, v68, v69
    v_exp_f32 v72, v72
    v_exp_f32 v73, v73
    v_cvt_pk_bf16_f32 v115, v70, v71
    v_exp_f32 v74, v74
    v_exp_f32 v75, v75
    v_cvt_pk_bf16_f32 v116, v72, v73
    v_exp_f32 v76, v76
    v_mfma_f32_32x32x16_bf16 v[128:143], v[20:23], v[112:115], v[128:143]
    v_exp_f32 v77, v77
    ds_read_b128 v[20:23], v46 offset:4224
    v_cvt_pk_bf16_f32 v117, v74, v75
    v_exp_f32 v78, v78
    v_exp_f32 v79, v79
    v_cvt_pk_bf16_f32 v118, v76, v77
    s_nop 0
    v_cvt_pk_bf16_f32 v119, v78, v79
    v_add_u32 v5, 4096, v5
    v_add_u32 v46, 4224, v46
    v_add_u32 v47, 4224, v47
    s_add_u32 s79, s79, 1
    s_cmp_lt_u32 s79, 7
    s_cbranch_scc1 L_a_loop
    v_mfma_f32_32x32x16_bf16 v[128:143], v[24:27], v[116:119], v[128:143]
    s_mul_i32 s55, s27, 3072
    s_add_u32 s55, s55, 136192
    s_xor_b32 s56, s27, 4
    s_mul_i32 s56, s56, 3072
    s_add_u32 s56, s56, 136192
    v_add_u32 v6, s55, v4
    v_add_u32 v7, s56, v4
    s_waitcnt lgkmcnt(0)
    s_nop 7
    s_cmp_lg_u32 s80, 0
    s_cbranch_scc1 L_a_x1
    ds_write_b128 v6, v[128:131] offset:0
    ds_write_b128 v6, v[132:135] offset:1024
    ds_write_b128 v6, v[136:139] offset:2048
    s_branch L_a_x2
L_a_x1:
    ds_write_b128 v6, v[80:83] offset:0
    ds_write_b128 v6, v[84:87] offset:1024
    ds_write_b128 v6, v[88:91] offset:2048
    s_nop 1
    v_mov_b32 v80, v128
    v_mov_b32 v81, v129
    v_mov_b32 v82, v130
    v_mov_b32 v83, v131
    v_mov_b32 v84, v132
    v_mov_b32 v85, v133
    v_mov_b32 v86, v134
    v_mov_b32 v87, v135
    v_mov_b32 v88, v136
    v_mov_b32 v8, v12
    v_mov_b32 v9, v13
    v_mov_b32 v10, v14
    v_mov_b32 v11, v15
L_a_x2:
    s_waitcnt lgkmcnt(0)
    s_barrier
    ds_read_b128 v[48:51], v7 offset:0
    ds_read_b128 v[52:55], v7 offset:1024
    ds_read_b128 v[56:59], v7 offset:2048
    s_waitcnt lgkmcnt(0)
    v_add_f32 v80, v80, v48
    v_add_f32 v81, v81, v49
    v_add_f32 v82, v82, v50
    v_add_f32 v83, v83, v51
    v_add_f32 v84, v84, v52
    v_add_f32 v85, v85, v53
    v_add_f32 v86, v86, v54
    v_add_f32 v87, v87, v55
    v_add_f32 v88, v88, v56
    v_cmp_nle_f32 vcc, 0x1f800000, v88
    s_cbranch_vccnz L_a_fallback
    v_mov_b32 v7, 0x7f000000
    v_cmp_nlt_f32 vcc, v88, v7
    s_cbranch_vccz L_a_out
L_a_fallback:
    v_mov_b32 v96, 0
    v_mov_b32 v97, 0
    v_mov_b32 v98, 0
    v_mov_b32 v99, 0
    v_mov_b32 v100, 0
    v_mov_b32 v101, 0
    v_mov_b32 v102, 0
    v_mov_b32 v103, 0
    v_mov_b32 v104, 0
    v_mov_b32 v105, 0
    v_mov_b32 v106, 0
    v_mov_b32 v107, 0
    v_mov_b32 v108, 0
    v_mov_b32 v109, 0
    v_mov_b32 v110, 0
    v_mov_b32 v111, 0
    v_mov_b32 v6, 0xff7fffff
    v_mov_b32 v5, v4
    s_mov_b32 s79, 0
L_a_fb1:
    ds_read_b128 v[16:19], v5
    s_waitcnt lgkmcnt(0)
    v_mfma_f32_32x32x16_bf16 v[48:63], v[16:19], v[8:11], v[96:111]
    s_nop 15
    s_nop 3
    v_max3_f32 v6, v6, v48, v49
    v_max3_f32 v6, v6, v50, v51
    v_max3_f32 v6, v6, v52, v53
    v_max3_f32 v6, v6, v54, v55
    v_max3_f32 v6, v6, v56, v57
    v_max3_f32 v6, v6, v58, v59
    v_max3_f32 v6, v6, v60, v61
    v_max3_f32 v6, v6, v62, v63
    v_add_u32 v5, 1024, v5
    s_add_u32 s79, s79, 1
    s_cmp_lt_u32 s79, 64
    s_cbranch_scc1 L_a_fb1
    v_mov_b32 v7, v6
    s_nop 1
    v_permlane32_swap_b32 v6, v7
    s_nop 1
    v_max_f32 v6, v6, v7
    v_sub_f32 v6, 0, v6
    v_mov_b32 v96, v6
    v_mov_b32 v80, 0
    v_mov_b32 v97, v6
    v_mov_b32 v81, 0
    v_mov_b32 v98, v6
    v_mov_b32 v82, 0
    v_mov_b32 v99, v6
    v_mov_b32 v83, 0
    v_mov_b32 v100, v6
    v_mov_b32 v84, 0
    v_mov_b32 v101, v6
    v_mov_b32 v85, 0
    v_mov_b32 v102, v6
    v_mov_b32 v86, 0
    v_mov_b32 v103, v6
    v_mov_b32 v87, 0
    v_mov_b32 v104, v6
    v_mov_b32 v88, 0
    v_mov_b32 v105, v6
    v_mov_b32 v89, 0
    v_mov_b32 v106, v6
    v_mov_b32 v90, 0
    v_mov_b32 v107, v6
    v_mov_b32 v91, 0
    v_mov_b32 v108, v6
    v_mov_b32 v92, 0
    v_mov_b32 v109, v6
    v_mov_b32 v93, 0
    v_mov_b32 v110, v6
    v_mov_b32 v94, 0
    v_mov_b32 v111, v6
    v_mov_b32 v95, 0
    v_mov_b32 v5, v4
    v_mov_b32 v46, v44
    v_mov_b32 v47, v45
    s_mov_b32 s79, 0
L_a_fb2:
    ds_read_b128 v[16:19], v5
    ds_read_b128 v[20:23], v46
    ds_read_b128 v[24:27], v47
    s_waitcnt lgkmcnt(0)
    v_mfma_f32_32x32x16_bf16 v[48:63], v[16:19], v[8:11], v[96:111]
    s_nop 15
    s_nop 3
    v_exp_f32 v48, v48
    v_exp_f32 v49, v49
    v_exp_f32 v50, v50
    v_exp_f32 v51, v51
    v_exp_f32 v52, v52
    v_exp_f32 v53, v53
    v_exp_f32 v54, v54
    v_exp_f32 v55, v55
    v_exp_f32 v56, v56
    v_exp_f32 v57, v57
    v_exp_f32 v58, v58
    v_exp_f32 v59, v59
    v_exp_f32 v60, v60
    v_exp_f32 v61, v61
    v_exp_f32 v62, v62
    v_exp_f32 v63, v63
    s_nop 0
    v_cvt_pk_bf16_f32 v28, v48, v49
    v_cvt_pk_bf16_f32 v29, v50, v51
    v_cvt_pk_bf16_f32 v30, v52, v53
    v_cvt_pk_bf16_f32 v31, v54, v55
    v_cvt_pk_bf16_f32 v32, v56, v57
    v_cvt_pk_bf16_f32 v33, v58, v59
    v_cvt_pk_bf16_f32 v34, v60, v61
    v_cvt_pk_bf16_f32 v35, v62, v63
    s_nop 1
    v_mfma_f32_32x32x16_bf16 v[80:95], v[20:23], v[28:31], v[80:95]
    v_mfma_f32_32x32x16_bf16 v[80:95], v[24:27], v[32:35], v[80:95]
    v_add_u32 v5, 1024, v5
    v_add_u32 v46, 1056, v46
    v_add_u32 v47, 1056, v47
    s_add_u32 s79, s79, 1
    s_cmp_lt_u32 s79, 64
    s_cbranch_scc1 L_a_fb2
    s_nop 15
    s_nop 3
L_a_out:
    v_rcp_f32 v6, v88
    s_nop 0
    v_mul_f32 v80, v80, v6
    v_mul_f32 v81, v81, v6
    v_mul_f32 v82, v82, v6
    v_mul_f32 v83, v83, v6
    v_mul_f32 v84, v84, v6
    v_mul_f32 v85, v85, v6
    v_mul_f32 v86, v86, v6
    v_mul_f32 v87, v87, v6
    v_cvt_pk_bf16_f32 v28, v80, v81
    v_cvt_pk_bf16_f32 v29, v82, v83
    v_cvt_pk_bf16_f32 v30, v84, v85
    v_cvt_pk_bf16_f32 v31, v86, v87
    buffer_store_dwordx4 v[28:31], v4, s[28:31], s75 offen sc1
    s_barrier
    s_cmp_ge_u32 s27, 4
    s_cbranch_scc1 L_t_loader
    s_waitcnt vmcnt(0)
    v_mov_b32 v228, 163776
    v_mov_b32 v229, 1
    s_mov_b64 exec, 1
    ds_add_rtn_u32 v229, v228, v229
    s_waitcnt lgkmcnt(0)
    v_readfirstlane_b32 s56, v229
    s_mov_b64 exec, -1
    s_cmp_lg_u32 s56, 7
    s_cbranch_scc1 L_h2a_np
    s_lshr_b32 s55, s2, 5
    s_lshl_b32 s55, s55, 13
    s_add_u32 s55, s55, 6422528
    s_lshl_b32 s56, s76, 5
    s_add_u32 s55, s55, s56
    v_mov_b32 v228, 0
    v_mov_b32 v229, s11
    s_mov_b64 exec, 1
    buffer_store_dword v229, v228, s[28:31], s55 offen sc1
    s_mov_b64 exec, -1
L_h2a_np:
    s_mov_b32 s40, s14
    s_and_b32 s41, s15, 0xffff
    s_mov_b32 s42, 3584
    s_mov_b32 s43, 0x20000
    v_lshlrev_b32 v15, 3, v3
    v_lshlrev_b32 v14, 4, v3
    s_lshl_b32 s55, s48, 8
    s_lshl_b32 s56, s46, 7
    s_add_u32 s55, s55, s56
    s_lshl_b32 s56, s55, 1
    s_add_u32 s56, s56, 6324224
    buffer_load_dwordx2 v[192:193], v15, s[40:43], s55 offen offset:0
    buffer_load_dwordx2 v[194:195], v15, s[40:43], s55 offen offset:16
    buffer_load_dwordx2 v[196:197], v15, s[40:43], s55 offen offset:32
    buffer_load_dwordx2 v[198:199], v15, s[40:43], s55 offen offset:48
    buffer_load_dwordx2 v[200:201], v15, s[40:43], s55 offen offset:64
    buffer_load_dwordx2 v[202:203], v15, s[40:43], s55 offen offset:80
    buffer_load_dwordx2 v[204:205], v15, s[40:43], s55 offen offset:96
    buffer_load_dwordx2 v[206:207], v15, s[40:43], s55 offen offset:112
    s_lshl_b32 s55, s49, 6
    s_lshl_b32 s56, s45, 5
    s_add_u32 s55, s55, s56
    v_add_u32 v12, s55, v2
    v_lshlrev_b32 v12, 10, v12
    v_lshlrev_b32 v13, 3, v3
    s_lshl_b32 s55, s50, 7
    s_lshl_b32 s56, s46, 6
    s_add_u32 s55, s55, s56
    v_add_u32 v13, s55, v13
    v_add_u32 v231, v12, v13
    s_mov_b32 s36, s4
    s_and_b32 s37, s5, 0xffff
    s_mov_b32 s38, 2097152
    s_mov_b32 s39, 0x20000
    buffer_load_dwordx2 v[16:17], v231, s[36:39], 0 offen offset:0
    buffer_load_dwordx2 v[18:19], v231, s[36:39], 0 offen offset:16
    buffer_load_dwordx2 v[20:21], v231, s[36:39], 0 offen offset:32
    buffer_load_dwordx2 v[22:23], v231, s[36:39], 0 offen offset:48
    s_lshl_b32 s55, s45, 12
    s_add_u32 s55, s55, 106496
    v_add_u32 v6, s55, v4
    v_and_b32 v12, 15, v1
    v_lshrrev_b32 v13, 2, v12
    v_lshl_add_u32 v13, v3, 2, v13
    v_lshlrev_b32 v13, 7, v13
    v_lshrrev_b32 v14, 3, v12
    v_xor_b32 v14, s46, v14
    v_lshl_add_u32 v13, v14, 6, v13
    v_bfe_u32 v14, v1, 4, 1
    v_lshl_add_u32 v13, v14, 5, v13
    v_and_b32 v14, 3, v12
    v_lshl_add_u32 v7, v14, 3, v13
    v_add_u32 v8, 65536, v7
    v_mov_b32 v96, 0
    v_mov_b32 v97, 0
    v_mov_b32 v98, 0
    v_mov_b32 v99, 0
    v_mov_b32 v100, 0
    v_mov_b32 v101, 0
    v_mov_b32 v102, 0
    v_mov_b32 v103, 0
    v_mov_b32 v104, 0
    v_mov_b32 v105, 0
    v_mov_b32 v106, 0
    v_mov_b32 v107, 0
    v_mov_b32 v108, 0
    v_mov_b32 v109, 0
    v_mov_b32 v110, 0
    v_mov_b32 v111, 0
    s_lshl_b32 s53, s50, 1
    s_add_u32 s53, s53, s46
    s_lshl_b32 s53, s53, 11
    s_lshl_b32 s56, s49, 6
    s_add_u32 s53, s53, s56
    s_lshl_b32 s56, s45, 5
    s_add_u32 s53, s53, s56
    s_lshl_b32 s53, s53, 3
    s_add_u32 s53, s53, 7340032
    v_lshlrev_b32 v15, 3, v2
    v_lshl_add_u32 v15, v3, 2, v15
    s_waitcnt vmcnt(0)
    v_lshlrev_b32 v96, 16, v16
    v_and_b32 v97, 0xffff0000, v16
    v_lshlrev_b32 v98, 16, v17
    v_and_b32 v99, 0xffff0000, v17
    v_lshlrev_b32 v100, 16, v18
    v_and_b32 v101, 0xffff0000, v18
    v_lshlrev_b32 v102, 16, v19
    v_and_b32 v103, 0xffff0000, v19
    v_lshlrev_b32 v104, 16, v20
    v_and_b32 v105, 0xffff0000, v20
    v_lshlrev_b32 v106, 16, v21
    v_and_b32 v107, 0xffff0000, v21
    v_lshlrev_b32 v108, 16, v22
    v_and_b32 v109, 0xffff0000, v22
    v_lshlrev_b32 v110, 16, v23
    v_and_b32 v111, 0xffff0000, v23
    s_cmp_lg_u32 s44, 0
    s_cbranch_scc1 L_h2b_x
    s_and_b32 s55, s2, 7
    s_lshl_b32 s55, s55, 13
    s_add_u32 s55, s55, 6422528
    v_min_u32 v228, 31, v1
    v_lshlrev_b32 v228, 5, v228
    s_mov_b32 s26, 0
L_h2b_p:
    buffer_load_dword v229, v228, s[28:31], s55 offen sc1
    s_add_u32 s26, s26, 1
    s_cmp_ge_u32 s26, 0x100000
    s_cbranch_scc1 L_h2b_x
    s_waitcnt vmcnt(0)
    v_cmp_ne_u32 vcc, s10, v229
    s_cbranch_vccz L_h2b_x
    s_sleep 1
    s_branch L_h2b_p
L_h2b_x:
    s_barrier
    s_cmp_ge_u32 s2, 8
    s_cbranch_scc1 L_t_ngen
    s_cmp_lg_u32 s44, 2
    s_cbranch_scc1 L_t_ngen
    s_lshl_b32 s55, s2, 13
    s_add_u32 s55, s55, 6357504
    v_mov_b32 v228, 0
    v_mov_b32 v229, s10
    s_mov_b64 exec, 1
    buffer_store_dword v229, v228, s[28:31], s55 offen sc1
    s_mov_b64 exec, -1
L_t_ngen:
    s_barrier
    ds_read_b128 v[32:35], v6 offset:0
    ds_read_b64_tr_b16 v[64:65], v7 offset:0
    ds_read_b64_tr_b16 v[66:67], v7 offset:1024
    ds_read_b128 v[36:39], v6 offset:1024
    ds_read_b64_tr_b16 v[68:69], v7 offset:2048
    ds_read_b64_tr_b16 v[70:71], v7 offset:3072
    ds_read_b128 v[40:43], v6 offset:2048
    ds_read_b64_tr_b16 v[72:73], v7 offset:4096
    ds_read_b64_tr_b16 v[74:75], v7 offset:5120
    ds_read_b128 v[44:47], v6 offset:3072
    ds_read_b64_tr_b16 v[76:77], v7 offset:6144
    ds_read_b64_tr_b16 v[78:79], v7 offset:7168
    s_waitcnt lgkmcnt(0)
    s_barrier
    v_mfma_f32_32x32x16_bf16 v[96:111], v[64:67], v[32:35], v[96:111]
    ds_read_b128 v[48:51], v6 offset:8192
    ds_read_b64_tr_b16 v[80:81], v7 offset:8192
    ds_read_b64_tr_b16 v[82:83], v7 offset:9216
    ds_read_b128 v[52:55], v6 offset:9216
    ds_read_b64_tr_b16 v[84:85], v7 offset:10240
    ds_read_b64_tr_b16 v[86:87], v7 offset:11264
    v_mfma_f32_32x32x16_bf16 v[96:111], v[68:71], v[36:39], v[96:111]
    ds_read_b128 v[56:59], v6 offset:10240
    ds_read_b64_tr_b16 v[88:89], v7 offset:12288
    ds_read_b64_tr_b16 v[90:91], v7 offset:13312
    ds_read_b128 v[60:63], v6 offset:11264
    ds_read_b64_tr_b16 v[92:93], v7 offset:14336
    ds_read_b64_tr_b16 v[94:95], v7 offset:15360
    v_mfma_f32_32x32x16_bf16 v[96:111], v[72:75], v[40:43], v[96:111]
    v_mfma_f32_32x32x16_bf16 v[96:111], v[76:79], v[44:47], v[96:111]
    s_waitcnt lgkmcnt(0)
    s_barrier
    v_mfma_f32_32x32x16_bf16 v[96:111], v[80:83], v[48:51], v[96:111]
    ds_read_b128 v[32:35], v6 offset:16384
    ds_read_b64_tr_b16 v[64:65], v7 offset:16384
    ds_read_b64_tr_b16 v[66:67], v7 offset:17408
    ds_read_b128 v[36:39], v6 offset:17408
    ds_read_b64_tr_b16 v[68:69], v7 offset:18432
    ds_read_b64_tr_b16 v[70:71], v7 offset:19456
    v_mfma_f32_32x32x16_bf16 v[96:111], v[84:87], v[52:55], v[96:111]
    ds_read_b128 v[40:43], v6 offset:18432
    ds_read_b64_tr_b16 v[72:73], v7 offset:20480
    ds_read_b64_tr_b16 v[74:75], v7 offset:21504
    ds_read_b128 v[44:47], v6 offset:19456
    ds_read_b64_tr_b16 v[76:77], v7 offset:22528
    ds_read_b64_tr_b16 v[78:79], v7 offset:23552
    v_mfma_f32_32x32x16_bf16 v[96:111], v[88:91], v[56:59], v[96:111]
    v_mfma_f32_32x32x16_bf16 v[96:111], v[92:95], v[60:63], v[96:111]
    s_waitcnt lgkmcnt(0)
    s_barrier
    v_mfma_f32_32x32x16_bf16 v[96:111], v[64:67], v[32:35], v[96:111]
    ds_read_b128 v[48:51], v6 offset:24576
    ds_read_b64_tr_b16 v[80:81], v7 offset:24576
    ds_read_b64_tr_b16 v[82:83], v7 offset:25600
    ds_read_b128 v[52:55], v6 offset:25600
    ds_read_b64_tr_b16 v[84:85], v7 offset:26624
    ds_read_b64_tr_b16 v[86:87], v7 offset:27648
    v_mfma_f32_32x32x16_bf16 v[96:111], v[68:71], v[36:39], v[96:111]
    ds_read_b128 v[56:59], v6 offset:26624
    ds_read_b64_tr_b16 v[88:89], v7 offset:28672
    ds_read_b64_tr_b16 v[90:91], v7 offset:29696
    ds_read_b128 v[60:63], v6 offset:27648
    ds_read_b64_tr_b16 v[92:93], v7 offset:30720
    ds_read_b64_tr_b16 v[94:95], v7 offset:31744
    v_mfma_f32_32x32x16_bf16 v[96:111], v[72:75], v[40:43], v[96:111]
    v_mfma_f32_32x32x16_bf16 v[96:111], v[76:79], v[44:47], v[96:111]
    s_waitcnt lgkmcnt(0)
    s_barrier
    v_mfma_f32_32x32x16_bf16 v[96:111], v[80:83], v[48:51], v[96:111]
    ds_read_b128 v[32:35], v6 offset:32768
    ds_read_b64_tr_b16 v[64:65], v7 offset:32768
    ds_read_b64_tr_b16 v[66:67], v7 offset:33792
    ds_read_b128 v[36:39], v6 offset:33792
    ds_read_b64_tr_b16 v[68:69], v7 offset:34816
    ds_read_b64_tr_b16 v[70:71], v7 offset:35840
    v_mfma_f32_32x32x16_bf16 v[96:111], v[84:87], v[52:55], v[96:111]
    ds_read_b128 v[40:43], v6 offset:34816
    ds_read_b64_tr_b16 v[72:73], v7 offset:36864
    ds_read_b64_tr_b16 v[74:75], v7 offset:37888
    ds_read_b128 v[44:47], v6 offset:35840
    ds_read_b64_tr_b16 v[76:77], v7 offset:38912
    ds_read_b64_tr_b16 v[78:79], v7 offset:39936
    v_mfma_f32_32x32x16_bf16 v[96:111], v[88:91], v[56:59], v[96:111]
    v_mfma_f32_32x32x16_bf16 v[96:111], v[92:95], v[60:63], v[96:111]
    s_waitcnt lgkmcnt(0)
    s_barrier
    v_mfma_f32_32x32x16_bf16 v[96:111], v[64:67], v[32:35], v[96:111]
    ds_read_b128 v[48:51], v6 offset:40960
    ds_read_b64_tr_b16 v[80:81], v7 offset:40960
    ds_read_b64_tr_b16 v[82:83], v7 offset:41984
    ds_read_b128 v[52:55], v6 offset:41984
    ds_read_b64_tr_b16 v[84:85], v7 offset:43008
    ds_read_b64_tr_b16 v[86:87], v7 offset:44032
    v_mfma_f32_32x32x16_bf16 v[96:111], v[68:71], v[36:39], v[96:111]
    ds_read_b128 v[56:59], v6 offset:43008
    ds_read_b64_tr_b16 v[88:89], v7 offset:45056
    ds_read_b64_tr_b16 v[90:91], v7 offset:46080
    ds_read_b128 v[60:63], v6 offset:44032
    ds_read_b64_tr_b16 v[92:93], v7 offset:47104
    ds_read_b64_tr_b16 v[94:95], v7 offset:48128
    v_mfma_f32_32x32x16_bf16 v[96:111], v[72:75], v[40:43], v[96:111]
    v_mfma_f32_32x32x16_bf16 v[96:111], v[76:79], v[44:47], v[96:111]
    s_waitcnt lgkmcnt(0)
    s_barrier
    v_mfma_f32_32x32x16_bf16 v[96:111], v[80:83], v[48:51], v[96:111]
    ds_read_b128 v[32:35], v6 offset:0
    ds_read_b64_tr_b16 v[64:65], v7 offset:49152
    ds_read_b64_tr_b16 v[66:67], v7 offset:50176
    ds_read_b128 v[36:39], v6 offset:1024
    ds_read_b64_tr_b16 v[68:69], v7 offset:51200
    ds_read_b64_tr_b16 v[70:71], v7 offset:52224
    v_mfma_f32_32x32x16_bf16 v[96:111], v[84:87], v[52:55], v[96:111]
    ds_read_b128 v[40:43], v6 offset:2048
    ds_read_b64_tr_b16 v[72:73], v7 offset:53248
    ds_read_b64_tr_b16 v[74:75], v7 offset:54272
    ds_read_b128 v[44:47], v6 offset:3072
    ds_read_b64_tr_b16 v[76:77], v7 offset:55296
    ds_read_b64_tr_b16 v[78:79], v7 offset:56320
    v_mfma_f32_32x32x16_bf16 v[96:111], v[88:91], v[56:59], v[96:111]
    v_mfma_f32_32x32x16_bf16 v[96:111], v[92:95], v[60:63], v[96:111]
    s_waitcnt lgkmcnt(0)
    s_barrier
    v_mfma_f32_32x32x16_bf16 v[96:111], v[64:67], v[32:35], v[96:111]
    ds_read_b128 v[48:51], v6 offset:8192
    ds_read_b64_tr_b16 v[80:81], v7 offset:57344
    ds_read_b64_tr_b16 v[82:83], v7 offset:58368
    ds_read_b128 v[52:55], v6 offset:9216
    ds_read_b64_tr_b16 v[84:85], v7 offset:59392
    ds_read_b64_tr_b16 v[86:87], v7 offset:60416
    v_mfma_f32_32x32x16_bf16 v[96:111], v[68:71], v[36:39], v[96:111]
    ds_read_b128 v[56:59], v6 offset:10240
    ds_read_b64_tr_b16 v[88:89], v7 offset:61440
    ds_read_b64_tr_b16 v[90:91], v7 offset:62464
    ds_read_b128 v[60:63], v6 offset:11264
    ds_read_b64_tr_b16 v[92:93], v7 offset:63488
    ds_read_b64_tr_b16 v[94:95], v7 offset:64512
    v_mfma_f32_32x32x16_bf16 v[96:111], v[72:75], v[40:43], v[96:111]
    v_mfma_f32_32x32x16_bf16 v[96:111], v[76:79], v[44:47], v[96:111]
    s_waitcnt lgkmcnt(0)
    v_mfma_f32_32x32x16_bf16 v[96:111], v[80:83], v[48:51], v[96:111]
    v_mfma_f32_32x32x16_bf16 v[96:111], v[84:87], v[52:55], v[96:111]
    v_mfma_f32_32x32x16_bf16 v[96:111], v[88:91], v[56:59], v[96:111]
    v_mfma_f32_32x32x16_bf16 v[96:111], v[92:95], v[60:63], v[96:111]
    s_nop 7
    s_nop 3
    v_cvt_pk_bf16_f32 v232, v96, v97
    v_cvt_pk_bf16_f32 v233, v98, v99
    v_cvt_pk_bf16_f32 v234, v100, v101
    v_cvt_pk_bf16_f32 v235, v102, v103
    v_cvt_pk_bf16_f32 v236, v104, v105
    v_cvt_pk_bf16_f32 v237, v106, v107
    v_cvt_pk_bf16_f32 v238, v108, v109
    v_cvt_pk_bf16_f32 v239, v110, v111
    s_cmp_eq_u32 s3, 0
    s_cbranch_scc1 L_hs5_slow
    buffer_store_dwordx4 v[232:235], v4, s[28:31], s58 offen
    buffer_store_dwordx4 v[236:239], v4, s[28:31], s58 offen offset:1024
    s_branch L_hs5_done
L_hs5_slow:
    buffer_store_dwordx4 v[232:235], v4, s[28:31], s58 offen sc1
    buffer_store_dwordx4 v[236:239], v4, s[28:31], s58 offen offset:1024 sc1
L_hs5_done:
    v_pk_add_f32 v[112:113], v[96:97], v[98:99]
    v_pk_mul_f32 v[114:115], v[96:97], v[96:97]
    v_pk_fma_f32 v[114:115], v[98:99], v[98:99], v[114:115]
    v_pk_add_f32 v[112:113], v[112:113], v[100:101]
    v_pk_fma_f32 v[114:115], v[100:101], v[100:101], v[114:115]
    v_pk_add_f32 v[112:113], v[112:113], v[102:103]
    v_pk_fma_f32 v[114:115], v[102:103], v[102:103], v[114:115]
    v_pk_add_f32 v[112:113], v[112:113], v[104:105]
    v_pk_fma_f32 v[114:115], v[104:105], v[104:105], v[114:115]
    v_pk_add_f32 v[112:113], v[112:113], v[106:107]
    v_pk_fma_f32 v[114:115], v[106:107], v[106:107], v[114:115]
    v_pk_add_f32 v[112:113], v[112:113], v[108:109]
    v_pk_fma_f32 v[114:115], v[108:109], v[108:109], v[114:115]
    v_pk_add_f32 v[112:113], v[112:113], v[110:111]
    v_pk_fma_f32 v[114:115], v[110:111], v[110:111], v[114:115]
    v_add_f32 v12, v112, v113
    v_add_f32 v13, v114, v115
    s_nop 1
    v_permlane32_swap_b32 v12, v13
    s_nop 1
    v_add_f32 v12, v12, v13
    s_cmp_eq_u32 s3, 0
    s_cbranch_scc1 L_hs6_slow
    buffer_store_dword v12, v15, s[28:31], s53 offen
    s_branch L_hs6_done
L_hs6_slow:
    buffer_store_dword v12, v15, s[28:31], s53 offen sc1
L_hs6_done:
    s_waitcnt vmcnt(0)
    v_mov_b32 v228, 163780
    v_mov_b32 v229, 1
    s_mov_b64 exec, 1
    ds_add_rtn_u32 v229, v228, v229
    s_waitcnt lgkmcnt(0)
    v_readfirstlane_b32 s56, v229
    s_mov_b64 exec, -1
    s_cmp_lg_u32 s56, 3
    s_cbranch_scc1 L_h3a_np
    s_lshl_b32 s55, s47, 12
    s_add_u32 s55, s55, 6356992
    s_lshl_b32 s56, s48, 2
    s_add_u32 s55, s55, s56
    v_mov_b32 v228, 0
    v_mov_b32 v229, s10
    s_mov_b64 exec, 1
    s_cmp_eq_u32 s3, 0
    s_cbranch_scc1 L_hs7_slow
    buffer_store_dword v229, v228, s[28:31], s55 offen
    s_branch L_hs7_done
L_hs7_slow:
    buffer_store_dword v229, v228, s[28:31], s55 offen sc1
L_hs7_done:
    s_mov_b64 exec, -1
L_h3a_np:
    s_cmp_ge_u32 s48, 14
    s_cbranch_scc1 L_t_c5b
    s_lshl_b32 s55, s45, 12
    s_add_u32 s55, s55, 106496
    v_add_u32 v6, s55, v4
    v_and_b32 v12, 15, v1
    v_lshrrev_b32 v13, 2, v12
    v_lshl_add_u32 v14, v3, 2, v13
    v_lshlrev_b32 v14, 8, v14
    v_bfe_u32 v15, v1, 4, 1
    v_lshl_add_u32 v14, v15, 5, v14
    v_and_b32 v15, 3, v12
    v_lshl_add_u32 v14, v15, 3, v14
    s_lshl_b32 s55, s46, 1
    s_add_u32 s56, s55, 0
    v_xor_b32 v15, s56, v13
    v_lshl_add_u32 v7, v15, 6, v14
    v_add_u32 v8, 65536, v7
    s_add_u32 s56, s55, 1
    v_xor_b32 v15, s56, v13
    v_lshl_add_u32 v9, v15, 6, v14
    v_add_u32 v10, 65536, v9
    v_mov_b32 v96, 0
    v_mov_b32 v97, 0
    v_mov_b32 v98, 0
    v_mov_b32 v99, 0
    v_mov_b32 v100, 0
    v_mov_b32 v101, 0
    v_mov_b32 v102, 0
    v_mov_b32 v103, 0
    v_mov_b32 v104, 0
    v_mov_b32 v105, 0
    v_mov_b32 v106, 0
    v_mov_b32 v107, 0
    v_mov_b32 v108, 0
    v_mov_b32 v109, 0
    v_mov_b32 v110, 0
    v_mov_b32 v111, 0
    v_mov_b32 v112, 0
    v_mov_b32 v113, 0
    v_mov_b32 v114, 0
    v_mov_b32 v115, 0
    v_mov_b32 v116, 0
    v_mov_b32 v117, 0
    v_mov_b32 v118, 0
    v_mov_b32 v119, 0
    v_mov_b32 v120, 0
    v_mov_b32 v121, 0
    v_mov_b32 v122, 0
    v_mov_b32 v123, 0
    v_mov_b32 v124, 0
    v_mov_b32 v125, 0
    v_mov_b32 v126, 0
    v_mov_b32 v127, 0
    v_mov_b32 v128, 0
    v_mov_b32 v129, 0
    v_mov_b32 v130, 0
    v_mov_b32 v131, 0
    v_mov_b32 v132, 0
    v_mov_b32 v133, 0
    v_mov_b32 v134, 0
    v_mov_b32 v135, 0
    v_mov_b32 v136, 0
    v_mov_b32 v137, 0
    v_mov_b32 v138, 0
    v_mov_b32 v139, 0
    v_mov_b32 v140, 0
    v_mov_b32 v141, 0
    v_mov_b32 v142, 0
    v_mov_b32 v143, 0
    v_mov_b32 v144, 0
    v_mov_b32 v145, 0
    v_mov_b32 v146, 0
    v_mov_b32 v147, 0
    v_mov_b32 v148, 0
    v_mov_b32 v149, 0
    v_mov_b32 v150, 0
    v_mov_b32 v151, 0
    v_mov_b32 v152, 0
    v_mov_b32 v153, 0
    v_mov_b32 v154, 0
    v_mov_b32 v155, 0
    v_mov_b32 v156, 0
    v_mov_b32 v157, 0
    v_mov_b32 v158, 0
    v_mov_b32 v159, 0
    v_mov_b32 v216, 0xc0135761
    v_mov_b32 v217, 0xc0135761
    v_mov_b32 v218, 0xbdd2d3e8
    v_mov_b32 v219, 0xbdd2d3e8
    v_mov_b32 v220, 1.0
    v_mov_b32 v221, 1.0
    s_lshl_b32 s55, s45, 9
    s_add_u32 s55, s55, 155648
    v_lshlrev_b32 v12, 3, v2
    v_add_u32 v12, s55, v12
    s_lshl_b32 s55, s46, 8
    s_add_u32 s55, s55, 158720
    v_lshlrev_b32 v13, 4, v3
    v_add_u32 v13, s55, v13
    v_and_b32 v14, 15, v1
    v_bfe_u32 v15, v1, 4, 1
    v_cmp_eq_u32 vcc, v14, v15
    v_cmp_gt_u32 s[84:85], 2, v14
    v_lshrrev_b32 v15, 4, v1
    v_lshlrev_b32 v15, 4, v15
    v_lshl_add_u32 v15, v14, 6, v15
    s_lshl_b32 s55, s44, 8
    s_add_u32 s55, s55, 156672
    v_add_u32 v15, s55, v15
    v_lshlrev_b32 v13, 4, v3
    v_add_u32 v13, s55, v13
    v_mov_b32 v28, 0
    v_mov_b32 v29, 0x3f803f80
    v_cndmask_b32 v16, v28, v29, vcc
    v_cndmask_b32 v17, v28, v29, vcc
    v_cndmask_b32 v18, v28, v29, vcc
    v_cndmask_b32 v19, v28, v29, vcc
    v_mov_b32 v20, 0
    v_mov_b32 v21, 0
    v_mov_b32 v22, 0
    v_mov_b32 v23, 0
    v_mov_b32 v24, 0
    v_mov_b32 v25, 0
    v_mov_b32 v26, 0
    v_mov_b32 v27, 0
    s_cmp_lg_u32 s44, 0
    s_cbranch_scc1 L_h3b_x
    s_lshl_b32 s55, s47, 12
    s_add_u32 s55, s55, 6356992
    v_min_u32 v228, 15, v1
    v_lshlrev_b32 v228, 2, v228
    s_mov_b32 s26, 0
L_h3b_p:
    buffer_load_dword v229, v228, s[28:31], s55 offen sc1
    s_add_u32 s26, s26, 1
    s_cmp_ge_u32 s26, 0x100000
    s_cbranch_scc1 L_h3b_x
    s_waitcnt vmcnt(0)
    v_cmp_ne_u32 vcc, s10, v229
    s_cbranch_vccz L_h3b_x
    s_sleep 1
    s_branch L_h3b_p
L_h3b_x:
    s_barrier
    s_barrier
    ds_read_b128 v[32:35], v6 offset:0
    ds_read_b64_tr_b16 v[64:65], v8 offset:0
    ds_read_b64_tr_b16 v[66:67], v8 offset:2048
    ds_read_b128 v[36:39], v6 offset:2048
    ds_read_b64_tr_b16 v[68:69], v10 offset:0
    ds_read_b64_tr_b16 v[70:71], v10 offset:2048
    ds_read_b128 v[40:43], v6 offset:1024
    ds_read_b64_tr_b16 v[72:73], v8 offset:4096
    ds_read_b64_tr_b16 v[74:75], v8 offset:6144
    ds_read_b128 v[44:47], v6 offset:3072
    ds_read_b64_tr_b16 v[76:77], v10 offset:4096
    ds_read_b64_tr_b16 v[78:79], v10 offset:6144
    s_waitcnt lgkmcnt(0)
    s_barrier
    v_mfma_f32_32x32x16_bf16 v[96:111], v[64:67], v[32:35], v[96:111]
    ds_read_b128 v[48:51], v6 offset:8192
    ds_read_b128 v[52:55], v6 offset:10240
    v_mfma_f32_32x32x16_bf16 v[128:143], v[64:67], v[36:39], v[128:143]
    ds_read_b64_tr_b16 v[80:81], v8 offset:8192
    ds_read_b64_tr_b16 v[82:83], v8 offset:10240
    v_mfma_f32_16x16x32_bf16 v[20:23], v[64:67], v[16:19], v[20:23]
    v_mfma_f32_32x32x16_bf16 v[112:127], v[68:71], v[32:35], v[112:127]
    ds_read_b64_tr_b16 v[84:85], v10 offset:8192
    ds_read_b64_tr_b16 v[86:87], v10 offset:10240
    v_mfma_f32_32x32x16_bf16 v[144:159], v[68:71], v[36:39], v[144:159]
    ds_read_b128 v[56:59], v6 offset:9216
    ds_read_b128 v[60:63], v6 offset:11264
    v_mfma_f32_16x16x32_bf16 v[24:27], v[68:71], v[16:19], v[24:27]
    v_mfma_f32_32x32x16_bf16 v[96:111], v[72:75], v[40:43], v[96:111]
    ds_read_b64_tr_b16 v[88:89], v8 offset:12288
    ds_read_b64_tr_b16 v[90:91], v8 offset:14336
    v_mfma_f32_32x32x16_bf16 v[128:143], v[72:75], v[44:47], v[128:143]
    ds_read_b64_tr_b16 v[92:93], v10 offset:12288
    ds_read_b64_tr_b16 v[94:95], v10 offset:14336
    v_mfma_f32_16x16x32_bf16 v[20:23], v[72:75], v[16:19], v[20:23]
    v_mfma_f32_32x32x16_bf16 v[112:127], v[76:79], v[40:43], v[112:127]
    v_mfma_f32_32x32x16_bf16 v[144:159], v[76:79], v[44:47], v[144:159]
    v_mfma_f32_16x16x32_bf16 v[24:27], v[76:79], v[16:19], v[24:27]
    s_waitcnt lgkmcnt(0)
    s_barrier
    v_mfma_f32_32x32x16_bf16 v[96:111], v[80:83], v[48:51], v[96:111]
    ds_read_b128 v[32:35], v6 offset:16384
    ds_read_b128 v[36:39], v6 offset:18432
    v_mfma_f32_32x32x16_bf16 v[128:143], v[80:83], v[52:55], v[128:143]
    ds_read_b64_tr_b16 v[64:65], v8 offset:16384
    ds_read_b64_tr_b16 v[66:67], v8 offset:18432
    v_mfma_f32_16x16x32_bf16 v[20:23], v[80:83], v[16:19], v[20:23]
    v_mfma_f32_32x32x16_bf16 v[112:127], v[84:87], v[48:51], v[112:127]
    ds_read_b64_tr_b16 v[68:69], v10 offset:16384
    ds_read_b64_tr_b16 v[70:71], v10 offset:18432
    v_mfma_f32_32x32x16_bf16 v[144:159], v[84:87], v[52:55], v[144:159]
    ds_read_b128 v[40:43], v6 offset:17408
    ds_read_b128 v[44:47], v6 offset:19456
    v_mfma_f32_16x16x32_bf16 v[24:27], v[84:87], v[16:19], v[24:27]
    v_mfma_f32_32x32x16_bf16 v[96:111], v[88:91], v[56:59], v[96:111]
    ds_read_b64_tr_b16 v[72:73], v8 offset:20480
    ds_read_b64_tr_b16 v[74:75], v8 offset:22528
    v_mfma_f32_32x32x16_bf16 v[128:143], v[88:91], v[60:63], v[128:143]
    ds_read_b64_tr_b16 v[76:77], v10 offset:20480
    ds_read_b64_tr_b16 v[78:79], v10 offset:22528
    v_mfma_f32_16x16x32_bf16 v[20:23], v[88:91], v[16:19], v[20:23]
    v_mfma_f32_32x32x16_bf16 v[112:127], v[92:95], v[56:59], v[112:127]
    v_mfma_f32_32x32x16_bf16 v[144:159], v[92:95], v[60:63], v[144:159]
    v_mfma_f32_16x16x32_bf16 v[24:27], v[92:95], v[16:19], v[24:27]
    s_waitcnt lgkmcnt(0)
    s_barrier
    v_mfma_f32_32x32x16_bf16 v[96:111], v[64:67], v[32:35], v[96:111]
    ds_read_b128 v[48:51], v6 offset:24576
    ds_read_b128 v[52:55], v6 offset:26624
    v_mfma_f32_32x32x16_bf16 v[128:143], v[64:67], v[36:39], v[128:143]
    ds_read_b64_tr_b16 v[80:81], v8 offset:24576
    ds_read_b64_tr_b16 v[82:83], v8 offset:26624
    v_mfma_f32_16x16x32_bf16 v[20:23], v[64:67], v[16:19], v[20:23]
    v_mfma_f32_32x32x16_bf16 v[112:127], v[68:71], v[32:35], v[112:127]
    ds_read_b64_tr_b16 v[84:85], v10 offset:24576
    ds_read_b64_tr_b16 v[86:87], v10 offset:26624
    v_mfma_f32_32x32x16_bf16 v[144:159], v[68:71], v[36:39], v[144:159]
    ds_read_b128 v[56:59], v6 offset:25600
    ds_read_b128 v[60:63], v6 offset:27648
    v_mfma_f32_16x16x32_bf16 v[24:27], v[68:71], v[16:19], v[24:27]
    v_mfma_f32_32x32x16_bf16 v[96:111], v[72:75], v[40:43], v[96:111]
    ds_read_b64_tr_b16 v[88:89], v8 offset:28672
    ds_read_b64_tr_b16 v[90:91], v8 offset:30720
    v_mfma_f32_32x32x16_bf16 v[128:143], v[72:75], v[44:47], v[128:143]
    ds_read_b64_tr_b16 v[92:93], v10 offset:28672
    ds_read_b64_tr_b16 v[94:95], v10 offset:30720
    v_mfma_f32_16x16x32_bf16 v[20:23], v[72:75], v[16:19], v[20:23]
    v_mfma_f32_32x32x16_bf16 v[112:127], v[76:79], v[40:43], v[112:127]
    v_mfma_f32_32x32x16_bf16 v[144:159], v[76:79], v[44:47], v[144:159]
    v_mfma_f32_16x16x32_bf16 v[24:27], v[76:79], v[16:19], v[24:27]
    s_waitcnt lgkmcnt(0)
    s_barrier
    v_mfma_f32_32x32x16_bf16 v[96:111], v[80:83], v[48:51], v[96:111]
    ds_read_b128 v[32:35], v6 offset:32768
    ds_read_b128 v[36:39], v6 offset:34816
    v_mfma_f32_32x32x16_bf16 v[128:143], v[80:83], v[52:55], v[128:143]
    ds_read_b64_tr_b16 v[64:65], v8 offset:32768
    ds_read_b64_tr_b16 v[66:67], v8 offset:34816
    v_mfma_f32_16x16x32_bf16 v[20:23], v[80:83], v[16:19], v[20:23]
    v_mfma_f32_32x32x16_bf16 v[112:127], v[84:87], v[48:51], v[112:127]
    ds_read_b64_tr_b16 v[68:69], v10 offset:32768
    ds_read_b64_tr_b16 v[70:71], v10 offset:34816
    v_mfma_f32_32x32x16_bf16 v[144:159], v[84:87], v[52:55], v[144:159]
    ds_read_b128 v[40:43], v6 offset:33792
    ds_read_b128 v[44:47], v6 offset:35840
    v_mfma_f32_16x16x32_bf16 v[24:27], v[84:87], v[16:19], v[24:27]
    v_mfma_f32_32x32x16_bf16 v[96:111], v[88:91], v[56:59], v[96:111]
    ds_read_b64_tr_b16 v[72:73], v8 offset:36864
    ds_read_b64_tr_b16 v[74:75], v8 offset:38912
    v_mfma_f32_32x32x16_bf16 v[128:143], v[88:91], v[60:63], v[128:143]
    ds_read_b64_tr_b16 v[76:77], v10 offset:36864
    ds_read_b64_tr_b16 v[78:79], v10 offset:38912
    v_mfma_f32_16x16x32_bf16 v[20:23], v[88:91], v[16:19], v[20:23]
    v_mfma_f32_32x32x16_bf16 v[112:127], v[92:95], v[56:59], v[112:127]
    v_mfma_f32_32x32x16_bf16 v[144:159], v[92:95], v[60:63], v[144:159]
    v_mfma_f32_16x16x32_bf16 v[24:27], v[92:95], v[16:19], v[24:27]
    s_waitcnt lgkmcnt(0)
    s_barrier
    v_mfma_f32_32x32x16_bf16 v[96:111], v[64:67], v[32:35], v[96:111]
    ds_read_b128 v[48:51], v6 offset:40960
    ds_read_b128 v[52:55], v6 offset:43008
    v_mfma_f32_32x32x16_bf16 v[128:143], v[64:67], v[36:39], v[128:143]
    ds_read_b64_tr_b16 v[80:81], v7 offset:0
    ds_read_b64_tr_b16 v[82:83], v7 offset:2048
    v_mfma_f32_16x16x32_bf16 v[20:23], v[64:67], v[16:19], v[20:23]
    v_mfma_f32_32x32x16_bf16 v[112:127], v[68:71], v[32:35], v[112:127]
    ds_read_b64_tr_b16 v[84:85], v9 offset:0
    ds_read_b64_tr_b16 v[86:87], v9 offset:2048
    v_mfma_f32_32x32x16_bf16 v[144:159], v[68:71], v[36:39], v[144:159]
    ds_read_b128 v[56:59], v6 offset:41984
    ds_read_b128 v[60:63], v6 offset:44032
    v_mfma_f32_16x16x32_bf16 v[24:27], v[68:71], v[16:19], v[24:27]
    v_mfma_f32_32x32x16_bf16 v[96:111], v[72:75], v[40:43], v[96:111]
    ds_read_b64_tr_b16 v[88:89], v7 offset:4096
    ds_read_b64_tr_b16 v[90:91], v7 offset:6144
    v_mfma_f32_32x32x16_bf16 v[128:143], v[72:75], v[44:47], v[128:143]
    ds_read_b64_tr_b16 v[92:93], v9 offset:4096
    ds_read_b64_tr_b16 v[94:95], v9 offset:6144
    v_mfma_f32_16x16x32_bf16 v[20:23], v[72:75], v[16:19], v[20:23]
    v_mfma_f32_32x32x16_bf16 v[112:127], v[76:79], v[40:43], v[112:127]
    v_mfma_f32_32x32x16_bf16 v[144:159], v[76:79], v[44:47], v[144:159]
    v_mfma_f32_16x16x32_bf16 v[24:27], v[76:79], v[16:19], v[24:27]
    s_waitcnt lgkmcnt(0)
    s_barrier
    v_mfma_f32_32x32x16_bf16 v[96:111], v[80:83], v[48:51], v[96:111]
    ds_read_b128 v[32:35], v6 offset:0
    ds_read_b128 v[36:39], v6 offset:2048
    v_mfma_f32_32x32x16_bf16 v[128:143], v[80:83], v[52:55], v[128:143]
    ds_read_b64_tr_b16 v[64:65], v7 offset:8192
    ds_read_b64_tr_b16 v[66:67], v7 offset:10240
    v_mfma_f32_16x16x32_bf16 v[20:23], v[80:83], v[16:19], v[20:23]
    v_mfma_f32_32x32x16_bf16 v[112:127], v[84:87], v[48:51], v[112:127]
    ds_read_b64_tr_b16 v[68:69], v9 offset:8192
    ds_read_b64_tr_b16 v[70:71], v9 offset:10240
    v_mfma_f32_32x32x16_bf16 v[144:159], v[84:87], v[52:55], v[144:159]
    ds_read_b128 v[40:43], v6 offset:1024
    ds_read_b128 v[44:47], v6 offset:3072
    v_mfma_f32_16x16x32_bf16 v[24:27], v[84:87], v[16:19], v[24:27]
    v_mfma_f32_32x32x16_bf16 v[96:111], v[88:91], v[56:59], v[96:111]
    ds_read_b64_tr_b16 v[72:73], v7 offset:12288
    ds_read_b64_tr_b16 v[74:75], v7 offset:14336
    v_mfma_f32_32x32x16_bf16 v[128:143], v[88:91], v[60:63], v[128:143]
    ds_read_b64_tr_b16 v[76:77], v9 offset:12288
    ds_read_b64_tr_b16 v[78:79], v9 offset:14336
    v_mfma_f32_16x16x32_bf16 v[20:23], v[88:91], v[16:19], v[20:23]
    v_mfma_f32_32x32x16_bf16 v[112:127], v[92:95], v[56:59], v[112:127]
    v_mfma_f32_32x32x16_bf16 v[144:159], v[92:95], v[60:63], v[144:159]
    v_mfma_f32_16x16x32_bf16 v[24:27], v[92:95], v[16:19], v[24:27]
    s_waitcnt lgkmcnt(0)
    s_barrier
    v_mfma_f32_32x32x16_bf16 v[96:111], v[64:67], v[32:35], v[96:111]
    ds_read_b128 v[48:51], v6 offset:8192
    ds_read_b128 v[52:55], v6 offset:10240
    v_mfma_f32_32x32x16_bf16 v[128:143], v[64:67], v[36:39], v[128:143]
    ds_read_b64_tr_b16 v[80:81], v7 offset:16384
    ds_read_b64_tr_b16 v[82:83], v7 offset:18432
    v_mfma_f32_16x16x32_bf16 v[20:23], v[64:67], v[16:19], v[20:23]
    v_mfma_f32_32x32x16_bf16 v[112:127], v[68:71], v[32:35], v[112:127]
    ds_read_b64_tr_b16 v[84:85], v9 offset:16384
    ds_read_b64_tr_b16 v[86:87], v9 offset:18432
    v_mfma_f32_32x32x16_bf16 v[144:159], v[68:71], v[36:39], v[144:159]
    ds_read_b128 v[56:59], v6 offset:9216
    ds_read_b128 v[60:63], v6 offset:11264
    v_mfma_f32_16x16x32_bf16 v[24:27], v[68:71], v[16:19], v[24:27]
    v_mfma_f32_32x32x16_bf16 v[96:111], v[72:75], v[40:43], v[96:111]
    ds_read_b64_tr_b16 v[88:89], v7 offset:20480
    ds_read_b64_tr_b16 v[90:91], v7 offset:22528
    v_mfma_f32_32x32x16_bf16 v[128:143], v[72:75], v[44:47], v[128:143]
    ds_read_b64_tr_b16 v[92:93], v9 offset:20480
    ds_read_b64_tr_b16 v[94:95], v9 offset:22528
    v_mfma_f32_16x16x32_bf16 v[20:23], v[72:75], v[16:19], v[20:23]
    v_mfma_f32_32x32x16_bf16 v[112:127], v[76:79], v[40:43], v[112:127]
    v_mfma_f32_32x32x16_bf16 v[144:159], v[76:79], v[44:47], v[144:159]
    v_mfma_f32_16x16x32_bf16 v[24:27], v[76:79], v[16:19], v[24:27]
    s_waitcnt lgkmcnt(0)
    s_barrier
    v_mfma_f32_32x32x16_bf16 v[96:111], v[80:83], v[48:51], v[96:111]
    ds_read_b128 v[32:35], v6 offset:16384
    ds_read_b128 v[36:39], v6 offset:18432
    v_mfma_f32_32x32x16_bf16 v[128:143], v[80:83], v[52:55], v[128:143]
    ds_read_b64_tr_b16 v[64:65], v7 offset:24576
    ds_read_b64_tr_b16 v[66:67], v7 offset:26624
    v_mfma_f32_16x16x32_bf16 v[20:23], v[80:83], v[16:19], v[20:23]
    v_mfma_f32_32x32x16_bf16 v[112:127], v[84:87], v[48:51], v[112:127]
    ds_read_b64_tr_b16 v[68:69], v9 offset:24576
    ds_read_b64_tr_b16 v[70:71], v9 offset:26624
    v_mfma_f32_32x32x16_bf16 v[144:159], v[84:87], v[52:55], v[144:159]
    ds_read_b128 v[40:43], v6 offset:17408
    ds_read_b128 v[44:47], v6 offset:19456
    v_mfma_f32_16x16x32_bf16 v[24:27], v[84:87], v[16:19], v[24:27]
    v_mfma_f32_32x32x16_bf16 v[96:111], v[88:91], v[56:59], v[96:111]
    ds_read_b64_tr_b16 v[72:73], v7 offset:28672
    ds_read_b64_tr_b16 v[74:75], v7 offset:30720
    v_mfma_f32_32x32x16_bf16 v[128:143], v[88:91], v[60:63], v[128:143]
    ds_read_b64_tr_b16 v[76:77], v9 offset:28672
    ds_read_b64_tr_b16 v[78:79], v9 offset:30720
    v_mfma_f32_16x16x32_bf16 v[20:23], v[88:91], v[16:19], v[20:23]
    v_mfma_f32_32x32x16_bf16 v[112:127], v[92:95], v[56:59], v[112:127]
    v_mfma_f32_32x32x16_bf16 v[144:159], v[92:95], v[60:63], v[144:159]
    v_mfma_f32_16x16x32_bf16 v[24:27], v[92:95], v[16:19], v[24:27]
    s_waitcnt lgkmcnt(0)
    s_barrier
    v_mfma_f32_32x32x16_bf16 v[96:111], v[64:67], v[32:35], v[96:111]
    ds_read_b128 v[48:51], v6 offset:24576
    ds_read_b128 v[52:55], v6 offset:26624
    v_mfma_f32_32x32x16_bf16 v[128:143], v[64:67], v[36:39], v[128:143]
    ds_read_b64_tr_b16 v[80:81], v7 offset:32768
    ds_read_b64_tr_b16 v[82:83], v7 offset:34816
    v_mfma_f32_16x16x32_bf16 v[20:23], v[64:67], v[16:19], v[20:23]
    v_mfma_f32_32x32x16_bf16 v[112:127], v[68:71], v[32:35], v[112:127]
    ds_read_b64_tr_b16 v[84:85], v9 offset:32768
    ds_read_b64_tr_b16 v[86:87], v9 offset:34816
    v_mfma_f32_32x32x16_bf16 v[144:159], v[68:71], v[36:39], v[144:159]
    ds_read_b128 v[56:59], v6 offset:25600
    ds_read_b128 v[60:63], v6 offset:27648
    v_mfma_f32_16x16x32_bf16 v[24:27], v[68:71], v[16:19], v[24:27]
    v_mfma_f32_32x32x16_bf16 v[96:111], v[72:75], v[40:43], v[96:111]
    ds_read_b64_tr_b16 v[88:89], v7 offset:36864
    ds_read_b64_tr_b16 v[90:91], v7 offset:38912
    v_mfma_f32_32x32x16_bf16 v[128:143], v[72:75], v[44:47], v[128:143]
    ds_read_b64_tr_b16 v[92:93], v9 offset:36864
    ds_read_b64_tr_b16 v[94:95], v9 offset:38912
    v_mfma_f32_16x16x32_bf16 v[20:23], v[72:75], v[16:19], v[20:23]
    v_mfma_f32_32x32x16_bf16 v[112:127], v[76:79], v[40:43], v[112:127]
    v_mfma_f32_32x32x16_bf16 v[144:159], v[76:79], v[44:47], v[144:159]
    v_mfma_f32_16x16x32_bf16 v[24:27], v[76:79], v[16:19], v[24:27]
    s_waitcnt lgkmcnt(0)
    s_barrier
    v_mfma_f32_32x32x16_bf16 v[96:111], v[80:83], v[48:51], v[96:111]
    ds_read_b128 v[32:35], v6 offset:32768
    ds_read_b128 v[36:39], v6 offset:34816
    v_mfma_f32_32x32x16_bf16 v[128:143], v[80:83], v[52:55], v[128:143]
    ds_read_b64_tr_b16 v[64:65], v7 offset:40960
    ds_read_b64_tr_b16 v[66:67], v7 offset:43008
    v_mfma_f32_16x16x32_bf16 v[20:23], v[80:83], v[16:19], v[20:23]
    v_mfma_f32_32x32x16_bf16 v[112:127], v[84:87], v[48:51], v[112:127]
    ds_read_b64_tr_b16 v[68:69], v9 offset:40960
    ds_read_b64_tr_b16 v[70:71], v9 offset:43008
    v_mfma_f32_32x32x16_bf16 v[144:159], v[84:87], v[52:55], v[144:159]
    ds_read_b128 v[40:43], v6 offset:33792
    ds_read_b128 v[44:47], v6 offset:35840
    v_mfma_f32_16x16x32_bf16 v[24:27], v[84:87], v[16:19], v[24:27]
    v_mfma_f32_32x32x16_bf16 v[96:111], v[88:91], v[56:59], v[96:111]
    ds_read_b64_tr_b16 v[72:73], v7 offset:45056
    ds_read_b64_tr_b16 v[74:75], v7 offset:47104
    v_mfma_f32_32x32x16_bf16 v[128:143], v[88:91], v[60:63], v[128:143]
    ds_read_b64_tr_b16 v[76:77], v9 offset:45056
    ds_read_b64_tr_b16 v[78:79], v9 offset:47104
    v_mfma_f32_16x16x32_bf16 v[20:23], v[88:91], v[16:19], v[20:23]
    v_mfma_f32_32x32x16_bf16 v[112:127], v[92:95], v[56:59], v[112:127]
    v_mfma_f32_32x32x16_bf16 v[144:159], v[92:95], v[60:63], v[144:159]
    v_mfma_f32_16x16x32_bf16 v[24:27], v[92:95], v[16:19], v[24:27]
    s_waitcnt lgkmcnt(0)
    s_barrier
    v_mfma_f32_32x32x16_bf16 v[96:111], v[64:67], v[32:35], v[96:111]
    ds_read_b128 v[48:51], v6 offset:40960
    ds_read_b128 v[52:55], v6 offset:43008
    v_mfma_f32_32x32x16_bf16 v[128:143], v[64:67], v[36:39], v[128:143]
    ds_read_b64_tr_b16 v[80:81], v7 offset:49152
    ds_read_b64_tr_b16 v[82:83], v7 offset:51200
    v_mfma_f32_16x16x32_bf16 v[20:23], v[64:67], v[16:19], v[20:23]
    v_mfma_f32_32x32x16_bf16 v[112:127], v[68:71], v[32:35], v[112:127]
    ds_read_b64_tr_b16 v[84:85], v9 offset:49152
    ds_read_b64_tr_b16 v[86:87], v9 offset:51200
    v_mfma_f32_32x32x16_bf16 v[144:159], v[68:71], v[36:39], v[144:159]
    ds_read_b128 v[56:59], v6 offset:41984
    ds_read_b128 v[60:63], v6 offset:44032
    v_mfma_f32_16x16x32_bf16 v[24:27], v[68:71], v[16:19], v[24:27]
    v_mfma_f32_32x32x16_bf16 v[96:111], v[72:75], v[40:43], v[96:111]
    ds_read_b64_tr_b16 v[88:89], v7 offset:53248
    ds_read_b64_tr_b16 v[90:91], v7 offset:55296
    v_mfma_f32_32x32x16_bf16 v[128:143], v[72:75], v[44:47], v[128:143]
    ds_read_b64_tr_b16 v[92:93], v9 offset:53248
    ds_read_b64_tr_b16 v[94:95], v9 offset:55296
    v_mfma_f32_16x16x32_bf16 v[20:23], v[72:75], v[16:19], v[20:23]
    v_mfma_f32_32x32x16_bf16 v[112:127], v[76:79], v[40:43], v[112:127]
    v_mfma_f32_32x32x16_bf16 v[144:159], v[76:79], v[44:47], v[144:159]
    v_mfma_f32_16x16x32_bf16 v[24:27], v[76:79], v[16:19], v[24:27]
    s_waitcnt lgkmcnt(0)
    s_barrier
    v_mfma_f32_32x32x16_bf16 v[96:111], v[80:83], v[48:51], v[96:111]
    ds_read_b128 v[32:35], v6 offset:0
    ds_read_b128 v[36:39], v6 offset:2048
    v_mfma_f32_32x32x16_bf16 v[128:143], v[80:83], v[52:55], v[128:143]
    ds_read_b64_tr_b16 v[64:65], v7 offset:57344
    ds_read_b64_tr_b16 v[66:67], v7 offset:59392
    v_mfma_f32_16x16x32_bf16 v[20:23], v[80:83], v[16:19], v[20:23]
    v_mfma_f32_32x32x16_bf16 v[112:127], v[84:87], v[48:51], v[112:127]
    ds_read_b64_tr_b16 v[68:69], v9 offset:57344
    ds_read_b64_tr_b16 v[70:71], v9 offset:59392
    v_mfma_f32_32x32x16_bf16 v[144:159], v[84:87], v[52:55], v[144:159]
    ds_read_b128 v[40:43], v6 offset:1024
    ds_read_b128 v[44:47], v6 offset:3072
    v_mfma_f32_16x16x32_bf16 v[24:27], v[84:87], v[16:19], v[24:27]
    v_mfma_f32_32x32x16_bf16 v[96:111], v[88:91], v[56:59], v[96:111]
    ds_read_b64_tr_b16 v[72:73], v7 offset:61440
    ds_read_b64_tr_b16 v[74:75], v7 offset:63488
    v_mfma_f32_32x32x16_bf16 v[128:143], v[88:91], v[60:63], v[128:143]
    ds_read_b64_tr_b16 v[76:77], v9 offset:61440
    ds_read_b64_tr_b16 v[78:79], v9 offset:63488
    v_mfma_f32_16x16x32_bf16 v[20:23], v[88:91], v[16:19], v[20:23]
    v_mfma_f32_32x32x16_bf16 v[112:127], v[92:95], v[56:59], v[112:127]
    v_mfma_f32_32x32x16_bf16 v[144:159], v[92:95], v[60:63], v[144:159]
    v_mfma_f32_16x16x32_bf16 v[24:27], v[92:95], v[16:19], v[24:27]
    s_waitcnt lgkmcnt(0)
    s_barrier
    v_mfma_f32_32x32x16_bf16 v[96:111], v[64:67], v[32:35], v[96:111]
    ds_read_b128 v[48:51], v6 offset:8192
    ds_read_b128 v[52:55], v6 offset:10240
    v_mfma_f32_32x32x16_bf16 v[128:143], v[64:67], v[36:39], v[128:143]
    ds_read_b64_tr_b16 v[80:81], v8 offset:0
    ds_read_b64_tr_b16 v[82:83], v8 offset:2048
    v_mfma_f32_16x16x32_bf16 v[20:23], v[64:67], v[16:19], v[20:23]
    v_mfma_f32_32x32x16_bf16 v[112:127], v[68:71], v[32:35], v[112:127]
    ds_read_b64_tr_b16 v[84:85], v10 offset:0
    ds_read_b64_tr_b16 v[86:87], v10 offset:2048
    v_mfma_f32_32x32x16_bf16 v[144:159], v[68:71], v[36:39], v[144:159]
    ds_read_b128 v[56:59], v6 offset:9216
    ds_read_b128 v[60:63], v6 offset:11264
    v_mfma_f32_16x16x32_bf16 v[24:27], v[68:71], v[16:19], v[24:27]
    v_mfma_f32_32x32x16_bf16 v[96:111], v[72:75], v[40:43], v[96:111]
    ds_read_b64_tr_b16 v[88:89], v8 offset:4096
    ds_read_b64_tr_b16 v[90:91], v8 offset:6144
    v_mfma_f32_32x32x16_bf16 v[128:143], v[72:75], v[44:47], v[128:143]
    ds_read_b64_tr_b16 v[92:93], v10 offset:4096
    ds_read_b64_tr_b16 v[94:95], v10 offset:6144
    v_mfma_f32_16x16x32_bf16 v[20:23], v[72:75], v[16:19], v[20:23]
    v_mfma_f32_32x32x16_bf16 v[112:127], v[76:79], v[40:43], v[112:127]
    v_mfma_f32_32x32x16_bf16 v[144:159], v[76:79], v[44:47], v[144:159]
    v_mfma_f32_16x16x32_bf16 v[24:27], v[76:79], v[16:19], v[24:27]
    s_waitcnt lgkmcnt(0)
    s_barrier
    v_mfma_f32_32x32x16_bf16 v[96:111], v[80:83], v[48:51], v[96:111]
    ds_read_b128 v[32:35], v6 offset:16384
    ds_read_b128 v[36:39], v6 offset:18432
    v_mfma_f32_32x32x16_bf16 v[128:143], v[80:83], v[52:55], v[128:143]
    ds_read_b64_tr_b16 v[64:65], v8 offset:8192
    ds_read_b64_tr_b16 v[66:67], v8 offset:10240
    v_mfma_f32_16x16x32_bf16 v[20:23], v[80:83], v[16:19], v[20:23]
    v_mfma_f32_32x32x16_bf16 v[112:127], v[84:87], v[48:51], v[112:127]
    ds_read_b64_tr_b16 v[68:69], v10 offset:8192
    ds_read_b64_tr_b16 v[70:71], v10 offset:10240
    v_mfma_f32_32x32x16_bf16 v[144:159], v[84:87], v[52:55], v[144:159]
    ds_read_b128 v[40:43], v6 offset:17408
    ds_read_b128 v[44:47], v6 offset:19456
    v_mfma_f32_16x16x32_bf16 v[24:27], v[84:87], v[16:19], v[24:27]
    v_mfma_f32_32x32x16_bf16 v[96:111], v[88:91], v[56:59], v[96:111]
    ds_read_b64_tr_b16 v[72:73], v8 offset:12288
    ds_read_b64_tr_b16 v[74:75], v8 offset:14336
    v_mfma_f32_32x32x16_bf16 v[128:143], v[88:91], v[60:63], v[128:143]
    ds_read_b64_tr_b16 v[76:77], v10 offset:12288
    ds_read_b64_tr_b16 v[78:79], v10 offset:14336
    v_mfma_f32_16x16x32_bf16 v[20:23], v[88:91], v[16:19], v[20:23]
    v_mfma_f32_32x32x16_bf16 v[112:127], v[92:95], v[56:59], v[112:127]
    v_mfma_f32_32x32x16_bf16 v[144:159], v[92:95], v[60:63], v[144:159]
    v_mfma_f32_16x16x32_bf16 v[24:27], v[92:95], v[16:19], v[24:27]
    s_waitcnt lgkmcnt(0)
    s_barrier
    v_mfma_f32_32x32x16_bf16 v[96:111], v[64:67], v[32:35], v[96:111]
    ds_read_b128 v[48:51], v6 offset:24576
    ds_read_b128 v[52:55], v6 offset:26624
    v_mfma_f32_32x32x16_bf16 v[128:143], v[64:67], v[36:39], v[128:143]
    ds_read_b64_tr_b16 v[80:81], v8 offset:16384
    ds_read_b64_tr_b16 v[82:83], v8 offset:18432
    v_mfma_f32_16x16x32_bf16 v[20:23], v[64:67], v[16:19], v[20:23]
    v_mfma_f32_32x32x16_bf16 v[112:127], v[68:71], v[32:35], v[112:127]
    ds_read_b64_tr_b16 v[84:85], v10 offset:16384
    ds_read_b64_tr_b16 v[86:87], v10 offset:18432
    v_mfma_f32_32x32x16_bf16 v[144:159], v[68:71], v[36:39], v[144:159]
    ds_read_b128 v[56:59], v6 offset:25600
    ds_read_b128 v[60:63], v6 offset:27648
    v_mfma_f32_16x16x32_bf16 v[24:27], v[68:71], v[16:19], v[24:27]
    v_mfma_f32_32x32x16_bf16 v[96:111], v[72:75], v[40:43], v[96:111]
    ds_read_b64_tr_b16 v[88:89], v8 offset:20480
    ds_read_b64_tr_b16 v[90:91], v8 offset:22528
    v_mfma_f32_32x32x16_bf16 v[128:143], v[72:75], v[44:47], v[128:143]
    ds_read_b64_tr_b16 v[92:93], v10 offset:20480
    ds_read_b64_tr_b16 v[94:95], v10 offset:22528
    v_mfma_f32_16x16x32_bf16 v[20:23], v[72:75], v[16:19], v[20:23]
    v_mfma_f32_32x32x16_bf16 v[112:127], v[76:79], v[40:43], v[112:127]
    v_mfma_f32_32x32x16_bf16 v[144:159], v[76:79], v[44:47], v[144:159]
    v_mfma_f32_16x16x32_bf16 v[24:27], v[76:79], v[16:19], v[24:27]
    s_waitcnt lgkmcnt(0)
    ds_read_b64 v[208:209], v12
    ds_read_b64 v[212:213], v12 offset:256
    v_mfma_f32_16x16x32_bf16 v[20:23], v[80:83], v[16:19], v[20:23]
    v_mfma_f32_16x16x32_bf16 v[24:27], v[84:87], v[16:19], v[24:27]
    v_mfma_f32_16x16x32_bf16 v[20:23], v[88:91], v[16:19], v[20:23]
    v_mfma_f32_16x16x32_bf16 v[24:27], v[92:95], v[16:19], v[24:27]
    v_mfma_f32_32x32x16_bf16 v[96:111], v[80:83], v[48:51], v[96:111]
    v_mfma_f32_32x32x16_bf16 v[128:143], v[80:83], v[52:55], v[128:143]
    v_mfma_f32_32x32x16_bf16 v[112:127], v[84:87], v[48:51], v[112:127]
    v_mfma_f32_32x32x16_bf16 v[144:159], v[84:87], v[52:55], v[144:159]
    v_mfma_f32_32x32x16_bf16 v[96:111], v[88:91], v[56:59], v[96:111]
    v_mfma_f32_32x32x16_bf16 v[128:143], v[88:91], v[60:63], v[128:143]
    v_mfma_f32_32x32x16_bf16 v[112:127], v[92:95], v[56:59], v[112:127]
    v_mfma_f32_32x32x16_bf16 v[144:159], v[92:95], v[60:63], v[144:159]
    s_mov_b64 exec, s[84:85]
    ds_write_b128 v15, v[20:23]
    ds_write_b128 v15, v[24:27] offset:128
    s_mov_b64 exec, -1
    ds_read_b128 v[160:163], v13 offset:0
    ds_read_b128 v[164:167], v13 offset:32
    ds_read_b128 v[168:171], v13 offset:64
    ds_read_b128 v[172:175], v13 offset:96
    ds_read_b128 v[176:179], v13 offset:128
    ds_read_b128 v[180:183], v13 offset:160
    ds_read_b128 v[184:187], v13 offset:192
    ds_read_b128 v[188:191], v13 offset:224
    s_waitcnt vmcnt(0) lgkmcnt(0)
    v_mov_b32 v210, v209
    v_mov_b32 v211, v209
    v_mov_b32 v209, v208
    v_mov_b32 v214, v213
    v_mov_b32 v215, v213
    v_mov_b32 v213, v212
    v_lshlrev_b32 v64, 16, v192
    v_and_b32 v65, 0xffff0000, v192
    v_lshlrev_b32 v66, 16, v193
    v_and_b32 v67, 0xffff0000, v193
    v_lshlrev_b32 v68, 16, v194
    v_and_b32 v69, 0xffff0000, v194
    v_lshlrev_b32 v70, 16, v195
    v_and_b32 v71, 0xffff0000, v195
    v_lshlrev_b32 v72, 16, v196
    v_and_b32 v73, 0xffff0000, v196
    v_lshlrev_b32 v74, 16, v197
    v_and_b32 v75, 0xffff0000, v197
    v_lshlrev_b32 v76, 16, v198
    v_and_b32 v77, 0xffff0000, v198
    v_lshlrev_b32 v78, 16, v199
    v_and_b32 v79, 0xffff0000, v199
    v_lshlrev_b32 v80, 16, v200
    v_and_b32 v81, 0xffff0000, v200
    v_lshlrev_b32 v82, 16, v201
    v_and_b32 v83, 0xffff0000, v201
    v_lshlrev_b32 v84, 16, v202
    v_and_b32 v85, 0xffff0000, v202
    v_lshlrev_b32 v86, 16, v203
    v_and_b32 v87, 0xffff0000, v203
    v_lshlrev_b32 v88, 16, v204
    v_and_b32 v89, 0xffff0000, v204
    v_lshlrev_b32 v90, 16, v205
    v_and_b32 v91, 0xffff0000, v205
    v_lshlrev_b32 v92, 16, v206
    v_and_b32 v93, 0xffff0000, v206
    v_lshlrev_b32 v94, 16, v207
    v_and_b32 v95, 0xffff0000, v207
    v_pk_fma_f32 v[32:33], v[210:211], v[160:161], v[64:65]
    v_pk_fma_f32 v[34:35], v[210:211], v[162:163], v[66:67]
    v_pk_fma_f32 v[36:37], v[210:211], v[164:165], v[68:69]
    v_pk_fma_f32 v[38:39], v[210:211], v[166:167], v[70:71]
    v_pk_fma_f32 v[40:41], v[210:211], v[168:169], v[72:73]
    v_pk_fma_f32 v[42:43], v[210:211], v[170:171], v[74:75]
    v_pk_fma_f32 v[44:45], v[210:211], v[172:173], v[76:77]
    v_pk_fma_f32 v[46:47], v[210:211], v[174:175], v[78:79]
    v_pk_fma_f32 v[96:97], v[96:97], v[208:209], v[32:33]
    v_pk_fma_f32 v[98:99], v[98:99], v[208:209], v[34:35]
    v_pk_fma_f32 v[100:101], v[100:101], v[208:209], v[36:37]
    v_pk_fma_f32 v[102:103], v[102:103], v[208:209], v[38:39]
    v_pk_fma_f32 v[104:105], v[104:105], v[208:209], v[40:41]
    v_pk_fma_f32 v[106:107], v[106:107], v[208:209], v[42:43]
    v_pk_fma_f32 v[108:109], v[108:109], v[208:209], v[44:45]
    v_pk_fma_f32 v[110:111], v[110:111], v[208:209], v[46:47]
    v_pk_mul_f32 v[32:33], v[96:97], v[96:97]
    v_pk_mul_f32 v[34:35], v[98:99], v[98:99]
    v_pk_mul_f32 v[36:37], v[100:101], v[100:101]
    v_pk_mul_f32 v[38:39], v[102:103], v[102:103]
    v_pk_mul_f32 v[40:41], v[104:105], v[104:105]
    v_pk_mul_f32 v[42:43], v[106:107], v[106:107]
    v_pk_mul_f32 v[44:45], v[108:109], v[108:109]
    v_pk_mul_f32 v[46:47], v[110:111], v[110:111]
    v_pk_fma_f32 v[32:33], v[32:33], v[218:219], v[216:217]
    v_pk_fma_f32 v[34:35], v[34:35], v[218:219], v[216:217]
    v_pk_fma_f32 v[36:37], v[36:37], v[218:219], v[216:217]
    v_pk_fma_f32 v[38:39], v[38:39], v[218:219], v[216:217]
    v_pk_fma_f32 v[40:41], v[40:41], v[218:219], v[216:217]
    v_pk_fma_f32 v[42:43], v[42:43], v[218:219], v[216:217]
    v_pk_fma_f32 v[44:45], v[44:45], v[218:219], v[216:217]
    v_pk_fma_f32 v[46:47], v[46:47], v[218:219], v[216:217]
    v_pk_mul_f32 v[32:33], v[32:33], v[96:97]
    v_pk_mul_f32 v[34:35], v[34:35], v[98:99]
    v_pk_mul_f32 v[36:37], v[36:37], v[100:101]
    v_pk_mul_f32 v[38:39], v[38:39], v[102:103]
    v_pk_mul_f32 v[40:41], v[40:41], v[104:105]
    v_pk_mul_f32 v[42:43], v[42:43], v[106:107]
    v_pk_mul_f32 v[44:45], v[44:45], v[108:109]
    v_pk_mul_f32 v[46:47], v[46:47], v[110:111]
    v_exp_f32 v32, v32
    v_exp_f32 v33, v33
    v_exp_f32 v34, v34
    v_exp_f32 v35, v35
    v_exp_f32 v36, v36
    v_exp_f32 v37, v37
    v_exp_f32 v38, v38
    v_exp_f32 v39, v39
    v_exp_f32 v40, v40
    v_exp_f32 v41, v41
    v_exp_f32 v42, v42
    v_exp_f32 v43, v43
    v_exp_f32 v44, v44
    v_exp_f32 v45, v45
    v_exp_f32 v46, v46
    v_exp_f32 v47, v47
    v_pk_add_f32 v[32:33], v[32:33], v[220:221]
    v_pk_add_f32 v[34:35], v[34:35], v[220:221]
    v_pk_add_f32 v[36:37], v[36:37], v[220:221]
    v_pk_add_f32 v[38:39], v[38:39], v[220:221]
    v_pk_add_f32 v[40:41], v[40:41], v[220:221]
    v_pk_add_f32 v[42:43], v[42:43], v[220:221]
    v_pk_add_f32 v[44:45], v[44:45], v[220:221]
    v_pk_add_f32 v[46:47], v[46:47], v[220:221]
    v_rcp_f32 v32, v32
    v_rcp_f32 v33, v33
    v_rcp_f32 v34, v34
    v_rcp_f32 v35, v35
    v_rcp_f32 v36, v36
    v_rcp_f32 v37, v37
    v_rcp_f32 v38, v38
    v_rcp_f32 v39, v39
    v_rcp_f32 v40, v40
    v_rcp_f32 v41, v41
    v_rcp_f32 v42, v42
    v_rcp_f32 v43, v43
    v_rcp_f32 v44, v44
    v_rcp_f32 v45, v45
    v_rcp_f32 v46, v46
    v_rcp_f32 v47, v47
    v_pk_mul_f32 v[96:97], v[96:97], v[32:33]
    v_pk_mul_f32 v[98:99], v[98:99], v[34:35]
    v_pk_mul_f32 v[100:101], v[100:101], v[36:37]
    v_pk_mul_f32 v[102:103], v[102:103], v[38:39]
    v_pk_mul_f32 v[104:105], v[104:105], v[40:41]
    v_pk_mul_f32 v[106:107], v[106:107], v[42:43]
    v_pk_mul_f32 v[108:109], v[108:109], v[44:45]
    v_pk_mul_f32 v[110:111], v[110:111], v[46:47]
    v_cvt_pk_bf16_f32 v96, v96, v97
    v_cvt_pk_bf16_f32 v97, v98, v99
    v_cvt_pk_bf16_f32 v98, v100, v101
    v_cvt_pk_bf16_f32 v99, v102, v103
    v_cvt_pk_bf16_f32 v100, v104, v105
    v_cvt_pk_bf16_f32 v101, v106, v107
    v_cvt_pk_bf16_f32 v102, v108, v109
    v_cvt_pk_bf16_f32 v103, v110, v111
    s_add_u32 s56, s59, 0
    s_cmp_eq_u32 s3, 0
    s_cbranch_scc1 L_hs8_slow
    buffer_store_dwordx4 v[96:99], v4, s[28:31], s56 offen
    buffer_store_dwordx4 v[100:103], v4, s[28:31], s56 offen offset:1024
    s_branch L_hs8_done
L_hs8_slow:
    buffer_store_dwordx4 v[96:99], v4, s[28:31], s56 offen sc1
    buffer_store_dwordx4 v[100:103], v4, s[28:31], s56 offen offset:1024 sc1
L_hs8_done:
    v_pk_fma_f32 v[48:49], v[214:215], v[160:161], v[64:65]
    v_pk_fma_f32 v[50:51], v[214:215], v[162:163], v[66:67]
    v_pk_fma_f32 v[52:53], v[214:215], v[164:165], v[68:69]
    v_pk_fma_f32 v[54:55], v[214:215], v[166:167], v[70:71]
    v_pk_fma_f32 v[56:57], v[214:215], v[168:169], v[72:73]
    v_pk_fma_f32 v[58:59], v[214:215], v[170:171], v[74:75]
    v_pk_fma_f32 v[60:61], v[214:215], v[172:173], v[76:77]
    v_pk_fma_f32 v[62:63], v[214:215], v[174:175], v[78:79]
    v_pk_fma_f32 v[128:129], v[128:129], v[212:213], v[48:49]
    v_pk_fma_f32 v[130:131], v[130:131], v[212:213], v[50:51]
    v_pk_fma_f32 v[132:133], v[132:133], v[212:213], v[52:53]
    v_pk_fma_f32 v[134:135], v[134:135], v[212:213], v[54:55]
    v_pk_fma_f32 v[136:137], v[136:137], v[212:213], v[56:57]
    v_pk_fma_f32 v[138:139], v[138:139], v[212:213], v[58:59]
    v_pk_fma_f32 v[140:141], v[140:141], v[212:213], v[60:61]
    v_pk_fma_f32 v[142:143], v[142:143], v[212:213], v[62:63]
    v_pk_mul_f32 v[48:49], v[128:129], v[128:129]
    v_pk_mul_f32 v[50:51], v[130:131], v[130:131]
    v_pk_mul_f32 v[52:53], v[132:133], v[132:133]
    v_pk_mul_f32 v[54:55], v[134:135], v[134:135]
    v_pk_mul_f32 v[56:57], v[136:137], v[136:137]
    v_pk_mul_f32 v[58:59], v[138:139], v[138:139]
    v_pk_mul_f32 v[60:61], v[140:141], v[140:141]
    v_pk_mul_f32 v[62:63], v[142:143], v[142:143]
    v_pk_fma_f32 v[48:49], v[48:49], v[218:219], v[216:217]
    v_pk_fma_f32 v[50:51], v[50:51], v[218:219], v[216:217]
    v_pk_fma_f32 v[52:53], v[52:53], v[218:219], v[216:217]
    v_pk_fma_f32 v[54:55], v[54:55], v[218:219], v[216:217]
    v_pk_fma_f32 v[56:57], v[56:57], v[218:219], v[216:217]
    v_pk_fma_f32 v[58:59], v[58:59], v[218:219], v[216:217]
    v_pk_fma_f32 v[60:61], v[60:61], v[218:219], v[216:217]
    v_pk_fma_f32 v[62:63], v[62:63], v[218:219], v[216:217]
    v_pk_mul_f32 v[48:49], v[48:49], v[128:129]
    v_pk_mul_f32 v[50:51], v[50:51], v[130:131]
    v_pk_mul_f32 v[52:53], v[52:53], v[132:133]
    v_pk_mul_f32 v[54:55], v[54:55], v[134:135]
    v_pk_mul_f32 v[56:57], v[56:57], v[136:137]
    v_pk_mul_f32 v[58:59], v[58:59], v[138:139]
    v_pk_mul_f32 v[60:61], v[60:61], v[140:141]
    v_pk_mul_f32 v[62:63], v[62:63], v[142:143]
    v_exp_f32 v48, v48
    v_exp_f32 v49, v49
    v_exp_f32 v50, v50
    v_exp_f32 v51, v51
    v_exp_f32 v52, v52
    v_exp_f32 v53, v53
    v_exp_f32 v54, v54
    v_exp_f32 v55, v55
    v_exp_f32 v56, v56
    v_exp_f32 v57, v57
    v_exp_f32 v58, v58
    v_exp_f32 v59, v59
    v_exp_f32 v60, v60
    v_exp_f32 v61, v61
    v_exp_f32 v62, v62
    v_exp_f32 v63, v63
    v_pk_add_f32 v[48:49], v[48:49], v[220:221]
    v_pk_add_f32 v[50:51], v[50:51], v[220:221]
    v_pk_add_f32 v[52:53], v[52:53], v[220:221]
    v_pk_add_f32 v[54:55], v[54:55], v[220:221]
    v_pk_add_f32 v[56:57], v[56:57], v[220:221]
    v_pk_add_f32 v[58:59], v[58:59], v[220:221]
    v_pk_add_f32 v[60:61], v[60:61], v[220:221]
    v_pk_add_f32 v[62:63], v[62:63], v[220:221]
    v_rcp_f32 v48, v48
    v_rcp_f32 v49, v49
    v_rcp_f32 v50, v50
    v_rcp_f32 v51, v51
    v_rcp_f32 v52, v52
    v_rcp_f32 v53, v53
    v_rcp_f32 v54, v54
    v_rcp_f32 v55, v55
    v_rcp_f32 v56, v56
    v_rcp_f32 v57, v57
    v_rcp_f32 v58, v58
    v_rcp_f32 v59, v59
    v_rcp_f32 v60, v60
    v_rcp_f32 v61, v61
    v_rcp_f32 v62, v62
    v_rcp_f32 v63, v63
    v_pk_mul_f32 v[128:129], v[128:129], v[48:49]
    v_pk_mul_f32 v[130:131], v[130:131], v[50:51]
    v_pk_mul_f32 v[132:133], v[132:133], v[52:53]
    v_pk_mul_f32 v[134:135], v[134:135], v[54:55]
    v_pk_mul_f32 v[136:137], v[136:137], v[56:57]
    v_pk_mul_f32 v[138:139], v[138:139], v[58:59]
    v_pk_mul_f32 v[140:141], v[140:141], v[60:61]
    v_pk_mul_f32 v[142:143], v[142:143], v[62:63]
    v_cvt_pk_bf16_f32 v128, v128, v129
    v_cvt_pk_bf16_f32 v129, v130, v131
    v_cvt_pk_bf16_f32 v130, v132, v133
    v_cvt_pk_bf16_f32 v131, v134, v135
    v_cvt_pk_bf16_f32 v132, v136, v137
    v_cvt_pk_bf16_f32 v133, v138, v139
    v_cvt_pk_bf16_f32 v134, v140, v141
    v_cvt_pk_bf16_f32 v135, v142, v143
    s_add_u32 s56, s59, 114688
    s_cmp_eq_u32 s3, 0
    s_cbranch_scc1 L_hs9_slow
    buffer_store_dwordx4 v[128:131], v4, s[28:31], s56 offen
    buffer_store_dwordx4 v[132:135], v4, s[28:31], s56 offen offset:1024
    s_branch L_hs9_done
L_hs9_slow:
    buffer_store_dwordx4 v[128:131], v4, s[28:31], s56 offen sc1
    buffer_store_dwordx4 v[132:135], v4, s[28:31], s56 offen offset:1024 sc1
L_hs9_done:
    v_pk_fma_f32 v[32:33], v[210:211], v[176:177], v[80:81]
    v_pk_fma_f32 v[34:35], v[210:211], v[178:179], v[82:83]
    v_pk_fma_f32 v[36:37], v[210:211], v[180:181], v[84:85]
    v_pk_fma_f32 v[38:39], v[210:211], v[182:183], v[86:87]
    v_pk_fma_f32 v[40:41], v[210:211], v[184:185], v[88:89]
    v_pk_fma_f32 v[42:43], v[210:211], v[186:187], v[90:91]
    v_pk_fma_f32 v[44:45], v[210:211], v[188:189], v[92:93]
    v_pk_fma_f32 v[46:47], v[210:211], v[190:191], v[94:95]
    v_pk_fma_f32 v[112:113], v[112:113], v[208:209], v[32:33]
    v_pk_fma_f32 v[114:115], v[114:115], v[208:209], v[34:35]
    v_pk_fma_f32 v[116:117], v[116:117], v[208:209], v[36:37]
    v_pk_fma_f32 v[118:119], v[118:119], v[208:209], v[38:39]
    v_pk_fma_f32 v[120:121], v[120:121], v[208:209], v[40:41]
    v_pk_fma_f32 v[122:123], v[122:123], v[208:209], v[42:43]
    v_pk_fma_f32 v[124:125], v[124:125], v[208:209], v[44:45]
    v_pk_fma_f32 v[126:127], v[126:127], v[208:209], v[46:47]
    v_pk_mul_f32 v[32:33], v[112:113], v[112:113]
    v_pk_mul_f32 v[34:35], v[114:115], v[114:115]
    v_pk_mul_f32 v[36:37], v[116:117], v[116:117]
    v_pk_mul_f32 v[38:39], v[118:119], v[118:119]
    v_pk_mul_f32 v[40:41], v[120:121], v[120:121]
    v_pk_mul_f32 v[42:43], v[122:123], v[122:123]
    v_pk_mul_f32 v[44:45], v[124:125], v[124:125]
    v_pk_mul_f32 v[46:47], v[126:127], v[126:127]
    v_pk_fma_f32 v[32:33], v[32:33], v[218:219], v[216:217]
    v_pk_fma_f32 v[34:35], v[34:35], v[218:219], v[216:217]
    v_pk_fma_f32 v[36:37], v[36:37], v[218:219], v[216:217]
    v_pk_fma_f32 v[38:39], v[38:39], v[218:219], v[216:217]
    v_pk_fma_f32 v[40:41], v[40:41], v[218:219], v[216:217]
    v_pk_fma_f32 v[42:43], v[42:43], v[218:219], v[216:217]
    v_pk_fma_f32 v[44:45], v[44:45], v[218:219], v[216:217]
    v_pk_fma_f32 v[46:47], v[46:47], v[218:219], v[216:217]
    v_pk_mul_f32 v[32:33], v[32:33], v[112:113]
    v_pk_mul_f32 v[34:35], v[34:35], v[114:115]
    v_pk_mul_f32 v[36:37], v[36:37], v[116:117]
    v_pk_mul_f32 v[38:39], v[38:39], v[118:119]
    v_pk_mul_f32 v[40:41], v[40:41], v[120:121]
    v_pk_mul_f32 v[42:43], v[42:43], v[122:123]
    v_pk_mul_f32 v[44:45], v[44:45], v[124:125]
    v_pk_mul_f32 v[46:47], v[46:47], v[126:127]
    v_exp_f32 v32, v32
    v_exp_f32 v33, v33
    v_exp_f32 v34, v34
    v_exp_f32 v35, v35
    v_exp_f32 v36, v36
    v_exp_f32 v37, v37
    v_exp_f32 v38, v38
    v_exp_f32 v39, v39
    v_exp_f32 v40, v40
    v_exp_f32 v41, v41
    v_exp_f32 v42, v42
    v_exp_f32 v43, v43
    v_exp_f32 v44, v44
    v_exp_f32 v45, v45
    v_exp_f32 v46, v46
    v_exp_f32 v47, v47
    v_pk_add_f32 v[32:33], v[32:33], v[220:221]
    v_pk_add_f32 v[34:35], v[34:35], v[220:221]
    v_pk_add_f32 v[36:37], v[36:37], v[220:221]
    v_pk_add_f32 v[38:39], v[38:39], v[220:221]
    v_pk_add_f32 v[40:41], v[40:41], v[220:221]
    v_pk_add_f32 v[42:43], v[42:43], v[220:221]
    v_pk_add_f32 v[44:45], v[44:45], v[220:221]
    v_pk_add_f32 v[46:47], v[46:47], v[220:221]
    v_rcp_f32 v32, v32
    v_rcp_f32 v33, v33
    v_rcp_f32 v34, v34
    v_rcp_f32 v35, v35
    v_rcp_f32 v36, v36
    v_rcp_f32 v37, v37
    v_rcp_f32 v38, v38
    v_rcp_f32 v39, v39
    v_rcp_f32 v40, v40
    v_rcp_f32 v41, v41
    v_rcp_f32 v42, v42
    v_rcp_f32 v43, v43
    v_rcp_f32 v44, v44
    v_rcp_f32 v45, v45
    v_rcp_f32 v46, v46
    v_rcp_f32 v47, v47
    v_pk_mul_f32 v[112:113], v[112:113], v[32:33]
    v_pk_mul_f32 v[114:115], v[114:115], v[34:35]
    v_pk_mul_f32 v[116:117], v[116:117], v[36:37]
    v_pk_mul_f32 v[118:119], v[118:119], v[38:39]
    v_pk_mul_f32 v[120:121], v[120:121], v[40:41]
    v_pk_mul_f32 v[122:123], v[122:123], v[42:43]
    v_pk_mul_f32 v[124:125], v[124:125], v[44:45]
    v_pk_mul_f32 v[126:127], v[126:127], v[46:47]
    v_cvt_pk_bf16_f32 v112, v112, v113
    v_cvt_pk_bf16_f32 v113, v114, v115
    v_cvt_pk_bf16_f32 v114, v116, v117
    v_cvt_pk_bf16_f32 v115, v118, v119
    v_cvt_pk_bf16_f32 v116, v120, v121
    v_cvt_pk_bf16_f32 v117, v122, v123
    v_cvt_pk_bf16_f32 v118, v124, v125
    v_cvt_pk_bf16_f32 v119, v126, v127
    s_add_u32 s56, s59, 2048
    s_cmp_eq_u32 s3, 0
    s_cbranch_scc1 L_hs10_slow
    buffer_store_dwordx4 v[112:115], v4, s[28:31], s56 offen
    buffer_store_dwordx4 v[116:119], v4, s[28:31], s56 offen offset:1024
    s_branch L_hs10_done
L_hs10_slow:
    buffer_store_dwordx4 v[112:115], v4, s[28:31], s56 offen sc1
    buffer_store_dwordx4 v[116:119], v4, s[28:31], s56 offen offset:1024 sc1
L_hs10_done:
    v_pk_fma_f32 v[48:49], v[214:215], v[176:177], v[80:81]
    v_pk_fma_f32 v[50:51], v[214:215], v[178:179], v[82:83]
    v_pk_fma_f32 v[52:53], v[214:215], v[180:181], v[84:85]
    v_pk_fma_f32 v[54:55], v[214:215], v[182:183], v[86:87]
    v_pk_fma_f32 v[56:57], v[214:215], v[184:185], v[88:89]
    v_pk_fma_f32 v[58:59], v[214:215], v[186:187], v[90:91]
    v_pk_fma_f32 v[60:61], v[214:215], v[188:189], v[92:93]
    v_pk_fma_f32 v[62:63], v[214:215], v[190:191], v[94:95]
    v_pk_fma_f32 v[144:145], v[144:145], v[212:213], v[48:49]
    v_pk_fma_f32 v[146:147], v[146:147], v[212:213], v[50:51]
    v_pk_fma_f32 v[148:149], v[148:149], v[212:213], v[52:53]
    v_pk_fma_f32 v[150:151], v[150:151], v[212:213], v[54:55]
    v_pk_fma_f32 v[152:153], v[152:153], v[212:213], v[56:57]
    v_pk_fma_f32 v[154:155], v[154:155], v[212:213], v[58:59]
    v_pk_fma_f32 v[156:157], v[156:157], v[212:213], v[60:61]
    v_pk_fma_f32 v[158:159], v[158:159], v[212:213], v[62:63]
    v_pk_mul_f32 v[48:49], v[144:145], v[144:145]
    v_pk_mul_f32 v[50:51], v[146:147], v[146:147]
    v_pk_mul_f32 v[52:53], v[148:149], v[148:149]
    v_pk_mul_f32 v[54:55], v[150:151], v[150:151]
    v_pk_mul_f32 v[56:57], v[152:153], v[152:153]
    v_pk_mul_f32 v[58:59], v[154:155], v[154:155]
    v_pk_mul_f32 v[60:61], v[156:157], v[156:157]
    v_pk_mul_f32 v[62:63], v[158:159], v[158:159]
    v_pk_fma_f32 v[48:49], v[48:49], v[218:219], v[216:217]
    v_pk_fma_f32 v[50:51], v[50:51], v[218:219], v[216:217]
    v_pk_fma_f32 v[52:53], v[52:53], v[218:219], v[216:217]
    v_pk_fma_f32 v[54:55], v[54:55], v[218:219], v[216:217]
    v_pk_fma_f32 v[56:57], v[56:57], v[218:219], v[216:217]
    v_pk_fma_f32 v[58:59], v[58:59], v[218:219], v[216:217]
    v_pk_fma_f32 v[60:61], v[60:61], v[218:219], v[216:217]
    v_pk_fma_f32 v[62:63], v[62:63], v[218:219], v[216:217]
    v_pk_mul_f32 v[48:49], v[48:49], v[144:145]
    v_pk_mul_f32 v[50:51], v[50:51], v[146:147]
    v_pk_mul_f32 v[52:53], v[52:53], v[148:149]
    v_pk_mul_f32 v[54:55], v[54:55], v[150:151]
    v_pk_mul_f32 v[56:57], v[56:57], v[152:153]
    v_pk_mul_f32 v[58:59], v[58:59], v[154:155]
    v_pk_mul_f32 v[60:61], v[60:61], v[156:157]
    v_pk_mul_f32 v[62:63], v[62:63], v[158:159]
    v_exp_f32 v48, v48
    v_exp_f32 v49, v49
    v_exp_f32 v50, v50
    v_exp_f32 v51, v51
    v_exp_f32 v52, v52
    v_exp_f32 v53, v53
    v_exp_f32 v54, v54
    v_exp_f32 v55, v55
    v_exp_f32 v56, v56
    v_exp_f32 v57, v57
    v_exp_f32 v58, v58
    v_exp_f32 v59, v59
    v_exp_f32 v60, v60
    v_exp_f32 v61, v61
    v_exp_f32 v62, v62
    v_exp_f32 v63, v63
    v_pk_add_f32 v[48:49], v[48:49], v[220:221]
    v_pk_add_f32 v[50:51], v[50:51], v[220:221]
    v_pk_add_f32 v[52:53], v[52:53], v[220:221]
    v_pk_add_f32 v[54:55], v[54:55], v[220:221]
    v_pk_add_f32 v[56:57], v[56:57], v[220:221]
    v_pk_add_f32 v[58:59], v[58:59], v[220:221]
    v_pk_add_f32 v[60:61], v[60:61], v[220:221]
    v_pk_add_f32 v[62:63], v[62:63], v[220:221]
    v_rcp_f32 v48, v48
    v_rcp_f32 v49, v49
    v_rcp_f32 v50, v50
    v_rcp_f32 v51, v51
    v_rcp_f32 v52, v52
    v_rcp_f32 v53, v53
    v_rcp_f32 v54, v54
    v_rcp_f32 v55, v55
    v_rcp_f32 v56, v56
    v_rcp_f32 v57, v57
    v_rcp_f32 v58, v58
    v_rcp_f32 v59, v59
    v_rcp_f32 v60, v60
    v_rcp_f32 v61, v61
    v_rcp_f32 v62, v62
    v_rcp_f32 v63, v63
    v_pk_mul_f32 v[144:145], v[144:145], v[48:49]
    v_pk_mul_f32 v[146:147], v[146:147], v[50:51]
    v_pk_mul_f32 v[148:149], v[148:149], v[52:53]
    v_pk_mul_f32 v[150:151], v[150:151], v[54:55]
    v_pk_mul_f32 v[152:153], v[152:153], v[56:57]
    v_pk_mul_f32 v[154:155], v[154:155], v[58:59]
    v_pk_mul_f32 v[156:157], v[156:157], v[60:61]
    v_pk_mul_f32 v[158:159], v[158:159], v[62:63]
    v_cvt_pk_bf16_f32 v144, v144, v145
    v_cvt_pk_bf16_f32 v145, v146, v147
    v_cvt_pk_bf16_f32 v146, v148, v149
    v_cvt_pk_bf16_f32 v147, v150, v151
    v_cvt_pk_bf16_f32 v148, v152, v153
    v_cvt_pk_bf16_f32 v149, v154, v155
    v_cvt_pk_bf16_f32 v150, v156, v157
    v_cvt_pk_bf16_f32 v151, v158, v159
    s_add_u32 s56, s59, 116736
    s_cmp_eq_u32 s3, 0
    s_cbranch_scc1 L_hs11_slow
    buffer_store_dwordx4 v[144:147], v4, s[28:31], s56 offen
    buffer_store_dwordx4 v[148:151], v4, s[28:31], s56 offen offset:1024
    s_branch L_hs11_done
L_hs11_slow:
    buffer_store_dwordx4 v[144:147], v4, s[28:31], s56 offen sc1
    buffer_store_dwordx4 v[148:151], v4, s[28:31], s56 offen offset:1024 sc1
L_hs11_done:
    s_waitcnt vmcnt(0)
    v_mov_b32 v228, 163784
    v_mov_b32 v229, 1
    s_mov_b64 exec, 1
    ds_add_rtn_u32 v229, v228, v229
    s_waitcnt lgkmcnt(0)
    v_readfirstlane_b32 s56, v229
    s_mov_b64 exec, -1
    s_cmp_lg_u32 s56, 3
    s_cbranch_scc1 L_h4a_np
    s_lshl_b32 s55, s47, 12
    s_add_u32 s55, s55, 6359040
    s_lshl_b32 s56, s48, 2
    s_add_u32 s55, s55, s56
    v_mov_b32 v228, 0
    v_mov_b32 v229, s10
    s_mov_b64 exec, 1
    s_cmp_eq_u32 s3, 0
    s_cbranch_scc1 L_hs12_slow
    buffer_store_dword v229, v228, s[28:31], s55 offen
    s_branch L_hs12_done
L_hs12_slow:
    buffer_store_dword v229, v228, s[28:31], s55 offen sc1
L_hs12_done:
    s_mov_b64 exec, -1
L_h4a_np:
    s_mov_b32 s40, s18
    s_and_b32 s41, s19, 0xffff
    s_mov_b32 s42, 1024
    s_mov_b32 s43, 0x20000
    s_mov_b32 s36, s20
    s_and_b32 s37, s21, 0xffff
    s_mov_b32 s38, 2097152
    s_mov_b32 s39, 0x20000
    v_lshlrev_b32 v13, 3, v3
    s_lshl_b32 s55, s50, 7
    s_lshl_b32 s56, s46, 6
    s_add_u32 s55, s55, s56
    buffer_load_dwordx2 v[24:25], v13, s[40:43], s55 offen offset:0
    buffer_load_dwordx2 v[26:27], v13, s[40:43], s55 offen offset:16
    buffer_load_dwordx2 v[28:29], v13, s[40:43], s55 offen offset:32
    buffer_load_dwordx2 v[30:31], v13, s[40:43], s55 offen offset:48
    s_lshl_b32 s55, s45, 12
    s_add_u32 s55, s55, 106496
    v_add_u32 v6, s55, v4
    v_and_b32 v12, 15, v1
    v_lshrrev_b32 v13, 2, v12
    v_lshl_add_u32 v13, v3, 2, v13
    v_lshlrev_b32 v13, 7, v13
    v_lshrrev_b32 v14, 3, v12
    v_xor_b32 v14, s46, v14
    v_lshl_add_u32 v13, v14, 6, v13
    v_bfe_u32 v14, v1, 4, 1
    v_lshl_add_u32 v13, v14, 5, v13
    v_and_b32 v14, 3, v12
    v_lshl_add_u32 v7, v14, 3, v13
    v_add_u32 v8, 65536, v7
    v_mov_b32 v96, 0
    v_mov_b32 v97, 0
    v_mov_b32 v98, 0
    v_mov_b32 v99, 0
    v_mov_b32 v100, 0
    v_mov_b32 v101, 0
    v_mov_b32 v102, 0
    v_mov_b32 v103, 0
    v_mov_b32 v104, 0
    v_mov_b32 v105, 0
    v_mov_b32 v106, 0
    v_mov_b32 v107, 0
    v_mov_b32 v108, 0
    v_mov_b32 v109, 0
    v_mov_b32 v110, 0
    v_mov_b32 v111, 0
    s_waitcnt vmcnt(0)
    v_lshlrev_b32 v112, 16, v232
    v_and_b32 v113, 0xffff0000, v232
    v_lshlrev_b32 v114, 16, v233
    v_and_b32 v115, 0xffff0000, v233
    v_lshlrev_b32 v116, 16, v234
    v_and_b32 v117, 0xffff0000, v234
    v_lshlrev_b32 v118, 16, v235
    v_and_b32 v119, 0xffff0000, v235
    v_lshlrev_b32 v120, 16, v236
    v_and_b32 v121, 0xffff0000, v236
    v_lshlrev_b32 v122, 16, v237
    v_and_b32 v123, 0xffff0000, v237
    v_lshlrev_b32 v124, 16, v238
    v_and_b32 v125, 0xffff0000, v238
    v_lshlrev_b32 v126, 16, v239
    v_and_b32 v127, 0xffff0000, v239
    v_lshlrev_b32 v32, 16, v24
    v_and_b32 v33, 0xffff0000, v24
    v_lshlrev_b32 v34, 16, v25
    v_and_b32 v35, 0xffff0000, v25
    v_lshlrev_b32 v36, 16, v26
    v_and_b32 v37, 0xffff0000, v26
    v_lshlrev_b32 v38, 16, v27
    v_and_b32 v39, 0xffff0000, v27
    v_lshlrev_b32 v40, 16, v28
    v_and_b32 v41, 0xffff0000, v28
    v_lshlrev_b32 v42, 16, v29
    v_and_b32 v43, 0xffff0000, v29
    v_lshlrev_b32 v44, 16, v30
    v_and_b32 v45, 0xffff0000, v30
    v_lshlrev_b32 v46, 16, v31
    v_and_b32 v47, 0xffff0000, v31
    v_add_f32 v96, v112, v32
    v_add_f32 v97, v113, v33
    v_add_f32 v98, v114, v34
    v_add_f32 v99, v115, v35
    v_add_f32 v100, v116, v36
    v_add_f32 v101, v117, v37
    v_add_f32 v102, v118, v38
    v_add_f32 v103, v119, v39
    v_add_f32 v104, v120, v40
    v_add_f32 v105, v121, v41
    v_add_f32 v106, v122, v42
    v_add_f32 v107, v123, v43
    v_add_f32 v108, v124, v44
    v_add_f32 v109, v125, v45
    v_add_f32 v110, v126, v46
    v_add_f32 v111, v127, v47
    s_cmp_lg_u32 s44, 0
    s_cbranch_scc1 L_h4b24_x
    s_lshl_b32 s55, s47, 12
    s_add_u32 s55, s55, 6359040
    v_min_u32 v228, 13, v1
    v_lshlrev_b32 v228, 2, v228
    s_mov_b32 s26, 0
L_h4b24_p:
    buffer_load_dword v229, v228, s[28:31], s55 offen sc1
    s_add_u32 s26, s26, 1
    s_cmp_ge_u32 s26, 0x100000
    s_cbranch_scc1 L_h4b24_x
    s_waitcnt vmcnt(0)
    v_cmp_ne_u32 vcc, s10, v229
    s_cbranch_vccz L_h4b24_x
    s_sleep 1
    s_branch L_h4b24_p
L_h4b24_x:
    s_barrier
    s_barrier
    ds_read_b128 v[32:35], v6 offset:0
    ds_read_b64_tr_b16 v[64:65], v8 offset:24576
    ds_read_b64_tr_b16 v[66:67], v8 offset:25600
    ds_read_b128 v[36:39], v6 offset:1024
    ds_read_b64_tr_b16 v[68:69], v8 offset:26624
    ds_read_b64_tr_b16 v[70:71], v8 offset:27648
    ds_read_b128 v[40:43], v6 offset:2048
    ds_read_b64_tr_b16 v[72:73], v8 offset:28672
    ds_read_b64_tr_b16 v[74:75], v8 offset:29696
    ds_read_b128 v[44:47], v6 offset:3072
    ds_read_b64_tr_b16 v[76:77], v8 offset:30720
    ds_read_b64_tr_b16 v[78:79], v8 offset:31744
    s_waitcnt lgkmcnt(0)
    s_barrier
    v_mfma_f32_32x32x16_bf16 v[96:111], v[64:67], v[32:35], v[96:111]
    ds_read_b128 v[48:51], v6 offset:8192
    ds_read_b64_tr_b16 v[80:81], v8 offset:32768
    ds_read_b64_tr_b16 v[82:83], v8 offset:33792
    ds_read_b128 v[52:55], v6 offset:9216
    ds_read_b64_tr_b16 v[84:85], v8 offset:34816
    ds_read_b64_tr_b16 v[86:87], v8 offset:35840
    v_mfma_f32_32x32x16_bf16 v[96:111], v[68:71], v[36:39], v[96:111]
    ds_read_b128 v[56:59], v6 offset:10240
    ds_read_b64_tr_b16 v[88:89], v8 offset:36864
    ds_read_b64_tr_b16 v[90:91], v8 offset:37888
    ds_read_b128 v[60:63], v6 offset:11264
    ds_read_b64_tr_b16 v[92:93], v8 offset:38912
    ds_read_b64_tr_b16 v[94:95], v8 offset:39936
    v_mfma_f32_32x32x16_bf16 v[96:111], v[72:75], v[40:43], v[96:111]
    v_mfma_f32_32x32x16_bf16 v[96:111], v[76:79], v[44:47], v[96:111]
    s_waitcnt lgkmcnt(0)
    s_barrier
    v_mfma_f32_32x32x16_bf16 v[96:111], v[80:83], v[48:51], v[96:111]
    ds_read_b128 v[32:35], v6 offset:16384
    ds_read_b64_tr_b16 v[64:65], v7 offset:0
    ds_read_b64_tr_b16 v[66:67], v7 offset:1024
    ds_read_b128 v[36:39], v6 offset:17408
    ds_read_b64_tr_b16 v[68:69], v7 offset:2048
    ds_read_b64_tr_b16 v[70:71], v7 offset:3072
    v_mfma_f32_32x32x16_bf16 v[96:111], v[84:87], v[52:55], v[96:111]
    ds_read_b128 v[40:43], v6 offset:18432
    ds_read_b64_tr_b16 v[72:73], v7 offset:4096
    ds_read_b64_tr_b16 v[74:75], v7 offset:5120
    ds_read_b128 v[44:47], v6 offset:19456
    ds_read_b64_tr_b16 v[76:77], v7 offset:6144
    ds_read_b64_tr_b16 v[78:79], v7 offset:7168
    v_mfma_f32_32x32x16_bf16 v[96:111], v[88:91], v[56:59], v[96:111]
    v_mfma_f32_32x32x16_bf16 v[96:111], v[92:95], v[60:63], v[96:111]
    s_waitcnt lgkmcnt(0)
    s_barrier
    v_mfma_f32_32x32x16_bf16 v[96:111], v[64:67], v[32:35], v[96:111]
    ds_read_b128 v[48:51], v6 offset:24576
    ds_read_b64_tr_b16 v[80:81], v7 offset:8192
    ds_read_b64_tr_b16 v[82:83], v7 offset:9216
    ds_read_b128 v[52:55], v6 offset:25600
    ds_read_b64_tr_b16 v[84:85], v7 offset:10240
    ds_read_b64_tr_b16 v[86:87], v7 offset:11264
    v_mfma_f32_32x32x16_bf16 v[96:111], v[68:71], v[36:39], v[96:111]
    ds_read_b128 v[56:59], v6 offset:26624
    ds_read_b64_tr_b16 v[88:89], v7 offset:12288
    ds_read_b64_tr_b16 v[90:91], v7 offset:13312
    ds_read_b128 v[60:63], v6 offset:27648
    ds_read_b64_tr_b16 v[92:93], v7 offset:14336
    ds_read_b64_tr_b16 v[94:95], v7 offset:15360
    v_mfma_f32_32x32x16_bf16 v[96:111], v[72:75], v[40:43], v[96:111]
    v_mfma_f32_32x32x16_bf16 v[96:111], v[76:79], v[44:47], v[96:111]
    s_waitcnt lgkmcnt(0)
    s_barrier
    v_mfma_f32_32x32x16_bf16 v[96:111], v[80:83], v[48:51], v[96:111]
    ds_read_b128 v[32:35], v6 offset:32768
    ds_read_b64_tr_b16 v[64:65], v7 offset:16384
    ds_read_b64_tr_b16 v[66:67], v7 offset:17408
    ds_read_b128 v[36:39], v6 offset:33792
    ds_read_b64_tr_b16 v[68:69], v7 offset:18432
    ds_read_b64_tr_b16 v[70:71], v7 offset:19456
    v_mfma_f32_32x32x16_bf16 v[96:111], v[84:87], v[52:55], v[96:111]
    ds_read_b128 v[40:43], v6 offset:34816
    ds_read_b64_tr_b16 v[72:73], v7 offset:20480
    ds_read_b64_tr_b16 v[74:75], v7 offset:21504
    ds_read_b128 v[44:47], v6 offset:35840
    ds_read_b64_tr_b16 v[76:77], v7 offset:22528
    ds_read_b64_tr_b16 v[78:79], v7 offset:23552
    v_mfma_f32_32x32x16_bf16 v[96:111], v[88:91], v[56:59], v[96:111]
    v_mfma_f32_32x32x16_bf16 v[96:111], v[92:95], v[60:63], v[96:111]
    s_waitcnt lgkmcnt(0)
    s_barrier
    v_mfma_f32_32x32x16_bf16 v[96:111], v[64:67], v[32:35], v[96:111]
    ds_read_b128 v[48:51], v6 offset:40960
    ds_read_b64_tr_b16 v[80:81], v7 offset:24576
    ds_read_b64_tr_b16 v[82:83], v7 offset:25600
    ds_read_b128 v[52:55], v6 offset:41984
    ds_read_b64_tr_b16 v[84:85], v7 offset:26624
    ds_read_b64_tr_b16 v[86:87], v7 offset:27648
    v_mfma_f32_32x32x16_bf16 v[96:111], v[68:71], v[36:39], v[96:111]
    ds_read_b128 v[56:59], v6 offset:43008
    ds_read_b64_tr_b16 v[88:89], v7 offset:28672
    ds_read_b64_tr_b16 v[90:91], v7 offset:29696
    ds_read_b128 v[60:63], v6 offset:44032
    ds_read_b64_tr_b16 v[92:93], v7 offset:30720
    ds_read_b64_tr_b16 v[94:95], v7 offset:31744
    v_mfma_f32_32x32x16_bf16 v[96:111], v[72:75], v[40:43], v[96:111]
    v_mfma_f32_32x32x16_bf16 v[96:111], v[76:79], v[44:47], v[96:111]
    s_waitcnt lgkmcnt(0)
    s_barrier
    v_mfma_f32_32x32x16_bf16 v[96:111], v[80:83], v[48:51], v[96:111]
    ds_read_b128 v[32:35], v6 offset:0
    ds_read_b64_tr_b16 v[64:65], v7 offset:32768
    ds_read_b64_tr_b16 v[66:67], v7 offset:33792
    ds_read_b128 v[36:39], v6 offset:1024
    ds_read_b64_tr_b16 v[68:69], v7 offset:34816
    ds_read_b64_tr_b16 v[70:71], v7 offset:35840
    v_mfma_f32_32x32x16_bf16 v[96:111], v[84:87], v[52:55], v[96:111]
    ds_read_b128 v[40:43], v6 offset:2048
    ds_read_b64_tr_b16 v[72:73], v7 offset:36864
    ds_read_b64_tr_b16 v[74:75], v7 offset:37888
    ds_read_b128 v[44:47], v6 offset:3072
    ds_read_b64_tr_b16 v[76:77], v7 offset:38912
    ds_read_b64_tr_b16 v[78:79], v7 offset:39936
    v_mfma_f32_32x32x16_bf16 v[96:111], v[88:91], v[56:59], v[96:111]
    v_mfma_f32_32x32x16_bf16 v[96:111], v[92:95], v[60:63], v[96:111]
    s_waitcnt lgkmcnt(0)
    s_barrier
    v_mfma_f32_32x32x16_bf16 v[96:111], v[64:67], v[32:35], v[96:111]
    ds_read_b128 v[48:51], v6 offset:8192
    ds_read_b64_tr_b16 v[80:81], v7 offset:40960
    ds_read_b64_tr_b16 v[82:83], v7 offset:41984
    ds_read_b128 v[52:55], v6 offset:9216
    ds_read_b64_tr_b16 v[84:85], v7 offset:43008
    ds_read_b64_tr_b16 v[86:87], v7 offset:44032
    v_mfma_f32_32x32x16_bf16 v[96:111], v[68:71], v[36:39], v[96:111]
    ds_read_b128 v[56:59], v6 offset:10240
    ds_read_b64_tr_b16 v[88:89], v7 offset:45056
    ds_read_b64_tr_b16 v[90:91], v7 offset:46080
    ds_read_b128 v[60:63], v6 offset:11264
    ds_read_b64_tr_b16 v[92:93], v7 offset:47104
    ds_read_b64_tr_b16 v[94:95], v7 offset:48128
    v_mfma_f32_32x32x16_bf16 v[96:111], v[72:75], v[40:43], v[96:111]
    v_mfma_f32_32x32x16_bf16 v[96:111], v[76:79], v[44:47], v[96:111]
    s_waitcnt lgkmcnt(0)
    s_barrier
    v_mfma_f32_32x32x16_bf16 v[96:111], v[80:83], v[48:51], v[96:111]
    ds_read_b128 v[32:35], v6 offset:16384
    ds_read_b64_tr_b16 v[64:65], v7 offset:49152
    ds_read_b64_tr_b16 v[66:67], v7 offset:50176
    ds_read_b128 v[36:39], v6 offset:17408
    ds_read_b64_tr_b16 v[68:69], v7 offset:51200
    ds_read_b64_tr_b16 v[70:71], v7 offset:52224
    v_mfma_f32_32x32x16_bf16 v[96:111], v[84:87], v[52:55], v[96:111]
    ds_read_b128 v[40:43], v6 offset:18432
    ds_read_b64_tr_b16 v[72:73], v7 offset:53248
    ds_read_b64_tr_b16 v[74:75], v7 offset:54272
    ds_read_b128 v[44:47], v6 offset:19456
    ds_read_b64_tr_b16 v[76:77], v7 offset:55296
    ds_read_b64_tr_b16 v[78:79], v7 offset:56320
    v_mfma_f32_32x32x16_bf16 v[96:111], v[88:91], v[56:59], v[96:111]
    v_mfma_f32_32x32x16_bf16 v[96:111], v[92:95], v[60:63], v[96:111]
    s_waitcnt lgkmcnt(0)
    s_barrier
    v_mfma_f32_32x32x16_bf16 v[96:111], v[64:67], v[32:35], v[96:111]
    ds_read_b128 v[48:51], v6 offset:24576
    ds_read_b64_tr_b16 v[80:81], v7 offset:57344
    ds_read_b64_tr_b16 v[82:83], v7 offset:58368
    ds_read_b128 v[52:55], v6 offset:25600
    ds_read_b64_tr_b16 v[84:85], v7 offset:59392
    ds_read_b64_tr_b16 v[86:87], v7 offset:60416
    v_mfma_f32_32x32x16_bf16 v[96:111], v[68:71], v[36:39], v[96:111]
    ds_read_b128 v[56:59], v6 offset:26624
    ds_read_b64_tr_b16 v[88:89], v7 offset:61440
    ds_read_b64_tr_b16 v[90:91], v7 offset:62464
    ds_read_b128 v[60:63], v6 offset:27648
    ds_read_b64_tr_b16 v[92:93], v7 offset:63488
    ds_read_b64_tr_b16 v[94:95], v7 offset:64512
    v_mfma_f32_32x32x16_bf16 v[96:111], v[72:75], v[40:43], v[96:111]
    v_mfma_f32_32x32x16_bf16 v[96:111], v[76:79], v[44:47], v[96:111]
    s_waitcnt lgkmcnt(0)
    s_barrier
    v_mfma_f32_32x32x16_bf16 v[96:111], v[80:83], v[48:51], v[96:111]
    ds_read_b128 v[32:35], v6 offset:32768
    ds_read_b64_tr_b16 v[64:65], v8 offset:0
    ds_read_b64_tr_b16 v[66:67], v8 offset:1024
    ds_read_b128 v[36:39], v6 offset:33792
    ds_read_b64_tr_b16 v[68:69], v8 offset:2048
    ds_read_b64_tr_b16 v[70:71], v8 offset:3072
    v_mfma_f32_32x32x16_bf16 v[96:111], v[84:87], v[52:55], v[96:111]
    ds_read_b128 v[40:43], v6 offset:34816
    ds_read_b64_tr_b16 v[72:73], v8 offset:4096
    ds_read_b64_tr_b16 v[74:75], v8 offset:5120
    ds_read_b128 v[44:47], v6 offset:35840
    ds_read_b64_tr_b16 v[76:77], v8 offset:6144
    ds_read_b64_tr_b16 v[78:79], v8 offset:7168
    v_mfma_f32_32x32x16_bf16 v[96:111], v[88:91], v[56:59], v[96:111]
    v_mfma_f32_32x32x16_bf16 v[96:111], v[92:95], v[60:63], v[96:111]
    s_waitcnt lgkmcnt(0)
    s_barrier
    v_mfma_f32_32x32x16_bf16 v[96:111], v[64:67], v[32:35], v[96:111]
    ds_read_b128 v[48:51], v6 offset:40960
    ds_read_b64_tr_b16 v[80:81], v8 offset:8192
    ds_read_b64_tr_b16 v[82:83], v8 offset:9216
    ds_read_b128 v[52:55], v6 offset:41984
    ds_read_b64_tr_b16 v[84:85], v8 offset:10240
    ds_read_b64_tr_b16 v[86:87], v8 offset:11264
    v_mfma_f32_32x32x16_bf16 v[96:111], v[68:71], v[36:39], v[96:111]
    ds_read_b128 v[56:59], v6 offset:43008
    ds_read_b64_tr_b16 v[88:89], v8 offset:12288
    ds_read_b64_tr_b16 v[90:91], v8 offset:13312
    ds_read_b128 v[60:63], v6 offset:44032
    ds_read_b64_tr_b16 v[92:93], v8 offset:14336
    ds_read_b64_tr_b16 v[94:95], v8 offset:15360
    v_mfma_f32_32x32x16_bf16 v[96:111], v[72:75], v[40:43], v[96:111]
    v_mfma_f32_32x32x16_bf16 v[96:111], v[76:79], v[44:47], v[96:111]
    s_waitcnt lgkmcnt(0)
    s_barrier
    v_mfma_f32_32x32x16_bf16 v[96:111], v[80:83], v[48:51], v[96:111]
    ds_read_b128 v[32:35], v6 offset:0
    ds_read_b64_tr_b16 v[64:65], v8 offset:16384
    ds_read_b64_tr_b16 v[66:67], v8 offset:17408
    ds_read_b128 v[36:39], v6 offset:1024
    ds_read_b64_tr_b16 v[68:69], v8 offset:18432
    ds_read_b64_tr_b16 v[70:71], v8 offset:19456
    v_mfma_f32_32x32x16_bf16 v[96:111], v[84:87], v[52:55], v[96:111]
    ds_read_b128 v[40:43], v6 offset:2048
    ds_read_b64_tr_b16 v[72:73], v8 offset:20480
    ds_read_b64_tr_b16 v[74:75], v8 offset:21504
    ds_read_b128 v[44:47], v6 offset:3072
    ds_read_b64_tr_b16 v[76:77], v8 offset:22528
    ds_read_b64_tr_b16 v[78:79], v8 offset:23552
    v_mfma_f32_32x32x16_bf16 v[96:111], v[88:91], v[56:59], v[96:111]
    v_mfma_f32_32x32x16_bf16 v[96:111], v[92:95], v[60:63], v[96:111]
    s_waitcnt lgkmcnt(0)
    s_barrier
    v_mfma_f32_32x32x16_bf16 v[96:111], v[64:67], v[32:35], v[96:111]
    ds_read_b128 v[48:51], v6 offset:8192
    ds_read_b64_tr_b16 v[80:81], v8 offset:24576
    ds_read_b64_tr_b16 v[82:83], v8 offset:25600
    ds_read_b128 v[52:55], v6 offset:9216
    ds_read_b64_tr_b16 v[84:85], v8 offset:26624
    ds_read_b64_tr_b16 v[86:87], v8 offset:27648
    v_mfma_f32_32x32x16_bf16 v[96:111], v[68:71], v[36:39], v[96:111]
    ds_read_b128 v[56:59], v6 offset:10240
    ds_read_b64_tr_b16 v[88:89], v8 offset:28672
    ds_read_b64_tr_b16 v[90:91], v8 offset:29696
    ds_read_b128 v[60:63], v6 offset:11264
    ds_read_b64_tr_b16 v[92:93], v8 offset:30720
    ds_read_b64_tr_b16 v[94:95], v8 offset:31744
    v_mfma_f32_32x32x16_bf16 v[96:111], v[72:75], v[40:43], v[96:111]
    v_mfma_f32_32x32x16_bf16 v[96:111], v[76:79], v[44:47], v[96:111]
    s_waitcnt lgkmcnt(0)
    s_barrier
    v_mfma_f32_32x32x16_bf16 v[96:111], v[80:83], v[48:51], v[96:111]
    ds_read_b128 v[32:35], v6 offset:16384
    ds_read_b64_tr_b16 v[64:65], v8 offset:32768
    ds_read_b64_tr_b16 v[66:67], v8 offset:33792
    ds_read_b128 v[36:39], v6 offset:17408
    ds_read_b64_tr_b16 v[68:69], v8 offset:34816
    ds_read_b64_tr_b16 v[70:71], v8 offset:35840
    v_mfma_f32_32x32x16_bf16 v[96:111], v[84:87], v[52:55], v[96:111]
    ds_read_b128 v[40:43], v6 offset:18432
    ds_read_b64_tr_b16 v[72:73], v8 offset:36864
    ds_read_b64_tr_b16 v[74:75], v8 offset:37888
    ds_read_b128 v[44:47], v6 offset:19456
    ds_read_b64_tr_b16 v[76:77], v8 offset:38912
    ds_read_b64_tr_b16 v[78:79], v8 offset:39936
    v_mfma_f32_32x32x16_bf16 v[96:111], v[88:91], v[56:59], v[96:111]
    v_mfma_f32_32x32x16_bf16 v[96:111], v[92:95], v[60:63], v[96:111]
    s_waitcnt lgkmcnt(0)
    s_barrier
    v_mfma_f32_32x32x16_bf16 v[96:111], v[64:67], v[32:35], v[96:111]
    ds_read_b128 v[48:51], v6 offset:24576
    ds_read_b64_tr_b16 v[80:81], v7 offset:0
    ds_read_b64_tr_b16 v[82:83], v7 offset:1024
    ds_read_b128 v[52:55], v6 offset:25600
    ds_read_b64_tr_b16 v[84:85], v7 offset:2048
    ds_read_b64_tr_b16 v[86:87], v7 offset:3072
    v_mfma_f32_32x32x16_bf16 v[96:111], v[68:71], v[36:39], v[96:111]
    ds_read_b128 v[56:59], v6 offset:26624
    ds_read_b64_tr_b16 v[88:89], v7 offset:4096
    ds_read_b64_tr_b16 v[90:91], v7 offset:5120
    ds_read_b128 v[60:63], v6 offset:27648
    ds_read_b64_tr_b16 v[92:93], v7 offset:6144
    ds_read_b64_tr_b16 v[94:95], v7 offset:7168
    v_mfma_f32_32x32x16_bf16 v[96:111], v[72:75], v[40:43], v[96:111]
    v_mfma_f32_32x32x16_bf16 v[96:111], v[76:79], v[44:47], v[96:111]
    s_waitcnt lgkmcnt(0)
    s_barrier
    v_mfma_f32_32x32x16_bf16 v[96:111], v[80:83], v[48:51], v[96:111]
    ds_read_b128 v[32:35], v6 offset:32768
    ds_read_b64_tr_b16 v[64:65], v7 offset:8192
    ds_read_b64_tr_b16 v[66:67], v7 offset:9216
    ds_read_b128 v[36:39], v6 offset:33792
    ds_read_b64_tr_b16 v[68:69], v7 offset:10240
    ds_read_b64_tr_b16 v[70:71], v7 offset:11264
    v_mfma_f32_32x32x16_bf16 v[96:111], v[84:87], v[52:55], v[96:111]
    ds_read_b128 v[40:43], v6 offset:34816
    ds_read_b64_tr_b16 v[72:73], v7 offset:12288
    ds_read_b64_tr_b16 v[74:75], v7 offset:13312
    ds_read_b128 v[44:47], v6 offset:35840
    ds_read_b64_tr_b16 v[76:77], v7 offset:14336
    ds_read_b64_tr_b16 v[78:79], v7 offset:15360
    v_mfma_f32_32x32x16_bf16 v[96:111], v[88:91], v[56:59], v[96:111]
    v_mfma_f32_32x32x16_bf16 v[96:111], v[92:95], v[60:63], v[96:111]
    s_waitcnt lgkmcnt(0)
    s_barrier
    v_mfma_f32_32x32x16_bf16 v[96:111], v[64:67], v[32:35], v[96:111]
    ds_read_b128 v[48:51], v6 offset:40960
    ds_read_b64_tr_b16 v[80:81], v7 offset:16384
    ds_read_b64_tr_b16 v[82:83], v7 offset:17408
    ds_read_b128 v[52:55], v6 offset:41984
    ds_read_b64_tr_b16 v[84:85], v7 offset:18432
    ds_read_b64_tr_b16 v[86:87], v7 offset:19456
    v_mfma_f32_32x32x16_bf16 v[96:111], v[68:71], v[36:39], v[96:111]
    ds_read_b128 v[56:59], v6 offset:43008
    ds_read_b64_tr_b16 v[88:89], v7 offset:20480
    ds_read_b64_tr_b16 v[90:91], v7 offset:21504
    ds_read_b128 v[60:63], v6 offset:44032
    ds_read_b64_tr_b16 v[92:93], v7 offset:22528
    ds_read_b64_tr_b16 v[94:95], v7 offset:23552
    v_mfma_f32_32x32x16_bf16 v[96:111], v[72:75], v[40:43], v[96:111]
    v_mfma_f32_32x32x16_bf16 v[96:111], v[76:79], v[44:47], v[96:111]
    s_waitcnt lgkmcnt(0)
    s_barrier
    v_mfma_f32_32x32x16_bf16 v[96:111], v[80:83], v[48:51], v[96:111]
    ds_read_b128 v[32:35], v6 offset:0
    ds_read_b64_tr_b16 v[64:65], v7 offset:24576
    ds_read_b64_tr_b16 v[66:67], v7 offset:25600
    ds_read_b128 v[36:39], v6 offset:1024
    ds_read_b64_tr_b16 v[68:69], v7 offset:26624
    ds_read_b64_tr_b16 v[70:71], v7 offset:27648
    v_mfma_f32_32x32x16_bf16 v[96:111], v[84:87], v[52:55], v[96:111]
    ds_read_b128 v[40:43], v6 offset:2048
    ds_read_b64_tr_b16 v[72:73], v7 offset:28672
    ds_read_b64_tr_b16 v[74:75], v7 offset:29696
    ds_read_b128 v[44:47], v6 offset:3072
    ds_read_b64_tr_b16 v[76:77], v7 offset:30720
    ds_read_b64_tr_b16 v[78:79], v7 offset:31744
    v_mfma_f32_32x32x16_bf16 v[96:111], v[88:91], v[56:59], v[96:111]
    v_mfma_f32_32x32x16_bf16 v[96:111], v[92:95], v[60:63], v[96:111]
    s_waitcnt lgkmcnt(0)
    s_barrier
    v_mfma_f32_32x32x16_bf16 v[96:111], v[64:67], v[32:35], v[96:111]
    ds_read_b128 v[48:51], v6 offset:8192
    ds_read_b64_tr_b16 v[80:81], v7 offset:32768
    ds_read_b64_tr_b16 v[82:83], v7 offset:33792
    ds_read_b128 v[52:55], v6 offset:9216
    ds_read_b64_tr_b16 v[84:85], v7 offset:34816
    ds_read_b64_tr_b16 v[86:87], v7 offset:35840
    v_mfma_f32_32x32x16_bf16 v[96:111], v[68:71], v[36:39], v[96:111]
    ds_read_b128 v[56:59], v6 offset:10240
    ds_read_b64_tr_b16 v[88:89], v7 offset:36864
    ds_read_b64_tr_b16 v[90:91], v7 offset:37888
    ds_read_b128 v[60:63], v6 offset:11264
    ds_read_b64_tr_b16 v[92:93], v7 offset:38912
    ds_read_b64_tr_b16 v[94:95], v7 offset:39936
    v_mfma_f32_32x32x16_bf16 v[96:111], v[72:75], v[40:43], v[96:111]
    v_mfma_f32_32x32x16_bf16 v[96:111], v[76:79], v[44:47], v[96:111]
    s_waitcnt lgkmcnt(0)
    s_barrier
    v_mfma_f32_32x32x16_bf16 v[96:111], v[80:83], v[48:51], v[96:111]
    ds_read_b128 v[32:35], v6 offset:16384
    ds_read_b64_tr_b16 v[64:65], v7 offset:40960
    ds_read_b64_tr_b16 v[66:67], v7 offset:41984
    ds_read_b128 v[36:39], v6 offset:17408
    ds_read_b64_tr_b16 v[68:69], v7 offset:43008
    ds_read_b64_tr_b16 v[70:71], v7 offset:44032
    v_mfma_f32_32x32x16_bf16 v[96:111], v[84:87], v[52:55], v[96:111]
    ds_read_b128 v[40:43], v6 offset:18432
    ds_read_b64_tr_b16 v[72:73], v7 offset:45056
    ds_read_b64_tr_b16 v[74:75], v7 offset:46080
    ds_read_b128 v[44:47], v6 offset:19456
    ds_read_b64_tr_b16 v[76:77], v7 offset:47104
    ds_read_b64_tr_b16 v[78:79], v7 offset:48128
    v_mfma_f32_32x32x16_bf16 v[96:111], v[88:91], v[56:59], v[96:111]
    v_mfma_f32_32x32x16_bf16 v[96:111], v[92:95], v[60:63], v[96:111]
    s_waitcnt lgkmcnt(0)
    s_barrier
    v_mfma_f32_32x32x16_bf16 v[96:111], v[64:67], v[32:35], v[96:111]
    ds_read_b128 v[48:51], v6 offset:24576
    ds_read_b64_tr_b16 v[80:81], v7 offset:49152
    ds_read_b64_tr_b16 v[82:83], v7 offset:50176
    ds_read_b128 v[52:55], v6 offset:25600
    ds_read_b64_tr_b16 v[84:85], v7 offset:51200
    ds_read_b64_tr_b16 v[86:87], v7 offset:52224
    v_mfma_f32_32x32x16_bf16 v[96:111], v[68:71], v[36:39], v[96:111]
    ds_read_b128 v[56:59], v6 offset:26624
    ds_read_b64_tr_b16 v[88:89], v7 offset:53248
    ds_read_b64_tr_b16 v[90:91], v7 offset:54272
    ds_read_b128 v[60:63], v6 offset:27648
    ds_read_b64_tr_b16 v[92:93], v7 offset:55296
    ds_read_b64_tr_b16 v[94:95], v7 offset:56320
    v_mfma_f32_32x32x16_bf16 v[96:111], v[72:75], v[40:43], v[96:111]
    v_mfma_f32_32x32x16_bf16 v[96:111], v[76:79], v[44:47], v[96:111]
    s_waitcnt lgkmcnt(0)
    s_barrier
    v_mfma_f32_32x32x16_bf16 v[96:111], v[80:83], v[48:51], v[96:111]
    ds_read_b128 v[32:35], v6 offset:32768
    ds_read_b64_tr_b16 v[64:65], v7 offset:57344
    ds_read_b64_tr_b16 v[66:67], v7 offset:58368
    ds_read_b128 v[36:39], v6 offset:33792
    ds_read_b64_tr_b16 v[68:69], v7 offset:59392
    ds_read_b64_tr_b16 v[70:71], v7 offset:60416
    v_mfma_f32_32x32x16_bf16 v[96:111], v[84:87], v[52:55], v[96:111]
    ds_read_b128 v[40:43], v6 offset:34816
    ds_read_b64_tr_b16 v[72:73], v7 offset:61440
    ds_read_b64_tr_b16 v[74:75], v7 offset:62464
    ds_read_b128 v[44:47], v6 offset:35840
    ds_read_b64_tr_b16 v[76:77], v7 offset:63488
    ds_read_b64_tr_b16 v[78:79], v7 offset:64512
    v_mfma_f32_32x32x16_bf16 v[96:111], v[88:91], v[56:59], v[96:111]
    v_mfma_f32_32x32x16_bf16 v[96:111], v[92:95], v[60:63], v[96:111]
    s_waitcnt lgkmcnt(0)
    s_barrier
    v_mfma_f32_32x32x16_bf16 v[96:111], v[64:67], v[32:35], v[96:111]
    ds_read_b128 v[48:51], v6 offset:40960
    ds_read_b64_tr_b16 v[80:81], v8 offset:0
    ds_read_b64_tr_b16 v[82:83], v8 offset:1024
    ds_read_b128 v[52:55], v6 offset:41984
    ds_read_b64_tr_b16 v[84:85], v8 offset:2048
    ds_read_b64_tr_b16 v[86:87], v8 offset:3072
    v_mfma_f32_32x32x16_bf16 v[96:111], v[68:71], v[36:39], v[96:111]
    ds_read_b128 v[56:59], v6 offset:43008
    ds_read_b64_tr_b16 v[88:89], v8 offset:4096
    ds_read_b64_tr_b16 v[90:91], v8 offset:5120
    ds_read_b128 v[60:63], v6 offset:44032
    ds_read_b64_tr_b16 v[92:93], v8 offset:6144
    ds_read_b64_tr_b16 v[94:95], v8 offset:7168
    v_mfma_f32_32x32x16_bf16 v[96:111], v[72:75], v[40:43], v[96:111]
    v_mfma_f32_32x32x16_bf16 v[96:111], v[76:79], v[44:47], v[96:111]
    s_waitcnt lgkmcnt(0)
    s_barrier
    v_mfma_f32_32x32x16_bf16 v[96:111], v[80:83], v[48:51], v[96:111]
    ds_read_b128 v[32:35], v6 offset:0
    ds_read_b64_tr_b16 v[64:65], v8 offset:8192
    ds_read_b64_tr_b16 v[66:67], v8 offset:9216
    ds_read_b128 v[36:39], v6 offset:1024
    ds_read_b64_tr_b16 v[68:69], v8 offset:10240
    ds_read_b64_tr_b16 v[70:71], v8 offset:11264
    v_mfma_f32_32x32x16_bf16 v[96:111], v[84:87], v[52:55], v[96:111]
    ds_read_b128 v[40:43], v6 offset:2048
    ds_read_b64_tr_b16 v[72:73], v8 offset:12288
    ds_read_b64_tr_b16 v[74:75], v8 offset:13312
    ds_read_b128 v[44:47], v6 offset:3072
    ds_read_b64_tr_b16 v[76:77], v8 offset:14336
    ds_read_b64_tr_b16 v[78:79], v8 offset:15360
    v_mfma_f32_32x32x16_bf16 v[96:111], v[88:91], v[56:59], v[96:111]
    v_mfma_f32_32x32x16_bf16 v[96:111], v[92:95], v[60:63], v[96:111]
    s_waitcnt lgkmcnt(0)
    s_barrier
    v_mfma_f32_32x32x16_bf16 v[96:111], v[64:67], v[32:35], v[96:111]
    ds_read_b128 v[48:51], v6 offset:8192
    ds_read_b64_tr_b16 v[80:81], v8 offset:16384
    ds_read_b64_tr_b16 v[82:83], v8 offset:17408
    ds_read_b128 v[52:55], v6 offset:9216
    ds_read_b64_tr_b16 v[84:85], v8 offset:18432
    ds_read_b64_tr_b16 v[86:87], v8 offset:19456
    v_mfma_f32_32x32x16_bf16 v[96:111], v[68:71], v[36:39], v[96:111]
    ds_read_b128 v[56:59], v6 offset:10240
    ds_read_b64_tr_b16 v[88:89], v8 offset:20480
    ds_read_b64_tr_b16 v[90:91], v8 offset:21504
    ds_read_b128 v[60:63], v6 offset:11264
    ds_read_b64_tr_b16 v[92:93], v8 offset:22528
    ds_read_b64_tr_b16 v[94:95], v8 offset:23552
    v_mfma_f32_32x32x16_bf16 v[96:111], v[72:75], v[40:43], v[96:111]
    v_mfma_f32_32x32x16_bf16 v[96:111], v[76:79], v[44:47], v[96:111]
    s_waitcnt lgkmcnt(0)
    s_barrier
    v_mfma_f32_32x32x16_bf16 v[96:111], v[80:83], v[48:51], v[96:111]
    ds_read_b128 v[32:35], v6 offset:16384
    ds_read_b64_tr_b16 v[64:65], v8 offset:24576
    ds_read_b64_tr_b16 v[66:67], v8 offset:25600
    ds_read_b128 v[36:39], v6 offset:17408
    ds_read_b64_tr_b16 v[68:69], v8 offset:26624
    ds_read_b64_tr_b16 v[70:71], v8 offset:27648
    v_mfma_f32_32x32x16_bf16 v[96:111], v[84:87], v[52:55], v[96:111]
    ds_read_b128 v[40:43], v6 offset:18432
    ds_read_b64_tr_b16 v[72:73], v8 offset:28672
    ds_read_b64_tr_b16 v[74:75], v8 offset:29696
    ds_read_b128 v[44:47], v6 offset:19456
    ds_read_b64_tr_b16 v[76:77], v8 offset:30720
    ds_read_b64_tr_b16 v[78:79], v8 offset:31744
    v_mfma_f32_32x32x16_bf16 v[96:111], v[88:91], v[56:59], v[96:111]
    v_mfma_f32_32x32x16_bf16 v[96:111], v[92:95], v[60:63], v[96:111]
    s_waitcnt lgkmcnt(0)
    s_barrier
    v_mfma_f32_32x32x16_bf16 v[96:111], v[64:67], v[32:35], v[96:111]
    ds_read_b128 v[48:51], v6 offset:24576
    ds_read_b64_tr_b16 v[80:81], v8 offset:32768
    ds_read_b64_tr_b16 v[82:83], v8 offset:33792
    ds_read_b128 v[52:55], v6 offset:25600
    ds_read_b64_tr_b16 v[84:85], v8 offset:34816
    ds_read_b64_tr_b16 v[86:87], v8 offset:35840
    v_mfma_f32_32x32x16_bf16 v[96:111], v[68:71], v[36:39], v[96:111]
    ds_read_b128 v[56:59], v6 offset:26624
    ds_read_b64_tr_b16 v[88:89], v8 offset:36864
    ds_read_b64_tr_b16 v[90:91], v8 offset:37888
    ds_read_b128 v[60:63], v6 offset:27648
    ds_read_b64_tr_b16 v[92:93], v8 offset:38912
    ds_read_b64_tr_b16 v[94:95], v8 offset:39936
    v_mfma_f32_32x32x16_bf16 v[96:111], v[72:75], v[40:43], v[96:111]
    v_mfma_f32_32x32x16_bf16 v[96:111], v[76:79], v[44:47], v[96:111]
    s_waitcnt lgkmcnt(0)
    v_mfma_f32_32x32x16_bf16 v[96:111], v[80:83], v[48:51], v[96:111]
    v_mfma_f32_32x32x16_bf16 v[96:111], v[84:87], v[52:55], v[96:111]
    v_mfma_f32_32x32x16_bf16 v[96:111], v[88:91], v[56:59], v[96:111]
    v_mfma_f32_32x32x16_bf16 v[96:111], v[92:95], v[60:63], v[96:111]
    s_nop 7
    s_nop 3
    v_cvt_pk_bf16_f32 v112, v96, v97
    v_cvt_pk_bf16_f32 v113, v98, v99
    v_cvt_pk_bf16_f32 v114, v100, v101
    v_cvt_pk_bf16_f32 v115, v102, v103
    v_cvt_pk_bf16_f32 v116, v104, v105
    v_cvt_pk_bf16_f32 v117, v106, v107
    v_cvt_pk_bf16_f32 v118, v108, v109
    v_cvt_pk_bf16_f32 v119, v110, v111
    buffer_store_dwordx2 v[112:113], v231, s[36:39], 0 offen offset:0
    buffer_store_dwordx2 v[114:115], v231, s[36:39], 0 offen offset:16
    buffer_store_dwordx2 v[116:117], v231, s[36:39], 0 offen offset:32
    buffer_store_dwordx2 v[118:119], v231, s[36:39], 0 offen offset:48
    s_endpgm
L_t_c5b:
    s_mov_b32 s40, s18
    s_and_b32 s41, s19, 0xffff
    s_mov_b32 s42, 1024
    s_mov_b32 s43, 0x20000
    s_mov_b32 s36, s20
    s_and_b32 s37, s21, 0xffff
    s_mov_b32 s38, 2097152
    s_mov_b32 s39, 0x20000
    v_lshlrev_b32 v13, 3, v3
    s_lshl_b32 s55, s50, 7
    s_lshl_b32 s56, s46, 6
    s_add_u32 s55, s55, s56
    buffer_load_dwordx2 v[24:25], v13, s[40:43], s55 offen offset:0
    buffer_load_dwordx2 v[26:27], v13, s[40:43], s55 offen offset:16
    buffer_load_dwordx2 v[28:29], v13, s[40:43], s55 offen offset:32
    buffer_load_dwordx2 v[30:31], v13, s[40:43], s55 offen offset:48
    s_lshl_b32 s55, s45, 12
    s_add_u32 s55, s55, 106496
    v_add_u32 v6, s55, v4
    v_and_b32 v12, 15, v1
    v_lshrrev_b32 v13, 2, v12
    v_lshl_add_u32 v13, v3, 2, v13
    v_lshlrev_b32 v13, 7, v13
    v_lshrrev_b32 v14, 3, v12
    v_xor_b32 v14, s46, v14
    v_lshl_add_u32 v13, v14, 6, v13
    v_bfe_u32 v14, v1, 4, 1
    v_lshl_add_u32 v13, v14, 5, v13
    v_and_b32 v14, 3, v12
    v_lshl_add_u32 v7, v14, 3, v13
    v_add_u32 v8, 65536, v7
    v_mov_b32 v96, 0
    v_mov_b32 v97, 0
    v_mov_b32 v98, 0
    v_mov_b32 v99, 0
    v_mov_b32 v100, 0
    v_mov_b32 v101, 0
    v_mov_b32 v102, 0
    v_mov_b32 v103, 0
    v_mov_b32 v104, 0
    v_mov_b32 v105, 0
    v_mov_b32 v106, 0
    v_mov_b32 v107, 0
    v_mov_b32 v108, 0
    v_mov_b32 v109, 0
    v_mov_b32 v110, 0
    v_mov_b32 v111, 0
    s_waitcnt vmcnt(0)
    v_lshlrev_b32 v112, 16, v232
    v_and_b32 v113, 0xffff0000, v232
    v_lshlrev_b32 v114, 16, v233
    v_and_b32 v115, 0xffff0000, v233
    v_lshlrev_b32 v116, 16, v234
    v_and_b32 v117, 0xffff0000, v234
    v_lshlrev_b32 v118, 16, v235
    v_and_b32 v119, 0xffff0000, v235
    v_lshlrev_b32 v120, 16, v236
    v_and_b32 v121, 0xffff0000, v236
    v_lshlrev_b32 v122, 16, v237
    v_and_b32 v123, 0xffff0000, v237
    v_lshlrev_b32 v124, 16, v238
    v_and_b32 v125, 0xffff0000, v238
    v_lshlrev_b32 v126, 16, v239
    v_and_b32 v127, 0xffff0000, v239
    v_lshlrev_b32 v32, 16, v24
    v_and_b32 v33, 0xffff0000, v24
    v_lshlrev_b32 v34, 16, v25
    v_and_b32 v35, 0xffff0000, v25
    v_lshlrev_b32 v36, 16, v26
    v_and_b32 v37, 0xffff0000, v26
    v_lshlrev_b32 v38, 16, v27
    v_and_b32 v39, 0xffff0000, v27
    v_lshlrev_b32 v40, 16, v28
    v_and_b32 v41, 0xffff0000, v28
    v_lshlrev_b32 v42, 16, v29
    v_and_b32 v43, 0xffff0000, v29
    v_lshlrev_b32 v44, 16, v30
    v_and_b32 v45, 0xffff0000, v30
    v_lshlrev_b32 v46, 16, v31
    v_and_b32 v47, 0xffff0000, v31
    v_add_f32 v96, v112, v32
    v_add_f32 v97, v113, v33
    v_add_f32 v98, v114, v34
    v_add_f32 v99, v115, v35
    v_add_f32 v100, v116, v36
    v_add_f32 v101, v117, v37
    v_add_f32 v102, v118, v38
    v_add_f32 v103, v119, v39
    v_add_f32 v104, v120, v40
    v_add_f32 v105, v121, v41
    v_add_f32 v106, v122, v42
    v_add_f32 v107, v123, v43
    v_add_f32 v108, v124, v44
    v_add_f32 v109, v125, v45
    v_add_f32 v110, v126, v46
    v_add_f32 v111, v127, v47
    s_cmp_lg_u32 s44, 0
    s_cbranch_scc1 L_h4b8_x
    s_lshl_b32 s55, s47, 12
    s_add_u32 s55, s55, 6359040
    v_min_u32 v228, 13, v1
    v_lshlrev_b32 v228, 2, v228
    s_mov_b32 s26, 0
L_h4b8_p:
    buffer_load_dword v229, v228, s[28:31], s55 offen sc1
    s_add_u32 s26, s26, 1
    s_cmp_ge_u32 s26, 0x100000
    s_cbranch_scc1 L_h4b8_x
    s_waitcnt vmcnt(0)
    v_cmp_ne_u32 vcc, s10, v229
    s_cbranch_vccz L_h4b8_x
    s_sleep 1
    s_branch L_h4b8_p
L_h4b8_x:
    s_barrier
    s_barrier
    ds_read_b128 v[32:35], v6 offset:0
    ds_read_b64_tr_b16 v[64:65], v8 offset:0
    ds_read_b64_tr_b16 v[66:67], v8 offset:1024
    ds_read_b128 v[36:39], v6 offset:1024
    ds_read_b64_tr_b16 v[68:69], v8 offset:2048
    ds_read_b64_tr_b16 v[70:71], v8 offset:3072
    ds_read_b128 v[40:43], v6 offset:2048
    ds_read_b64_tr_b16 v[72:73], v8 offset:4096
    ds_read_b64_tr_b16 v[74:75], v8 offset:5120
    ds_read_b128 v[44:47], v6 offset:3072
    ds_read_b64_tr_b16 v[76:77], v8 offset:6144
    ds_read_b64_tr_b16 v[78:79], v8 offset:7168
    s_waitcnt lgkmcnt(0)
    s_barrier
    v_mfma_f32_32x32x16_bf16 v[96:111], v[64:67], v[32:35], v[96:111]
    ds_read_b128 v[48:51], v6 offset:8192
    ds_read_b64_tr_b16 v[80:81], v8 offset:8192
    ds_read_b64_tr_b16 v[82:83], v8 offset:9216
    ds_read_b128 v[52:55], v6 offset:9216
    ds_read_b64_tr_b16 v[84:85], v8 offset:10240
    ds_read_b64_tr_b16 v[86:87], v8 offset:11264
    v_mfma_f32_32x32x16_bf16 v[96:111], v[68:71], v[36:39], v[96:111]
    ds_read_b128 v[56:59], v6 offset:10240
    ds_read_b64_tr_b16 v[88:89], v8 offset:12288
    ds_read_b64_tr_b16 v[90:91], v8 offset:13312
    ds_read_b128 v[60:63], v6 offset:11264
    ds_read_b64_tr_b16 v[92:93], v8 offset:14336
    ds_read_b64_tr_b16 v[94:95], v8 offset:15360
    v_mfma_f32_32x32x16_bf16 v[96:111], v[72:75], v[40:43], v[96:111]
    v_mfma_f32_32x32x16_bf16 v[96:111], v[76:79], v[44:47], v[96:111]
    s_waitcnt lgkmcnt(0)
    s_barrier
    v_mfma_f32_32x32x16_bf16 v[96:111], v[80:83], v[48:51], v[96:111]
    ds_read_b128 v[32:35], v6 offset:16384
    ds_read_b64_tr_b16 v[64:65], v8 offset:16384
    ds_read_b64_tr_b16 v[66:67], v8 offset:17408
    ds_read_b128 v[36:39], v6 offset:17408
    ds_read_b64_tr_b16 v[68:69], v8 offset:18432
    ds_read_b64_tr_b16 v[70:71], v8 offset:19456
    v_mfma_f32_32x32x16_bf16 v[96:111], v[84:87], v[52:55], v[96:111]
    ds_read_b128 v[40:43], v6 offset:18432
    ds_read_b64_tr_b16 v[72:73], v8 offset:20480
    ds_read_b64_tr_b16 v[74:75], v8 offset:21504
    ds_read_b128 v[44:47], v6 offset:19456
    ds_read_b64_tr_b16 v[76:77], v8 offset:22528
    ds_read_b64_tr_b16 v[78:79], v8 offset:23552
    v_mfma_f32_32x32x16_bf16 v[96:111], v[88:91], v[56:59], v[96:111]
    v_mfma_f32_32x32x16_bf16 v[96:111], v[92:95], v[60:63], v[96:111]
    s_waitcnt lgkmcnt(0)
    s_barrier
    v_mfma_f32_32x32x16_bf16 v[96:111], v[64:67], v[32:35], v[96:111]
    ds_read_b128 v[48:51], v6 offset:24576
    ds_read_b64_tr_b16 v[80:81], v8 offset:24576
    ds_read_b64_tr_b16 v[82:83], v8 offset:25600
    ds_read_b128 v[52:55], v6 offset:25600
    ds_read_b64_tr_b16 v[84:85], v8 offset:26624
    ds_read_b64_tr_b16 v[86:87], v8 offset:27648
    v_mfma_f32_32x32x16_bf16 v[96:111], v[68:71], v[36:39], v[96:111]
    ds_read_b128 v[56:59], v6 offset:26624
    ds_read_b64_tr_b16 v[88:89], v8 offset:28672
    ds_read_b64_tr_b16 v[90:91], v8 offset:29696
    ds_read_b128 v[60:63], v6 offset:27648
    ds_read_b64_tr_b16 v[92:93], v8 offset:30720
    ds_read_b64_tr_b16 v[94:95], v8 offset:31744
    v_mfma_f32_32x32x16_bf16 v[96:111], v[72:75], v[40:43], v[96:111]
    v_mfma_f32_32x32x16_bf16 v[96:111], v[76:79], v[44:47], v[96:111]
    s_waitcnt lgkmcnt(0)
    s_barrier
    v_mfma_f32_32x32x16_bf16 v[96:111], v[80:83], v[48:51], v[96:111]
    ds_read_b128 v[32:35], v6 offset:32768
    ds_read_b64_tr_b16 v[64:65], v8 offset:32768
    ds_read_b64_tr_b16 v[66:67], v8 offset:33792
    ds_read_b128 v[36:39], v6 offset:33792
    ds_read_b64_tr_b16 v[68:69], v8 offset:34816
    ds_read_b64_tr_b16 v[70:71], v8 offset:35840
    v_mfma_f32_32x32x16_bf16 v[96:111], v[84:87], v[52:55], v[96:111]
    ds_read_b128 v[40:43], v6 offset:34816
    ds_read_b64_tr_b16 v[72:73], v8 offset:36864
    ds_read_b64_tr_b16 v[74:75], v8 offset:37888
    ds_read_b128 v[44:47], v6 offset:35840
    ds_read_b64_tr_b16 v[76:77], v8 offset:38912
    ds_read_b64_tr_b16 v[78:79], v8 offset:39936
    v_mfma_f32_32x32x16_bf16 v[96:111], v[88:91], v[56:59], v[96:111]
    v_mfma_f32_32x32x16_bf16 v[96:111], v[92:95], v[60:63], v[96:111]
    s_waitcnt lgkmcnt(0)
    s_barrier
    v_mfma_f32_32x32x16_bf16 v[96:111], v[64:67], v[32:35], v[96:111]
    ds_read_b128 v[48:51], v6 offset:40960
    ds_read_b64_tr_b16 v[80:81], v7 offset:0
    ds_read_b64_tr_b16 v[82:83], v7 offset:1024
    ds_read_b128 v[52:55], v6 offset:41984
    ds_read_b64_tr_b16 v[84:85], v7 offset:2048
    ds_read_b64_tr_b16 v[86:87], v7 offset:3072
    v_mfma_f32_32x32x16_bf16 v[96:111], v[68:71], v[36:39], v[96:111]
    ds_read_b128 v[56:59], v6 offset:43008
    ds_read_b64_tr_b16 v[88:89], v7 offset:4096
    ds_read_b64_tr_b16 v[90:91], v7 offset:5120
    ds_read_b128 v[60:63], v6 offset:44032
    ds_read_b64_tr_b16 v[92:93], v7 offset:6144
    ds_read_b64_tr_b16 v[94:95], v7 offset:7168
    v_mfma_f32_32x32x16_bf16 v[96:111], v[72:75], v[40:43], v[96:111]
    v_mfma_f32_32x32x16_bf16 v[96:111], v[76:79], v[44:47], v[96:111]
    s_waitcnt lgkmcnt(0)
    s_barrier
    v_mfma_f32_32x32x16_bf16 v[96:111], v[80:83], v[48:51], v[96:111]
    ds_read_b128 v[32:35], v6 offset:0
    ds_read_b64_tr_b16 v[64:65], v7 offset:8192
    ds_read_b64_tr_b16 v[66:67], v7 offset:9216
    ds_read_b128 v[36:39], v6 offset:1024
    ds_read_b64_tr_b16 v[68:69], v7 offset:10240
    ds_read_b64_tr_b16 v[70:71], v7 offset:11264
    v_mfma_f32_32x32x16_bf16 v[96:111], v[84:87], v[52:55], v[96:111]
    ds_read_b128 v[40:43], v6 offset:2048
    ds_read_b64_tr_b16 v[72:73], v7 offset:12288
    ds_read_b64_tr_b16 v[74:75], v7 offset:13312
    ds_read_b128 v[44:47], v6 offset:3072
    ds_read_b64_tr_b16 v[76:77], v7 offset:14336
    ds_read_b64_tr_b16 v[78:79], v7 offset:15360
    v_mfma_f32_32x32x16_bf16 v[96:111], v[88:91], v[56:59], v[96:111]
    v_mfma_f32_32x32x16_bf16 v[96:111], v[92:95], v[60:63], v[96:111]
    s_waitcnt lgkmcnt(0)
    s_barrier
    v_mfma_f32_32x32x16_bf16 v[96:111], v[64:67], v[32:35], v[96:111]
    ds_read_b128 v[48:51], v6 offset:8192
    ds_read_b64_tr_b16 v[80:81], v7 offset:16384
    ds_read_b64_tr_b16 v[82:83], v7 offset:17408
    ds_read_b128 v[52:55], v6 offset:9216
    ds_read_b64_tr_b16 v[84:85], v7 offset:18432
    ds_read_b64_tr_b16 v[86:87], v7 offset:19456
    v_mfma_f32_32x32x16_bf16 v[96:111], v[68:71], v[36:39], v[96:111]
    ds_read_b128 v[56:59], v6 offset:10240
    ds_read_b64_tr_b16 v[88:89], v7 offset:20480
    ds_read_b64_tr_b16 v[90:91], v7 offset:21504
    ds_read_b128 v[60:63], v6 offset:11264
    ds_read_b64_tr_b16 v[92:93], v7 offset:22528
    ds_read_b64_tr_b16 v[94:95], v7 offset:23552
    v_mfma_f32_32x32x16_bf16 v[96:111], v[72:75], v[40:43], v[96:111]
    v_mfma_f32_32x32x16_bf16 v[96:111], v[76:79], v[44:47], v[96:111]
    s_waitcnt lgkmcnt(0)
    s_barrier
    v_mfma_f32_32x32x16_bf16 v[96:111], v[80:83], v[48:51], v[96:111]
    ds_read_b128 v[32:35], v6 offset:16384
    ds_read_b64_tr_b16 v[64:65], v7 offset:24576
    ds_read_b64_tr_b16 v[66:67], v7 offset:25600
    ds_read_b128 v[36:39], v6 offset:17408
    ds_read_b64_tr_b16 v[68:69], v7 offset:26624
    ds_read_b64_tr_b16 v[70:71], v7 offset:27648
    v_mfma_f32_32x32x16_bf16 v[96:111], v[84:87], v[52:55], v[96:111]
    ds_read_b128 v[40:43], v6 offset:18432
    ds_read_b64_tr_b16 v[72:73], v7 offset:28672
    ds_read_b64_tr_b16 v[74:75], v7 offset:29696
    ds_read_b128 v[44:47], v6 offset:19456
    ds_read_b64_tr_b16 v[76:77], v7 offset:30720
    ds_read_b64_tr_b16 v[78:79], v7 offset:31744
    v_mfma_f32_32x32x16_bf16 v[96:111], v[88:91], v[56:59], v[96:111]
    v_mfma_f32_32x32x16_bf16 v[96:111], v[92:95], v[60:63], v[96:111]
    s_waitcnt lgkmcnt(0)
    s_barrier
    v_mfma_f32_32x32x16_bf16 v[96:111], v[64:67], v[32:35], v[96:111]
    ds_read_b128 v[48:51], v6 offset:24576
    ds_read_b64_tr_b16 v[80:81], v7 offset:32768
    ds_read_b64_tr_b16 v[82:83], v7 offset:33792
    ds_read_b128 v[52:55], v6 offset:25600
    ds_read_b64_tr_b16 v[84:85], v7 offset:34816
    ds_read_b64_tr_b16 v[86:87], v7 offset:35840
    v_mfma_f32_32x32x16_bf16 v[96:111], v[68:71], v[36:39], v[96:111]
    ds_read_b128 v[56:59], v6 offset:26624
    ds_read_b64_tr_b16 v[88:89], v7 offset:36864
    ds_read_b64_tr_b16 v[90:91], v7 offset:37888
    ds_read_b128 v[60:63], v6 offset:27648
    ds_read_b64_tr_b16 v[92:93], v7 offset:38912
    ds_read_b64_tr_b16 v[94:95], v7 offset:39936
    v_mfma_f32_32x32x16_bf16 v[96:111], v[72:75], v[40:43], v[96:111]
    v_mfma_f32_32x32x16_bf16 v[96:111], v[76:79], v[44:47], v[96:111]
    s_waitcnt lgkmcnt(0)
    s_barrier
    v_mfma_f32_32x32x16_bf16 v[96:111], v[80:83], v[48:51], v[96:111]
    ds_read_b128 v[32:35], v6 offset:32768
    ds_read_b64_tr_b16 v[64:65], v7 offset:40960
    ds_read_b64_tr_b16 v[66:67], v7 offset:41984
    ds_read_b128 v[36:39], v6 offset:33792
    ds_read_b64_tr_b16 v[68:69], v7 offset:43008
    ds_read_b64_tr_b16 v[70:71], v7 offset:44032
    v_mfma_f32_32x32x16_bf16 v[96:111], v[84:87], v[52:55], v[96:111]
    ds_read_b128 v[40:43], v6 offset:34816
    ds_read_b64_tr_b16 v[72:73], v7 offset:45056
    ds_read_b64_tr_b16 v[74:75], v7 offset:46080
    ds_read_b128 v[44:47], v6 offset:35840
    ds_read_b64_tr_b16 v[76:77], v7 offset:47104
    ds_read_b64_tr_b16 v[78:79], v7 offset:48128
    v_mfma_f32_32x32x16_bf16 v[96:111], v[88:91], v[56:59], v[96:111]
    v_mfma_f32_32x32x16_bf16 v[96:111], v[92:95], v[60:63], v[96:111]
    s_waitcnt lgkmcnt(0)
    s_barrier
    v_mfma_f32_32x32x16_bf16 v[96:111], v[64:67], v[32:35], v[96:111]
    ds_read_b128 v[48:51], v6 offset:40960
    ds_read_b64_tr_b16 v[80:81], v7 offset:49152
    ds_read_b64_tr_b16 v[82:83], v7 offset:50176
    ds_read_b128 v[52:55], v6 offset:41984
    ds_read_b64_tr_b16 v[84:85], v7 offset:51200
    ds_read_b64_tr_b16 v[86:87], v7 offset:52224
    v_mfma_f32_32x32x16_bf16 v[96:111], v[68:71], v[36:39], v[96:111]
    ds_read_b128 v[56:59], v6 offset:43008
    ds_read_b64_tr_b16 v[88:89], v7 offset:53248
    ds_read_b64_tr_b16 v[90:91], v7 offset:54272
    ds_read_b128 v[60:63], v6 offset:44032
    ds_read_b64_tr_b16 v[92:93], v7 offset:55296
    ds_read_b64_tr_b16 v[94:95], v7 offset:56320
    v_mfma_f32_32x32x16_bf16 v[96:111], v[72:75], v[40:43], v[96:111]
    v_mfma_f32_32x32x16_bf16 v[96:111], v[76:79], v[44:47], v[96:111]
    s_waitcnt lgkmcnt(0)
    s_barrier
    v_mfma_f32_32x32x16_bf16 v[96:111], v[80:83], v[48:51], v[96:111]
    ds_read_b128 v[32:35], v6 offset:0
    ds_read_b64_tr_b16 v[64:65], v7 offset:57344
    ds_read_b64_tr_b16 v[66:67], v7 offset:58368
    ds_read_b128 v[36:39], v6 offset:1024
    ds_read_b64_tr_b16 v[68:69], v7 offset:59392
    ds_read_b64_tr_b16 v[70:71], v7 offset:60416
    v_mfma_f32_32x32x16_bf16 v[96:111], v[84:87], v[52:55], v[96:111]
    ds_read_b128 v[40:43], v6 offset:2048
    ds_read_b64_tr_b16 v[72:73], v7 offset:61440
    ds_read_b64_tr_b16 v[74:75], v7 offset:62464
    ds_read_b128 v[44:47], v6 offset:3072
    ds_read_b64_tr_b16 v[76:77], v7 offset:63488
    ds_read_b64_tr_b16 v[78:79], v7 offset:64512
    v_mfma_f32_32x32x16_bf16 v[96:111], v[88:91], v[56:59], v[96:111]
    v_mfma_f32_32x32x16_bf16 v[96:111], v[92:95], v[60:63], v[96:111]
    s_waitcnt lgkmcnt(0)
    s_barrier
    v_mfma_f32_32x32x16_bf16 v[96:111], v[64:67], v[32:35], v[96:111]
    ds_read_b128 v[48:51], v6 offset:8192
    ds_read_b64_tr_b16 v[80:81], v8 offset:0
    ds_read_b64_tr_b16 v[82:83], v8 offset:1024
    ds_read_b128 v[52:55], v6 offset:9216
    ds_read_b64_tr_b16 v[84:85], v8 offset:2048
    ds_read_b64_tr_b16 v[86:87], v8 offset:3072
    v_mfma_f32_32x32x16_bf16 v[96:111], v[68:71], v[36:39], v[96:111]
    ds_read_b128 v[56:59], v6 offset:10240
    ds_read_b64_tr_b16 v[88:89], v8 offset:4096
    ds_read_b64_tr_b16 v[90:91], v8 offset:5120
    ds_read_b128 v[60:63], v6 offset:11264
    ds_read_b64_tr_b16 v[92:93], v8 offset:6144
    ds_read_b64_tr_b16 v[94:95], v8 offset:7168
    v_mfma_f32_32x32x16_bf16 v[96:111], v[72:75], v[40:43], v[96:111]
    v_mfma_f32_32x32x16_bf16 v[96:111], v[76:79], v[44:47], v[96:111]
    s_waitcnt lgkmcnt(0)
    s_barrier
    v_mfma_f32_32x32x16_bf16 v[96:111], v[80:83], v[48:51], v[96:111]
    ds_read_b128 v[32:35], v6 offset:16384
    ds_read_b64_tr_b16 v[64:65], v8 offset:8192
    ds_read_b64_tr_b16 v[66:67], v8 offset:9216
    ds_read_b128 v[36:39], v6 offset:17408
    ds_read_b64_tr_b16 v[68:69], v8 offset:10240
    ds_read_b64_tr_b16 v[70:71], v8 offset:11264
    v_mfma_f32_32x32x16_bf16 v[96:111], v[84:87], v[52:55], v[96:111]
    ds_read_b128 v[40:43], v6 offset:18432
    ds_read_b64_tr_b16 v[72:73], v8 offset:12288
    ds_read_b64_tr_b16 v[74:75], v8 offset:13312
    ds_read_b128 v[44:47], v6 offset:19456
    ds_read_b64_tr_b16 v[76:77], v8 offset:14336
    ds_read_b64_tr_b16 v[78:79], v8 offset:15360
    v_mfma_f32_32x32x16_bf16 v[96:111], v[88:91], v[56:59], v[96:111]
    v_mfma_f32_32x32x16_bf16 v[96:111], v[92:95], v[60:63], v[96:111]
    s_waitcnt lgkmcnt(0)
    s_barrier
    v_mfma_f32_32x32x16_bf16 v[96:111], v[64:67], v[32:35], v[96:111]
    ds_read_b128 v[48:51], v6 offset:24576
    ds_read_b64_tr_b16 v[80:81], v8 offset:16384
    ds_read_b64_tr_b16 v[82:83], v8 offset:17408
    ds_read_b128 v[52:55], v6 offset:25600
    ds_read_b64_tr_b16 v[84:85], v8 offset:18432
    ds_read_b64_tr_b16 v[86:87], v8 offset:19456
    v_mfma_f32_32x32x16_bf16 v[96:111], v[68:71], v[36:39], v[96:111]
    ds_read_b128 v[56:59], v6 offset:26624
    ds_read_b64_tr_b16 v[88:89], v8 offset:20480
    ds_read_b64_tr_b16 v[90:91], v8 offset:21504
    ds_read_b128 v[60:63], v6 offset:27648
    ds_read_b64_tr_b16 v[92:93], v8 offset:22528
    ds_read_b64_tr_b16 v[94:95], v8 offset:23552
    v_mfma_f32_32x32x16_bf16 v[96:111], v[72:75], v[40:43], v[96:111]
    v_mfma_f32_32x32x16_bf16 v[96:111], v[76:79], v[44:47], v[96:111]
    s_waitcnt lgkmcnt(0)
    s_barrier
    v_mfma_f32_32x32x16_bf16 v[96:111], v[80:83], v[48:51], v[96:111]
    ds_read_b128 v[32:35], v6 offset:32768
    ds_read_b64_tr_b16 v[64:65], v8 offset:24576
    ds_read_b64_tr_b16 v[66:67], v8 offset:25600
    ds_read_b128 v[36:39], v6 offset:33792
    ds_read_b64_tr_b16 v[68:69], v8 offset:26624
    ds_read_b64_tr_b16 v[70:71], v8 offset:27648
    v_mfma_f32_32x32x16_bf16 v[96:111], v[84:87], v[52:55], v[96:111]
    ds_read_b128 v[40:43], v6 offset:34816
    ds_read_b64_tr_b16 v[72:73], v8 offset:28672
    ds_read_b64_tr_b16 v[74:75], v8 offset:29696
    ds_read_b128 v[44:47], v6 offset:35840
    ds_read_b64_tr_b16 v[76:77], v8 offset:30720
    ds_read_b64_tr_b16 v[78:79], v8 offset:31744
    v_mfma_f32_32x32x16_bf16 v[96:111], v[88:91], v[56:59], v[96:111]
    v_mfma_f32_32x32x16_bf16 v[96:111], v[92:95], v[60:63], v[96:111]
    s_waitcnt lgkmcnt(0)
    s_barrier
    v_mfma_f32_32x32x16_bf16 v[96:111], v[64:67], v[32:35], v[96:111]
    ds_read_b128 v[48:51], v6 offset:40960
    ds_read_b64_tr_b16 v[80:81], v8 offset:32768
    ds_read_b64_tr_b16 v[82:83], v8 offset:33792
    ds_read_b128 v[52:55], v6 offset:41984
    ds_read_b64_tr_b16 v[84:85], v8 offset:34816
    ds_read_b64_tr_b16 v[86:87], v8 offset:35840
    v_mfma_f32_32x32x16_bf16 v[96:111], v[68:71], v[36:39], v[96:111]
    ds_read_b128 v[56:59], v6 offset:43008
    ds_read_b64_tr_b16 v[88:89], v8 offset:36864
    ds_read_b64_tr_b16 v[90:91], v8 offset:37888
    ds_read_b128 v[60:63], v6 offset:44032
    ds_read_b64_tr_b16 v[92:93], v8 offset:38912
    ds_read_b64_tr_b16 v[94:95], v8 offset:39936
    v_mfma_f32_32x32x16_bf16 v[96:111], v[72:75], v[40:43], v[96:111]
    v_mfma_f32_32x32x16_bf16 v[96:111], v[76:79], v[44:47], v[96:111]
    s_waitcnt lgkmcnt(0)
    s_barrier
    v_mfma_f32_32x32x16_bf16 v[96:111], v[80:83], v[48:51], v[96:111]
    ds_read_b128 v[32:35], v6 offset:0
    ds_read_b64_tr_b16 v[64:65], v7 offset:0
    ds_read_b64_tr_b16 v[66:67], v7 offset:1024
    ds_read_b128 v[36:39], v6 offset:1024
    ds_read_b64_tr_b16 v[68:69], v7 offset:2048
    ds_read_b64_tr_b16 v[70:71], v7 offset:3072
    v_mfma_f32_32x32x16_bf16 v[96:111], v[84:87], v[52:55], v[96:111]
    ds_read_b128 v[40:43], v6 offset:2048
    ds_read_b64_tr_b16 v[72:73], v7 offset:4096
    ds_read_b64_tr_b16 v[74:75], v7 offset:5120
    ds_read_b128 v[44:47], v6 offset:3072
    ds_read_b64_tr_b16 v[76:77], v7 offset:6144
    ds_read_b64_tr_b16 v[78:79], v7 offset:7168
    v_mfma_f32_32x32x16_bf16 v[96:111], v[88:91], v[56:59], v[96:111]
    v_mfma_f32_32x32x16_bf16 v[96:111], v[92:95], v[60:63], v[96:111]
    s_waitcnt lgkmcnt(0)
    s_barrier
    v_mfma_f32_32x32x16_bf16 v[96:111], v[64:67], v[32:35], v[96:111]
    ds_read_b128 v[48:51], v6 offset:8192
    ds_read_b64_tr_b16 v[80:81], v7 offset:8192
    ds_read_b64_tr_b16 v[82:83], v7 offset:9216
    ds_read_b128 v[52:55], v6 offset:9216
    ds_read_b64_tr_b16 v[84:85], v7 offset:10240
    ds_read_b64_tr_b16 v[86:87], v7 offset:11264
    v_mfma_f32_32x32x16_bf16 v[96:111], v[68:71], v[36:39], v[96:111]
    ds_read_b128 v[56:59], v6 offset:10240
    ds_read_b64_tr_b16 v[88:89], v7 offset:12288
    ds_read_b64_tr_b16 v[90:91], v7 offset:13312
    ds_read_b128 v[60:63], v6 offset:11264
    ds_read_b64_tr_b16 v[92:93], v7 offset:14336
    ds_read_b64_tr_b16 v[94:95], v7 offset:15360
    v_mfma_f32_32x32x16_bf16 v[96:111], v[72:75], v[40:43], v[96:111]
    v_mfma_f32_32x32x16_bf16 v[96:111], v[76:79], v[44:47], v[96:111]
    s_waitcnt lgkmcnt(0)
    s_barrier
    v_mfma_f32_32x32x16_bf16 v[96:111], v[80:83], v[48:51], v[96:111]
    ds_read_b128 v[32:35], v6 offset:16384
    ds_read_b64_tr_b16 v[64:65], v7 offset:16384
    ds_read_b64_tr_b16 v[66:67], v7 offset:17408
    ds_read_b128 v[36:39], v6 offset:17408
    ds_read_b64_tr_b16 v[68:69], v7 offset:18432
    ds_read_b64_tr_b16 v[70:71], v7 offset:19456
    v_mfma_f32_32x32x16_bf16 v[96:111], v[84:87], v[52:55], v[96:111]
    ds_read_b128 v[40:43], v6 offset:18432
    ds_read_b64_tr_b16 v[72:73], v7 offset:20480
    ds_read_b64_tr_b16 v[74:75], v7 offset:21504
    ds_read_b128 v[44:47], v6 offset:19456
    ds_read_b64_tr_b16 v[76:77], v7 offset:22528
    ds_read_b64_tr_b16 v[78:79], v7 offset:23552
    v_mfma_f32_32x32x16_bf16 v[96:111], v[88:91], v[56:59], v[96:111]
    v_mfma_f32_32x32x16_bf16 v[96:111], v[92:95], v[60:63], v[96:111]
    s_waitcnt lgkmcnt(0)
    s_barrier
    v_mfma_f32_32x32x16_bf16 v[96:111], v[64:67], v[32:35], v[96:111]
    ds_read_b128 v[48:51], v6 offset:24576
    ds_read_b64_tr_b16 v[80:81], v7 offset:24576
    ds_read_b64_tr_b16 v[82:83], v7 offset:25600
    ds_read_b128 v[52:55], v6 offset:25600
    ds_read_b64_tr_b16 v[84:85], v7 offset:26624
    ds_read_b64_tr_b16 v[86:87], v7 offset:27648
    v_mfma_f32_32x32x16_bf16 v[96:111], v[68:71], v[36:39], v[96:111]
    ds_read_b128 v[56:59], v6 offset:26624
    ds_read_b64_tr_b16 v[88:89], v7 offset:28672
    ds_read_b64_tr_b16 v[90:91], v7 offset:29696
    ds_read_b128 v[60:63], v6 offset:27648
    ds_read_b64_tr_b16 v[92:93], v7 offset:30720
    ds_read_b64_tr_b16 v[94:95], v7 offset:31744
    v_mfma_f32_32x32x16_bf16 v[96:111], v[72:75], v[40:43], v[96:111]
    v_mfma_f32_32x32x16_bf16 v[96:111], v[76:79], v[44:47], v[96:111]
    s_waitcnt lgkmcnt(0)
    s_barrier
    v_mfma_f32_32x32x16_bf16 v[96:111], v[80:83], v[48:51], v[96:111]
    ds_read_b128 v[32:35], v6 offset:32768
    ds_read_b64_tr_b16 v[64:65], v7 offset:32768
    ds_read_b64_tr_b16 v[66:67], v7 offset:33792
    ds_read_b128 v[36:39], v6 offset:33792
    ds_read_b64_tr_b16 v[68:69], v7 offset:34816
    ds_read_b64_tr_b16 v[70:71], v7 offset:35840
    v_mfma_f32_32x32x16_bf16 v[96:111], v[84:87], v[52:55], v[96:111]
    ds_read_b128 v[40:43], v6 offset:34816
    ds_read_b64_tr_b16 v[72:73], v7 offset:36864
    ds_read_b64_tr_b16 v[74:75], v7 offset:37888
    ds_read_b128 v[44:47], v6 offset:35840
    ds_read_b64_tr_b16 v[76:77], v7 offset:38912
    ds_read_b64_tr_b16 v[78:79], v7 offset:39936
    v_mfma_f32_32x32x16_bf16 v[96:111], v[88:91], v[56:59], v[96:111]
    v_mfma_f32_32x32x16_bf16 v[96:111], v[92:95], v[60:63], v[96:111]
    s_waitcnt lgkmcnt(0)
    s_barrier
    v_mfma_f32_32x32x16_bf16 v[96:111], v[64:67], v[32:35], v[96:111]
    ds_read_b128 v[48:51], v6 offset:40960
    ds_read_b64_tr_b16 v[80:81], v7 offset:40960
    ds_read_b64_tr_b16 v[82:83], v7 offset:41984
    ds_read_b128 v[52:55], v6 offset:41984
    ds_read_b64_tr_b16 v[84:85], v7 offset:43008
    ds_read_b64_tr_b16 v[86:87], v7 offset:44032
    v_mfma_f32_32x32x16_bf16 v[96:111], v[68:71], v[36:39], v[96:111]
    ds_read_b128 v[56:59], v6 offset:43008
    ds_read_b64_tr_b16 v[88:89], v7 offset:45056
    ds_read_b64_tr_b16 v[90:91], v7 offset:46080
    ds_read_b128 v[60:63], v6 offset:44032
    ds_read_b64_tr_b16 v[92:93], v7 offset:47104
    ds_read_b64_tr_b16 v[94:95], v7 offset:48128
    v_mfma_f32_32x32x16_bf16 v[96:111], v[72:75], v[40:43], v[96:111]
    v_mfma_f32_32x32x16_bf16 v[96:111], v[76:79], v[44:47], v[96:111]
    s_waitcnt lgkmcnt(0)
    s_barrier
    v_mfma_f32_32x32x16_bf16 v[96:111], v[80:83], v[48:51], v[96:111]
    ds_read_b128 v[32:35], v6 offset:0
    ds_read_b64_tr_b16 v[64:65], v7 offset:49152
    ds_read_b64_tr_b16 v[66:67], v7 offset:50176
    ds_read_b128 v[36:39], v6 offset:1024
    ds_read_b64_tr_b16 v[68:69], v7 offset:51200
    ds_read_b64_tr_b16 v[70:71], v7 offset:52224
    v_mfma_f32_32x32x16_bf16 v[96:111], v[84:87], v[52:55], v[96:111]
    ds_read_b128 v[40:43], v6 offset:2048
    ds_read_b64_tr_b16 v[72:73], v7 offset:53248
    ds_read_b64_tr_b16 v[74:75], v7 offset:54272
    ds_read_b128 v[44:47], v6 offset:3072
    ds_read_b64_tr_b16 v[76:77], v7 offset:55296
    ds_read_b64_tr_b16 v[78:79], v7 offset:56320
    v_mfma_f32_32x32x16_bf16 v[96:111], v[88:91], v[56:59], v[96:111]
    v_mfma_f32_32x32x16_bf16 v[96:111], v[92:95], v[60:63], v[96:111]
    s_waitcnt lgkmcnt(0)
    s_barrier
    v_mfma_f32_32x32x16_bf16 v[96:111], v[64:67], v[32:35], v[96:111]
    ds_read_b128 v[48:51], v6 offset:8192
    ds_read_b64_tr_b16 v[80:81], v7 offset:57344
    ds_read_b64_tr_b16 v[82:83], v7 offset:58368
    ds_read_b128 v[52:55], v6 offset:9216
    ds_read_b64_tr_b16 v[84:85], v7 offset:59392
    ds_read_b64_tr_b16 v[86:87], v7 offset:60416
    v_mfma_f32_32x32x16_bf16 v[96:111], v[68:71], v[36:39], v[96:111]
    ds_read_b128 v[56:59], v6 offset:10240
    ds_read_b64_tr_b16 v[88:89], v7 offset:61440
    ds_read_b64_tr_b16 v[90:91], v7 offset:62464
    ds_read_b128 v[60:63], v6 offset:11264
    ds_read_b64_tr_b16 v[92:93], v7 offset:63488
    ds_read_b64_tr_b16 v[94:95], v7 offset:64512
    v_mfma_f32_32x32x16_bf16 v[96:111], v[72:75], v[40:43], v[96:111]
    v_mfma_f32_32x32x16_bf16 v[96:111], v[76:79], v[44:47], v[96:111]
    s_waitcnt lgkmcnt(0)
    s_barrier
    v_mfma_f32_32x32x16_bf16 v[96:111], v[80:83], v[48:51], v[96:111]
    ds_read_b128 v[32:35], v6 offset:16384
    ds_read_b64_tr_b16 v[64:65], v8 offset:0
    ds_read_b64_tr_b16 v[66:67], v8 offset:1024
    ds_read_b128 v[36:39], v6 offset:17408
    ds_read_b64_tr_b16 v[68:69], v8 offset:2048
    ds_read_b64_tr_b16 v[70:71], v8 offset:3072
    v_mfma_f32_32x32x16_bf16 v[96:111], v[84:87], v[52:55], v[96:111]
    ds_read_b128 v[40:43], v6 offset:18432
    ds_read_b64_tr_b16 v[72:73], v8 offset:4096
    ds_read_b64_tr_b16 v[74:75], v8 offset:5120
    ds_read_b128 v[44:47], v6 offset:19456
    ds_read_b64_tr_b16 v[76:77], v8 offset:6144
    ds_read_b64_tr_b16 v[78:79], v8 offset:7168
    v_mfma_f32_32x32x16_bf16 v[96:111], v[88:91], v[56:59], v[96:111]
    v_mfma_f32_32x32x16_bf16 v[96:111], v[92:95], v[60:63], v[96:111]
    s_waitcnt lgkmcnt(0)
    s_barrier
    v_mfma_f32_32x32x16_bf16 v[96:111], v[64:67], v[32:35], v[96:111]
    ds_read_b128 v[48:51], v6 offset:24576
    ds_read_b64_tr_b16 v[80:81], v8 offset:8192
    ds_read_b64_tr_b16 v[82:83], v8 offset:9216
    ds_read_b128 v[52:55], v6 offset:25600
    ds_read_b64_tr_b16 v[84:85], v8 offset:10240
    ds_read_b64_tr_b16 v[86:87], v8 offset:11264
    v_mfma_f32_32x32x16_bf16 v[96:111], v[68:71], v[36:39], v[96:111]
    ds_read_b128 v[56:59], v6 offset:26624
    ds_read_b64_tr_b16 v[88:89], v8 offset:12288
    ds_read_b64_tr_b16 v[90:91], v8 offset:13312
    ds_read_b128 v[60:63], v6 offset:27648
    ds_read_b64_tr_b16 v[92:93], v8 offset:14336
    ds_read_b64_tr_b16 v[94:95], v8 offset:15360
    v_mfma_f32_32x32x16_bf16 v[96:111], v[72:75], v[40:43], v[96:111]
    v_mfma_f32_32x32x16_bf16 v[96:111], v[76:79], v[44:47], v[96:111]
    s_waitcnt lgkmcnt(0)
    v_mfma_f32_32x32x16_bf16 v[96:111], v[80:83], v[48:51], v[96:111]
    v_mfma_f32_32x32x16_bf16 v[96:111], v[84:87], v[52:55], v[96:111]
    v_mfma_f32_32x32x16_bf16 v[96:111], v[88:91], v[56:59], v[96:111]
    v_mfma_f32_32x32x16_bf16 v[96:111], v[92:95], v[60:63], v[96:111]
    s_nop 7
    s_nop 3
    v_cvt_pk_bf16_f32 v112, v96, v97
    v_cvt_pk_bf16_f32 v113, v98, v99
    v_cvt_pk_bf16_f32 v114, v100, v101
    v_cvt_pk_bf16_f32 v115, v102, v103
    v_cvt_pk_bf16_f32 v116, v104, v105
    v_cvt_pk_bf16_f32 v117, v106, v107
    v_cvt_pk_bf16_f32 v118, v108, v109
    v_cvt_pk_bf16_f32 v119, v110, v111
    buffer_store_dwordx2 v[112:113], v231, s[36:39], 0 offen offset:0
    buffer_store_dwordx2 v[114:115], v231, s[36:39], 0 offen offset:16
    buffer_store_dwordx2 v[116:117], v231, s[36:39], 0 offen offset:32
    buffer_store_dwordx2 v[118:119], v231, s[36:39], 0 offen offset:48
    s_endpgm
L_t_loader:
    v_lshrrev_b32 v12, 3, v1
    v_and_b32 v13, 7, v1
    v_bfe_u32 v14, v12, 1, 1
    v_lshlrev_b32 v14, 2, v14
    v_xor_b32 v14, v14, v13
    v_lshlrev_b32 v14, 4, v14
    s_lshl_b32 s55, s44, 4
    v_add_u32 v12, s55, v12
    v_lshl_add_u32 v14, v12, 10, v14
    s_lshl_b32 s56, s50, 7
    v_add_u32 v5, s56, v14
    v_lshrrev_b32 v12, 4, v1
    v_and_b32 v13, 15, v1
    v_lshlrev_b32 v14, 2, v12
    v_xor_b32 v14, v14, v13
    v_lshlrev_b32 v14, 4, v14
    s_lshl_b32 s55, s44, 3
    v_add_u32 v12, s55, v12
    v_mul_u32_u24 v12, 3584, v12
    v_add_u32 v14, v14, v12
    s_lshl_b32 s56, s48, 8
    v_add_u32 v7, s56, v14
    v_mov_b32 v8, 1
    s_lshl_b32 s52, s44, 11
    s_mov_b32 s32, s8
    s_and_b32 s33, s9, 0xffff
    s_mov_b32 s34, 524288
    s_mov_b32 s35, 0x20000
    s_mov_b32 s36, s12
    s_and_b32 s37, s13, 0xffff
    s_mov_b32 s38, 1835008
    s_mov_b32 s39, 0x20000
    s_mov_b32 s40, s16
    s_and_b32 s41, s17, 0xffff
    s_mov_b32 s42, 1835008
    s_mov_b32 s43, 0x20000
    s_cmp_ge_u32 s48, 14
    s_cbranch_scc1 L_t_lb
    s_lshl_b32 s57, s49, 1
    s_add_u32 s57, s57, s45
    s_mul_i32 s57, s57, 32
    s_lshl_b32 s55, s46, 1
    s_add_u32 s57, s57, s55
    s_lshl_b32 s57, s57, 10
    s_add_u32 s57, s57, 8388608
    s_lshl_b32 s51, s45, 12
    s_lshl_b32 s55, s46, 11
    s_add_u32 s51, s51, s55
    s_waitcnt vmcnt(0)
    v_mov_b32 v8, 163776
    v_mov_b32 v9, 1
    s_mov_b64 exec, 1
    ds_add_rtn_u32 v9, v8, v9
    s_waitcnt lgkmcnt(0)
    v_readfirstlane_b32 s56, v9
    s_mov_b64 exec, -1
    s_cmp_lg_u32 s56, 7
    s_cbranch_scc1 L_h2la_np
    s_lshr_b32 s55, s2, 5
    s_lshl_b32 s55, s55, 13
    s_add_u32 s55, s55, 6422528
    s_lshl_b32 s56, s76, 5
    s_add_u32 s55, s55, s56
    v_mov_b32 v8, 0
    v_mov_b32 v9, s11
    s_mov_b64 exec, 1
    buffer_store_dword v9, v8, s[28:31], s55 offen sc1
    s_mov_b64 exec, -1
L_h2la_np:
    s_add_u32 m0, s52, 0
    s_mov_b32 s54, 0
    buffer_load_dwordx4 v5, s[32:35], s54 offen lds
    s_add_u32 m0, s52, 1024
    s_mov_b32 s54, 8192
    buffer_load_dwordx4 v5, s[32:35], s54 offen lds
    s_add_u32 m0, s52, 8192
    s_mov_b32 s54, 65536
    buffer_load_dwordx4 v5, s[32:35], s54 offen lds
    s_add_u32 m0, s52, 9216
    s_mov_b32 s54, 73728
    buffer_load_dwordx4 v5, s[32:35], s54 offen lds
    s_add_u32 m0, s52, 16384
    s_mov_b32 s54, 131072
    buffer_load_dwordx4 v5, s[32:35], s54 offen lds
    s_add_u32 m0, s52, 17408
    s_mov_b32 s54, 139264
    buffer_load_dwordx4 v5, s[32:35], s54 offen lds
    s_add_u32 m0, s52, 24576
    s_mov_b32 s54, 196608
    buffer_load_dwordx4 v5, s[32:35], s54 offen lds
    s_add_u32 m0, s52, 25600
    s_mov_b32 s54, 204800
    buffer_load_dwordx4 v5, s[32:35], s54 offen lds
    s_add_u32 m0, s52, 32768
    s_mov_b32 s54, 262144
    buffer_load_dwordx4 v5, s[32:35], s54 offen lds
    s_add_u32 m0, s52, 33792
    s_mov_b32 s54, 270336
    buffer_load_dwordx4 v5, s[32:35], s54 offen lds
    s_add_u32 m0, s52, 40960
    s_mov_b32 s54, 327680
    buffer_load_dwordx4 v5, s[32:35], s54 offen lds
    s_add_u32 m0, s52, 41984
    s_mov_b32 s54, 335872
    buffer_load_dwordx4 v5, s[32:35], s54 offen lds
    s_add_u32 m0, s52, 49152
    s_mov_b32 s54, 393216
    buffer_load_dwordx4 v5, s[32:35], s54 offen lds
    s_add_u32 m0, s52, 50176
    s_mov_b32 s54, 401408
    buffer_load_dwordx4 v5, s[32:35], s54 offen lds
    s_add_u32 m0, s52, 57344
    s_mov_b32 s54, 458752
    buffer_load_dwordx4 v5, s[32:35], s54 offen lds
    s_add_u32 m0, s52, 58368
    s_mov_b32 s54, 466944
    buffer_load_dwordx4 v5, s[32:35], s54 offen lds
    s_barrier
    s_add_u32 m0, s51, 106496
    s_add_u32 s53, s57, 0
    buffer_load_dwordx4 v4, s[28:31], s53 offen sc1 lds
    buffer_load_dwordx4 v4, s[28:31], s53 offen offset:1024 sc1 lds
    s_add_u32 m0, s51, 114688
    s_add_u32 s53, s57, 4096
    buffer_load_dwordx4 v4, s[28:31], s53 offen sc1 lds
    buffer_load_dwordx4 v4, s[28:31], s53 offen offset:1024 sc1 lds
    s_add_u32 m0, s51, 122880
    s_add_u32 s53, s57, 8192
    buffer_load_dwordx4 v4, s[28:31], s53 offen sc1 lds
    buffer_load_dwordx4 v4, s[28:31], s53 offen offset:1024 sc1 lds
    s_add_u32 m0, s51, 131072
    s_add_u32 s53, s57, 12288
    buffer_load_dwordx4 v4, s[28:31], s53 offen sc1 lds
    buffer_load_dwordx4 v4, s[28:31], s53 offen offset:1024 sc1 lds
    s_waitcnt vmcnt(6)
    s_barrier
    s_add_u32 m0, s51, 139264
    s_add_u32 s53, s57, 16384
    buffer_load_dwordx4 v4, s[28:31], s53 offen sc1 lds
    buffer_load_dwordx4 v4, s[28:31], s53 offen offset:1024 sc1 lds
    s_add_u32 m0, s51, 147456
    s_add_u32 s53, s57, 20480
    buffer_load_dwordx4 v4, s[28:31], s53 offen sc1 lds
    buffer_load_dwordx4 v4, s[28:31], s53 offen offset:1024 sc1 lds
    s_waitcnt vmcnt(8)
    s_barrier
    s_add_u32 m0, s51, 106496
    s_add_u32 s53, s57, 24576
    buffer_load_dwordx4 v4, s[28:31], s53 offen sc1 lds
    buffer_load_dwordx4 v4, s[28:31], s53 offen offset:1024 sc1 lds
    s_waitcnt vmcnt(8)
    s_barrier
    s_add_u32 m0, s51, 114688
    s_add_u32 s53, s57, 28672
    buffer_load_dwordx4 v4, s[28:31], s53 offen sc1 lds
    buffer_load_dwordx4 v4, s[28:31], s53 offen offset:1024 sc1 lds
    s_waitcnt vmcnt(8)
    s_barrier
    s_waitcnt vmcnt(6)
    s_barrier
    s_waitcnt vmcnt(4)
    s_barrier
    s_waitcnt vmcnt(2)
    s_barrier
    s_waitcnt vmcnt(0)
    s_barrier
    s_add_u32 m0, s52, 65536
    s_mov_b32 s54, 0
    buffer_load_dwordx4 v7, s[36:39], s54 offen lds
    s_add_u32 m0, s52, 66560
    s_mov_b32 s54, 14336
    buffer_load_dwordx4 v7, s[36:39], s54 offen lds
    s_add_u32 m0, s52, 73728
    s_mov_b32 s54, 114688
    buffer_load_dwordx4 v7, s[36:39], s54 offen lds
    s_add_u32 m0, s52, 74752
    s_mov_b32 s54, 129024
    buffer_load_dwordx4 v7, s[36:39], s54 offen lds
    s_add_u32 m0, s52, 81920
    s_mov_b32 s54, 229376
    buffer_load_dwordx4 v7, s[36:39], s54 offen lds
    s_add_u32 m0, s52, 82944
    s_mov_b32 s54, 243712
    buffer_load_dwordx4 v7, s[36:39], s54 offen lds
    s_add_u32 m0, s52, 90112
    s_mov_b32 s54, 344064
    buffer_load_dwordx4 v7, s[36:39], s54 offen lds
    s_add_u32 m0, s52, 91136
    s_mov_b32 s54, 358400
    buffer_load_dwordx4 v7, s[36:39], s54 offen lds
    s_lshl_b32 s57, s47, 2
    s_add_u32 s57, s57, s44
    s_lshl_b32 s57, s57, 15
    s_add_u32 s57, s57, 10485760
    s_lshl_b32 s51, s44, 11
    s_barrier
    s_add_u32 m0, s51, 106496
    s_add_u32 s53, s57, 0
    buffer_load_dwordx4 v4, s[28:31], s53 offen sc1 lds
    buffer_load_dwordx4 v4, s[28:31], s53 offen offset:1024 sc1 lds
    s_add_u32 m0, s51, 114688
    s_add_u32 s53, s57, 2048
    buffer_load_dwordx4 v4, s[28:31], s53 offen sc1 lds
    buffer_load_dwordx4 v4, s[28:31], s53 offen offset:1024 sc1 lds
    s_add_u32 m0, s51, 122880
    s_add_u32 s53, s57, 4096
    buffer_load_dwordx4 v4, s[28:31], s53 offen sc1 lds
    buffer_load_dwordx4 v4, s[28:31], s53 offen offset:1024 sc1 lds
    s_add_u32 m0, s51, 131072
    s_add_u32 s53, s57, 6144
    buffer_load_dwordx4 v4, s[28:31], s53 offen sc1 lds
    buffer_load_dwordx4 v4, s[28:31], s53 offen offset:1024 sc1 lds
    s_waitcnt vmcnt(6)
    s_barrier
    s_add_u32 m0, s51, 139264
    s_add_u32 s53, s57, 8192
    buffer_load_dwordx4 v4, s[28:31], s53 offen sc1 lds
    buffer_load_dwordx4 v4, s[28:31], s53 offen offset:1024 sc1 lds
    s_add_u32 m0, s51, 147456
    s_add_u32 s53, s57, 10240
    buffer_load_dwordx4 v4, s[28:31], s53 offen sc1 lds
    buffer_load_dwordx4 v4, s[28:31], s53 offen offset:1024 sc1 lds
    s_add_u32 m0, s52, 98304
    s_mov_b32 s54, 458752
    buffer_load_dwordx4 v7, s[36:39], s54 offen lds
    s_add_u32 m0, s52, 99328
    s_mov_b32 s54, 473088
    buffer_load_dwordx4 v7, s[36:39], s54 offen lds
    s_waitcnt vmcnt(10)
    s_barrier
    s_add_u32 m0, s51, 106496
    s_add_u32 s53, s57, 12288
    buffer_load_dwordx4 v4, s[28:31], s53 offen sc1 lds
    buffer_load_dwordx4 v4, s[28:31], s53 offen offset:1024 sc1 lds
    s_lshl_b32 s55, s47, 7
    s_lshl_b32 s56, s44, 5
    s_add_u32 s55, s55, s56
    s_lshl_b32 s55, s55, 3
    s_add_u32 s55, s55, 7340032
    v_lshlrev_b32 v10, 3, v2
    v_lshl_add_u32 v12, v3, 17, v10
    s_add_u32 s56, s55, 0
    buffer_load_dwordx2 v[32:33], v12, s[28:31], s56 offen sc1
    s_add_u32 s56, s55, 16384
    buffer_load_dwordx2 v[34:35], v12, s[28:31], s56 offen sc1
    s_add_u32 s56, s55, 32768
    buffer_load_dwordx2 v[36:37], v12, s[28:31], s56 offen sc1
    s_add_u32 s56, s55, 49152
    buffer_load_dwordx2 v[38:39], v12, s[28:31], s56 offen sc1
    s_add_u32 s56, s55, 65536
    buffer_load_dwordx2 v[40:41], v12, s[28:31], s56 offen sc1
    s_add_u32 s56, s55, 81920
    buffer_load_dwordx2 v[42:43], v12, s[28:31], s56 offen sc1
    s_add_u32 s56, s55, 98304
    buffer_load_dwordx2 v[44:45], v12, s[28:31], s56 offen sc1
    s_add_u32 s56, s55, 114688
    buffer_load_dwordx2 v[46:47], v12, s[28:31], s56 offen sc1
    s_add_u32 m0, s52, 0
    s_mov_b32 s54, 573440
    buffer_load_dwordx4 v7, s[36:39], s54 offen lds
    s_add_u32 m0, s52, 1024
    s_mov_b32 s54, 587776
    buffer_load_dwordx4 v7, s[36:39], s54 offen lds
    s_waitcnt vmcnt(20)
    s_barrier
    s_add_u32 m0, s51, 114688
    s_add_u32 s53, s57, 14336
    buffer_load_dwordx4 v4, s[28:31], s53 offen sc1 lds
    buffer_load_dwordx4 v4, s[28:31], s53 offen offset:1024 sc1 lds
    s_add_u32 m0, s52, 8192
    s_mov_b32 s54, 688128
    buffer_load_dwordx4 v7, s[36:39], s54 offen lds
    s_add_u32 m0, s52, 9216
    s_mov_b32 s54, 702464
    buffer_load_dwordx4 v7, s[36:39], s54 offen lds
    s_waitcnt vmcnt(22)
    s_barrier
    s_add_u32 m0, s51, 122880
    s_add_u32 s53, s57, 16384
    buffer_load_dwordx4 v4, s[28:31], s53 offen sc1 lds
    buffer_load_dwordx4 v4, s[28:31], s53 offen offset:1024 sc1 lds
    s_add_u32 m0, s52, 16384
    s_mov_b32 s54, 802816
    buffer_load_dwordx4 v7, s[36:39], s54 offen lds
    s_add_u32 m0, s52, 17408
    s_mov_b32 s54, 817152
    buffer_load_dwordx4 v7, s[36:39], s54 offen lds
    s_waitcnt vmcnt(20)
    s_barrier
    s_add_u32 m0, s51, 131072
    s_add_u32 s53, s57, 18432
    buffer_load_dwordx4 v4, s[28:31], s53 offen sc1 lds
    buffer_load_dwordx4 v4, s[28:31], s53 offen offset:1024 sc1 lds
    s_add_u32 m0, s52, 24576
    s_mov_b32 s54, 917504
    buffer_load_dwordx4 v7, s[36:39], s54 offen lds
    s_add_u32 m0, s52, 25600
    s_mov_b32 s54, 931840
    buffer_load_dwordx4 v7, s[36:39], s54 offen lds
    s_waitcnt vmcnt(12)
    s_barrier
    s_add_u32 m0, s51, 139264
    s_add_u32 s53, s57, 20480
    buffer_load_dwordx4 v4, s[28:31], s53 offen sc1 lds
    buffer_load_dwordx4 v4, s[28:31], s53 offen offset:1024 sc1 lds
    s_add_u32 m0, s52, 32768
    s_mov_b32 s54, 1032192
    buffer_load_dwordx4 v7, s[36:39], s54 offen lds
    s_add_u32 m0, s52, 33792
    s_mov_b32 s54, 1046528
    buffer_load_dwordx4 v7, s[36:39], s54 offen lds
    s_waitcnt vmcnt(18)
    v_pk_add_f32 v[32:33], v[32:33], v[34:35]
    v_pk_add_f32 v[32:33], v[32:33], v[36:37]
    v_pk_add_f32 v[32:33], v[32:33], v[38:39]
    v_pk_add_f32 v[32:33], v[32:33], v[40:41]
    v_pk_add_f32 v[32:33], v[32:33], v[42:43]
    v_pk_add_f32 v[32:33], v[32:33], v[44:45]
    v_pk_add_f32 v[32:33], v[32:33], v[46:47]
    v_mov_b32 v13, v32
    s_nop 1
    v_permlane32_swap_b32 v32, v13
    s_nop 1
    v_add_f32 v32, v32, v13
    v_mov_b32 v13, v33
    s_nop 1
    v_permlane32_swap_b32 v33, v13
    s_nop 1
    v_add_f32 v33, v33, v13
    v_mul_f32 v13, 0.001953125, v32
    v_mul_f32 v14, 0.001953125, v33
    v_fma_f32 v14, -v13, v13, v14
    v_max_f32 v14, 0, v14
    v_add_f32 v14, 1e-05, v14
    v_rsq_f32 v34, v14
    s_lshl_b32 s55, s44, 8
    s_add_u32 s55, s55, 155648
    v_mul_f32 v35, v13, v34
    v_sub_f32 v35, 0, v35
    v_add_u32 v10, s55, v10
    ds_write_b64 v10, v[34:35]
    s_waitcnt lgkmcnt(0)
    s_waitcnt vmcnt(12)
    s_barrier
    s_add_u32 m0, s51, 147456
    s_add_u32 s53, s57, 22528
    buffer_load_dwordx4 v4, s[28:31], s53 offen sc1 lds
    buffer_load_dwordx4 v4, s[28:31], s53 offen offset:1024 sc1 lds
    s_add_u32 m0, s52, 40960
    s_mov_b32 s54, 1146880
    buffer_load_dwordx4 v7, s[36:39], s54 offen lds
    s_add_u32 m0, s52, 41984
    s_mov_b32 s54, 1161216
    buffer_load_dwordx4 v7, s[36:39], s54 offen lds
    s_waitcnt vmcnt(12)
    s_barrier
    s_add_u32 m0, s51, 106496
    s_add_u32 s53, s57, 24576
    buffer_load_dwordx4 v4, s[28:31], s53 offen sc1 lds
    buffer_load_dwordx4 v4, s[28:31], s53 offen offset:1024 sc1 lds
    s_add_u32 m0, s52, 49152
    s_mov_b32 s54, 1261568
    buffer_load_dwordx4 v7, s[36:39], s54 offen lds
    s_add_u32 m0, s52, 50176
    s_mov_b32 s54, 1275904
    buffer_load_dwordx4 v7, s[36:39], s54 offen lds
    s_waitcnt vmcnt(12)
    s_barrier
    s_add_u32 m0, s51, 114688
    s_add_u32 s53, s57, 26624
    buffer_load_dwordx4 v4, s[28:31], s53 offen sc1 lds
    buffer_load_dwordx4 v4, s[28:31], s53 offen offset:1024 sc1 lds
    s_add_u32 m0, s52, 57344
    s_mov_b32 s54, 1376256
    buffer_load_dwordx4 v7, s[36:39], s54 offen lds
    s_add_u32 m0, s52, 58368
    s_mov_b32 s54, 1390592
    buffer_load_dwordx4 v7, s[36:39], s54 offen lds
    s_waitcnt vmcnt(12)
    s_barrier
    s_add_u32 m0, s51, 122880
    s_add_u32 s53, s57, 28672
    buffer_load_dwordx4 v4, s[28:31], s53 offen sc1 lds
    buffer_load_dwordx4 v4, s[28:31], s53 offen offset:1024 sc1 lds
    s_add_u32 m0, s52, 65536
    s_mov_b32 s54, 1490944
    buffer_load_dwordx4 v7, s[36:39], s54 offen lds
    s_add_u32 m0, s52, 66560
    s_mov_b32 s54, 1505280
    buffer_load_dwordx4 v7, s[36:39], s54 offen lds
    s_waitcnt vmcnt(12)
    s_barrier
    s_add_u32 m0, s51, 131072
    s_add_u32 s53, s57, 30720
    buffer_load_dwordx4 v4, s[28:31], s53 offen sc1 lds
    buffer_load_dwordx4 v4, s[28:31], s53 offen offset:1024 sc1 lds
    s_add_u32 m0, s52, 73728
    s_mov_b32 s54, 1605632
    buffer_load_dwordx4 v7, s[36:39], s54 offen lds
    s_add_u32 m0, s52, 74752
    s_mov_b32 s54, 1619968
    buffer_load_dwordx4 v7, s[36:39], s54 offen lds
    s_waitcnt vmcnt(12)
    s_barrier
    s_add_u32 m0, s52, 81920
    s_mov_b32 s54, 1720320
    buffer_load_dwordx4 v7, s[36:39], s54 offen lds
    s_add_u32 m0, s52, 82944
    s_mov_b32 s54, 1734656
    buffer_load_dwordx4 v7, s[36:39], s54 offen lds
    s_waitcnt vmcnt(10)
    s_barrier
    s_waitcnt vmcnt(6)
    s_barrier
    s_waitcnt vmcnt(2)
    s_barrier
    s_waitcnt vmcnt(0)
    s_barrier
    s_add_u32 m0, s52, 90112
    s_mov_b32 s54, 0
    buffer_load_dwordx4 v5, s[40:43], s54 offen lds
    s_add_u32 m0, s52, 91136
    s_mov_b32 s54, 8192
    buffer_load_dwordx4 v5, s[40:43], s54 offen lds
    s_add_u32 m0, s52, 98304
    s_mov_b32 s54, 65536
    buffer_load_dwordx4 v5, s[40:43], s54 offen lds
    s_add_u32 m0, s52, 99328
    s_mov_b32 s54, 73728
    buffer_load_dwordx4 v5, s[40:43], s54 offen lds
    s_add_u32 m0, s52, 0
    s_mov_b32 s54, 131072
    buffer_load_dwordx4 v5, s[40:43], s54 offen lds
    s_add_u32 m0, s52, 1024
    s_mov_b32 s54, 139264
    buffer_load_dwordx4 v5, s[40:43], s54 offen lds
    s_add_u32 m0, s52, 8192
    s_mov_b32 s54, 196608
    buffer_load_dwordx4 v5, s[40:43], s54 offen lds
    s_add_u32 m0, s52, 9216
    s_mov_b32 s54, 204800
    buffer_load_dwordx4 v5, s[40:43], s54 offen lds
    s_add_u32 m0, s52, 16384
    s_mov_b32 s54, 262144
    buffer_load_dwordx4 v5, s[40:43], s54 offen lds
    s_add_u32 m0, s52, 17408
    s_mov_b32 s54, 270336
    buffer_load_dwordx4 v5, s[40:43], s54 offen lds
    s_add_u32 m0, s52, 24576
    s_mov_b32 s54, 327680
    buffer_load_dwordx4 v5, s[40:43], s54 offen lds
    s_add_u32 m0, s52, 25600
    s_mov_b32 s54, 335872
    buffer_load_dwordx4 v5, s[40:43], s54 offen lds
    s_add_u32 m0, s52, 32768
    s_mov_b32 s54, 393216
    buffer_load_dwordx4 v5, s[40:43], s54 offen lds
    s_add_u32 m0, s52, 33792
    s_mov_b32 s54, 401408
    buffer_load_dwordx4 v5, s[40:43], s54 offen lds
    s_add_u32 m0, s52, 40960
    s_mov_b32 s54, 458752
    buffer_load_dwordx4 v5, s[40:43], s54 offen lds
    s_add_u32 m0, s52, 41984
    s_mov_b32 s54, 466944
    buffer_load_dwordx4 v5, s[40:43], s54 offen lds
    s_add_u32 m0, s52, 49152
    s_mov_b32 s54, 524288
    buffer_load_dwordx4 v5, s[40:43], s54 offen lds
    s_add_u32 m0, s52, 50176
    s_mov_b32 s54, 532480
    buffer_load_dwordx4 v5, s[40:43], s54 offen lds
    s_add_u32 m0, s52, 57344
    s_mov_b32 s54, 589824
    buffer_load_dwordx4 v5, s[40:43], s54 offen lds
    s_add_u32 m0, s52, 58368
    s_mov_b32 s54, 598016
    buffer_load_dwordx4 v5, s[40:43], s54 offen lds
    s_add_u32 m0, s52, 65536
    s_mov_b32 s54, 655360
    buffer_load_dwordx4 v5, s[40:43], s54 offen lds
    s_add_u32 m0, s52, 66560
    s_mov_b32 s54, 663552
    buffer_load_dwordx4 v5, s[40:43], s54 offen lds
    s_add_u32 m0, s52, 73728
    s_mov_b32 s54, 720896
    buffer_load_dwordx4 v5, s[40:43], s54 offen lds
    s_add_u32 m0, s52, 74752
    s_mov_b32 s54, 729088
    buffer_load_dwordx4 v5, s[40:43], s54 offen lds
    s_lshl_b32 s57, s49, 1
    s_add_u32 s57, s57, s45
    s_mul_i32 s57, s57, 112
    s_lshl_b32 s55, s46, 1
    s_add_u32 s57, s57, s55
    s_lshl_b32 s57, s57, 10
    s_add_u32 s57, s57, 12582912
    s_lshl_b32 s51, s45, 12
    s_lshl_b32 s55, s46, 11
    s_add_u32 s51, s51, s55
    s_barrier
    s_add_u32 m0, s51, 106496
    s_add_u32 s53, s57, 0
    buffer_load_dwordx4 v4, s[28:31], s53 offen sc1 lds
    buffer_load_dwordx4 v4, s[28:31], s53 offen offset:1024 sc1 lds
    s_add_u32 m0, s51, 114688
    s_add_u32 s53, s57, 4096
    buffer_load_dwordx4 v4, s[28:31], s53 offen sc1 lds
    buffer_load_dwordx4 v4, s[28:31], s53 offen offset:1024 sc1 lds
    s_add_u32 m0, s51, 122880
    s_add_u32 s53, s57, 8192
    buffer_load_dwordx4 v4, s[28:31], s53 offen sc1 lds
    buffer_load_dwordx4 v4, s[28:31], s53 offen offset:1024 sc1 lds
    s_add_u32 m0, s51, 131072
    s_add_u32 s53, s57, 12288
    buffer_load_dwordx4 v4, s[28:31], s53 offen sc1 lds
    buffer_load_dwordx4 v4, s[28:31], s53 offen offset:1024 sc1 lds
    s_waitcnt vmcnt(6)
    s_barrier
    s_add_u32 m0, s51, 139264
    s_add_u32 s53, s57, 16384
    buffer_load_dwordx4 v4, s[28:31], s53 offen sc1 lds
    buffer_load_dwordx4 v4, s[28:31], s53 offen offset:1024 sc1 lds
    s_add_u32 m0, s51, 147456
    s_add_u32 s53, s57, 20480
    buffer_load_dwordx4 v4, s[28:31], s53 offen sc1 lds
    buffer_load_dwordx4 v4, s[28:31], s53 offen offset:1024 sc1 lds
    s_add_u32 m0, s52, 81920
    s_mov_b32 s54, 786432
    buffer_load_dwordx4 v5, s[40:43], s54 offen lds
    s_add_u32 m0, s52, 82944
    s_mov_b32 s54, 794624
    buffer_load_dwordx4 v5, s[40:43], s54 offen lds
    s_waitcnt vmcnt(10)
    s_barrier
    s_add_u32 m0, s51, 106496
    s_add_u32 s53, s57, 24576
    buffer_load_dwordx4 v4, s[28:31], s53 offen sc1 lds
    buffer_load_dwordx4 v4, s[28:31], s53 offen offset:1024 sc1 lds
    s_add_u32 m0, s52, 90112
    s_mov_b32 s54, 851968
    buffer_load_dwordx4 v5, s[40:43], s54 offen lds
    s_add_u32 m0, s52, 91136
    s_mov_b32 s54, 860160
    buffer_load_dwordx4 v5, s[40:43], s54 offen lds
    s_waitcnt vmcnt(12)
    s_barrier
    s_add_u32 m0, s51, 114688
    s_add_u32 s53, s57, 28672
    buffer_load_dwordx4 v4, s[28:31], s53 offen sc1 lds
    buffer_load_dwordx4 v4, s[28:31], s53 offen offset:1024 sc1 lds
    s_add_u32 m0, s52, 98304
    s_mov_b32 s54, 917504
    buffer_load_dwordx4 v5, s[40:43], s54 offen lds
    s_add_u32 m0, s52, 99328
    s_mov_b32 s54, 925696
    buffer_load_dwordx4 v5, s[40:43], s54 offen lds
    s_waitcnt vmcnt(14)
    s_barrier
    s_add_u32 m0, s51, 122880
    s_add_u32 s53, s57, 32768
    buffer_load_dwordx4 v4, s[28:31], s53 offen sc1 lds
    buffer_load_dwordx4 v4, s[28:31], s53 offen offset:1024 sc1 lds
    s_add_u32 m0, s52, 0
    s_mov_b32 s54, 983040
    buffer_load_dwordx4 v5, s[40:43], s54 offen lds
    s_add_u32 m0, s52, 1024
    s_mov_b32 s54, 991232
    buffer_load_dwordx4 v5, s[40:43], s54 offen lds
    s_waitcnt vmcnt(16)
    s_barrier
    s_add_u32 m0, s51, 131072
    s_add_u32 s53, s57, 36864
    buffer_load_dwordx4 v4, s[28:31], s53 offen sc1 lds
    buffer_load_dwordx4 v4, s[28:31], s53 offen offset:1024 sc1 lds
    s_add_u32 m0, s52, 8192
    s_mov_b32 s54, 1048576
    buffer_load_dwordx4 v5, s[40:43], s54 offen lds
    s_add_u32 m0, s52, 9216
    s_mov_b32 s54, 1056768
    buffer_load_dwordx4 v5, s[40:43], s54 offen lds
    s_waitcnt vmcnt(18)
    s_barrier
    s_add_u32 m0, s51, 139264
    s_add_u32 s53, s57, 40960
    buffer_load_dwordx4 v4, s[28:31], s53 offen sc1 lds
    buffer_load_dwordx4 v4, s[28:31], s53 offen offset:1024 sc1 lds
    s_add_u32 m0, s52, 16384
    s_mov_b32 s54, 1114112
    buffer_load_dwordx4 v5, s[40:43], s54 offen lds
    s_add_u32 m0, s52, 17408
    s_mov_b32 s54, 1122304
    buffer_load_dwordx4 v5, s[40:43], s54 offen lds
    s_waitcnt vmcnt(18)
    s_barrier
    s_add_u32 m0, s51, 147456
    s_add_u32 s53, s57, 45056
    buffer_load_dwordx4 v4, s[28:31], s53 offen sc1 lds
    buffer_load_dwordx4 v4, s[28:31], s53 offen offset:1024 sc1 lds
    s_add_u32 m0, s52, 24576
    s_mov_b32 s54, 1179648
    buffer_load_dwordx4 v5, s[40:43], s54 offen lds
    s_add_u32 m0, s52, 25600
    s_mov_b32 s54, 1187840
    buffer_load_dwordx4 v5, s[40:43], s54 offen lds
    s_waitcnt vmcnt(18)
    s_barrier
    s_add_u32 m0, s51, 106496
    s_add_u32 s53, s57, 49152
    buffer_load_dwordx4 v4, s[28:31], s53 offen sc1 lds
    buffer_load_dwordx4 v4, s[28:31], s53 offen offset:1024 sc1 lds
    s_add_u32 m0, s52, 32768
    s_mov_b32 s54, 1245184
    buffer_load_dwordx4 v5, s[40:43], s54 offen lds
    s_add_u32 m0, s52, 33792
    s_mov_b32 s54, 1253376
    buffer_load_dwordx4 v5, s[40:43], s54 offen lds
    s_waitcnt vmcnt(18)
    s_barrier
    s_add_u32 m0, s51, 114688
    s_add_u32 s53, s57, 53248
    buffer_load_dwordx4 v4, s[28:31], s53 offen sc1 lds
    buffer_load_dwordx4 v4, s[28:31], s53 offen offset:1024 sc1 lds
    s_add_u32 m0, s52, 40960
    s_mov_b32 s54, 1310720
    buffer_load_dwordx4 v5, s[40:43], s54 offen lds
    s_add_u32 m0, s52, 41984
    s_mov_b32 s54, 1318912
    buffer_load_dwordx4 v5, s[40:43], s54 offen lds
    s_waitcnt vmcnt(18)
    s_barrier
    s_add_u32 m0, s51, 122880
    s_add_u32 s53, s57, 57344
    buffer_load_dwordx4 v4, s[28:31], s53 offen sc1 lds
    buffer_load_dwordx4 v4, s[28:31], s53 offen offset:1024 sc1 lds
    s_add_u32 m0, s52, 49152
    s_mov_b32 s54, 1376256
    buffer_load_dwordx4 v5, s[40:43], s54 offen lds
    s_add_u32 m0, s52, 50176
    s_mov_b32 s54, 1384448
    buffer_load_dwordx4 v5, s[40:43], s54 offen lds
    s_waitcnt vmcnt(18)
    s_barrier
    s_add_u32 m0, s51, 131072
    s_add_u32 s53, s57, 61440
    buffer_load_dwordx4 v4, s[28:31], s53 offen sc1 lds
    buffer_load_dwordx4 v4, s[28:31], s53 offen offset:1024 sc1 lds
    s_add_u32 m0, s52, 57344
    s_mov_b32 s54, 1441792
    buffer_load_dwordx4 v5, s[40:43], s54 offen lds
    s_add_u32 m0, s52, 58368
    s_mov_b32 s54, 1449984
    buffer_load_dwordx4 v5, s[40:43], s54 offen lds
    s_waitcnt vmcnt(18)
    s_barrier
    s_add_u32 m0, s51, 139264
    s_add_u32 s53, s57, 65536
    buffer_load_dwordx4 v4, s[28:31], s53 offen sc1 lds
    buffer_load_dwordx4 v4, s[28:31], s53 offen offset:1024 sc1 lds
    s_add_u32 m0, s52, 65536
    s_mov_b32 s54, 1507328
    buffer_load_dwordx4 v5, s[40:43], s54 offen lds
    s_add_u32 m0, s52, 66560
    s_mov_b32 s54, 1515520
    buffer_load_dwordx4 v5, s[40:43], s54 offen lds
    s_waitcnt vmcnt(18)
    s_barrier
    s_add_u32 m0, s51, 147456
    s_add_u32 s53, s57, 69632
    buffer_load_dwordx4 v4, s[28:31], s53 offen sc1 lds
    buffer_load_dwordx4 v4, s[28:31], s53 offen offset:1024 sc1 lds
    s_add_u32 m0, s52, 73728
    s_mov_b32 s54, 1572864
    buffer_load_dwordx4 v5, s[40:43], s54 offen lds
    s_add_u32 m0, s52, 74752
    s_mov_b32 s54, 1581056
    buffer_load_dwordx4 v5, s[40:43], s54 offen lds
    s_waitcnt vmcnt(18)
    s_barrier
    s_add_u32 m0, s51, 106496
    s_add_u32 s53, s57, 73728
    buffer_load_dwordx4 v4, s[28:31], s53 offen sc1 lds
    buffer_load_dwordx4 v4, s[28:31], s53 offen offset:1024 sc1 lds
    s_add_u32 m0, s52, 81920
    s_mov_b32 s54, 1638400
    buffer_load_dwordx4 v5, s[40:43], s54 offen lds
    s_add_u32 m0, s52, 82944
    s_mov_b32 s54, 1646592
    buffer_load_dwordx4 v5, s[40:43], s54 offen lds
    s_waitcnt vmcnt(18)
    s_barrier
    s_add_u32 m0, s51, 114688
    s_add_u32 s53, s57, 77824
    buffer_load_dwordx4 v4, s[28:31], s53 offen sc1 lds
    buffer_load_dwordx4 v4, s[28:31], s53 offen offset:1024 sc1 lds
    s_add_u32 m0, s52, 90112
    s_mov_b32 s54, 1703936
    buffer_load_dwordx4 v5, s[40:43], s54 offen lds
    s_add_u32 m0, s52, 91136
    s_mov_b32 s54, 1712128
    buffer_load_dwordx4 v5, s[40:43], s54 offen lds
    s_waitcnt vmcnt(18)
    s_barrier
    s_add_u32 m0, s51, 122880
    s_add_u32 s53, s57, 81920
    buffer_load_dwordx4 v4, s[28:31], s53 offen sc1 lds
    buffer_load_dwordx4 v4, s[28:31], s53 offen offset:1024 sc1 lds
    s_add_u32 m0, s52, 98304
    s_mov_b32 s54, 1769472
    buffer_load_dwordx4 v5, s[40:43], s54 offen lds
    s_add_u32 m0, s52, 99328
    s_mov_b32 s54, 1777664
    buffer_load_dwordx4 v5, s[40:43], s54 offen lds
    s_waitcnt vmcnt(18)
    s_barrier
    s_add_u32 m0, s51, 131072
    s_add_u32 s53, s57, 86016
    buffer_load_dwordx4 v4, s[28:31], s53 offen sc1 lds
    buffer_load_dwordx4 v4, s[28:31], s53 offen offset:1024 sc1 lds
    s_waitcnt vmcnt(16)
    s_barrier
    s_add_u32 m0, s51, 139264
    s_add_u32 s53, s57, 90112
    buffer_load_dwordx4 v4, s[28:31], s53 offen sc1 lds
    buffer_load_dwordx4 v4, s[28:31], s53 offen offset:1024 sc1 lds
    s_waitcnt vmcnt(14)
    s_barrier
    s_add_u32 m0, s51, 147456
    s_add_u32 s53, s57, 94208
    buffer_load_dwordx4 v4, s[28:31], s53 offen sc1 lds
    buffer_load_dwordx4 v4, s[28:31], s53 offen offset:1024 sc1 lds
    s_waitcnt vmcnt(12)
    s_barrier
    s_add_u32 m0, s51, 106496
    s_add_u32 s53, s57, 98304
    buffer_load_dwordx4 v4, s[28:31], s53 offen sc1 lds
    buffer_load_dwordx4 v4, s[28:31], s53 offen offset:1024 sc1 lds
    s_waitcnt vmcnt(10)
    s_barrier
    s_add_u32 m0, s51, 114688
    s_add_u32 s53, s57, 102400
    buffer_load_dwordx4 v4, s[28:31], s53 offen sc1 lds
    buffer_load_dwordx4 v4, s[28:31], s53 offen offset:1024 sc1 lds
    s_waitcnt vmcnt(8)
    s_barrier
    s_add_u32 m0, s51, 122880
    s_add_u32 s53, s57, 106496
    buffer_load_dwordx4 v4, s[28:31], s53 offen sc1 lds
    buffer_load_dwordx4 v4, s[28:31], s53 offen offset:1024 sc1 lds
    s_waitcnt vmcnt(8)
    s_barrier
    s_add_u32 m0, s51, 131072
    s_add_u32 s53, s57, 110592
    buffer_load_dwordx4 v4, s[28:31], s53 offen sc1 lds
    buffer_load_dwordx4 v4, s[28:31], s53 offen offset:1024 sc1 lds
    s_waitcnt vmcnt(8)
    s_barrier
    s_waitcnt vmcnt(6)
    s_barrier
    s_waitcnt vmcnt(4)
    s_barrier
    s_waitcnt vmcnt(2)
    s_barrier
    s_waitcnt vmcnt(0)
    s_barrier
    s_endpgm
L_t_lb:
    s_lshl_b32 s57, s49, 1
    s_add_u32 s57, s57, s45
    s_mul_i32 s57, s57, 32
    s_lshl_b32 s55, s46, 1
    s_add_u32 s57, s57, s55
    s_lshl_b32 s57, s57, 10
    s_add_u32 s57, s57, 8388608
    s_lshl_b32 s51, s45, 12
    s_lshl_b32 s55, s46, 11
    s_add_u32 s51, s51, s55
    s_waitcnt vmcnt(0)
    v_mov_b32 v8, 163776
    v_mov_b32 v9, 1
    s_mov_b64 exec, 1
    ds_add_rtn_u32 v9, v8, v9
    s_waitcnt lgkmcnt(0)
    v_readfirstlane_b32 s56, v9
    s_mov_b64 exec, -1
    s_cmp_lg_u32 s56, 7
    s_cbranch_scc1 L_h2lb_np
    s_lshr_b32 s55, s2, 5
    s_lshl_b32 s55, s55, 13
    s_add_u32 s55, s55, 6422528
    s_lshl_b32 s56, s76, 5
    s_add_u32 s55, s55, s56
    v_mov_b32 v8, 0
    v_mov_b32 v9, s11
    s_mov_b64 exec, 1
    buffer_store_dword v9, v8, s[28:31], s55 offen sc1
    s_mov_b64 exec, -1
L_h2lb_np:
    s_add_u32 m0, s52, 0
    s_mov_b32 s54, 0
    buffer_load_dwordx4 v5, s[32:35], s54 offen lds
    s_add_u32 m0, s52, 1024
    s_mov_b32 s54, 8192
    buffer_load_dwordx4 v5, s[32:35], s54 offen lds
    s_add_u32 m0, s52, 8192
    s_mov_b32 s54, 65536
    buffer_load_dwordx4 v5, s[32:35], s54 offen lds
    s_add_u32 m0, s52, 9216
    s_mov_b32 s54, 73728
    buffer_load_dwordx4 v5, s[32:35], s54 offen lds
    s_add_u32 m0, s52, 16384
    s_mov_b32 s54, 131072
    buffer_load_dwordx4 v5, s[32:35], s54 offen lds
    s_add_u32 m0, s52, 17408
    s_mov_b32 s54, 139264
    buffer_load_dwordx4 v5, s[32:35], s54 offen lds
    s_add_u32 m0, s52, 24576
    s_mov_b32 s54, 196608
    buffer_load_dwordx4 v5, s[32:35], s54 offen lds
    s_add_u32 m0, s52, 25600
    s_mov_b32 s54, 204800
    buffer_load_dwordx4 v5, s[32:35], s54 offen lds
    s_add_u32 m0, s52, 32768
    s_mov_b32 s54, 262144
    buffer_load_dwordx4 v5, s[32:35], s54 offen lds
    s_add_u32 m0, s52, 33792
    s_mov_b32 s54, 270336
    buffer_load_dwordx4 v5, s[32:35], s54 offen lds
    s_add_u32 m0, s52, 40960
    s_mov_b32 s54, 327680
    buffer_load_dwordx4 v5, s[32:35], s54 offen lds
    s_add_u32 m0, s52, 41984
    s_mov_b32 s54, 335872
    buffer_load_dwordx4 v5, s[32:35], s54 offen lds
    s_add_u32 m0, s52, 49152
    s_mov_b32 s54, 393216
    buffer_load_dwordx4 v5, s[32:35], s54 offen lds
    s_add_u32 m0, s52, 50176
    s_mov_b32 s54, 401408
    buffer_load_dwordx4 v5, s[32:35], s54 offen lds
    s_add_u32 m0, s52, 57344
    s_mov_b32 s54, 458752
    buffer_load_dwordx4 v5, s[32:35], s54 offen lds
    s_add_u32 m0, s52, 58368
    s_mov_b32 s54, 466944
    buffer_load_dwordx4 v5, s[32:35], s54 offen lds
    s_barrier
    s_add_u32 m0, s51, 106496
    s_add_u32 s53, s57, 0
    buffer_load_dwordx4 v4, s[28:31], s53 offen sc1 lds
    buffer_load_dwordx4 v4, s[28:31], s53 offen offset:1024 sc1 lds
    s_add_u32 m0, s51, 114688
    s_add_u32 s53, s57, 4096
    buffer_load_dwordx4 v4, s[28:31], s53 offen sc1 lds
    buffer_load_dwordx4 v4, s[28:31], s53 offen offset:1024 sc1 lds
    s_add_u32 m0, s51, 122880
    s_add_u32 s53, s57, 8192
    buffer_load_dwordx4 v4, s[28:31], s53 offen sc1 lds
    buffer_load_dwordx4 v4, s[28:31], s53 offen offset:1024 sc1 lds
    s_add_u32 m0, s51, 131072
    s_add_u32 s53, s57, 12288
    buffer_load_dwordx4 v4, s[28:31], s53 offen sc1 lds
    buffer_load_dwordx4 v4, s[28:31], s53 offen offset:1024 sc1 lds
    s_waitcnt vmcnt(6)
    s_barrier
    s_add_u32 m0, s51, 139264
    s_add_u32 s53, s57, 16384
    buffer_load_dwordx4 v4, s[28:31], s53 offen sc1 lds
    buffer_load_dwordx4 v4, s[28:31], s53 offen offset:1024 sc1 lds
    s_add_u32 m0, s51, 147456
    s_add_u32 s53, s57, 20480
    buffer_load_dwordx4 v4, s[28:31], s53 offen sc1 lds
    buffer_load_dwordx4 v4, s[28:31], s53 offen offset:1024 sc1 lds
    s_waitcnt vmcnt(8)
    s_barrier
    s_add_u32 m0, s51, 106496
    s_add_u32 s53, s57, 24576
    buffer_load_dwordx4 v4, s[28:31], s53 offen sc1 lds
    buffer_load_dwordx4 v4, s[28:31], s53 offen offset:1024 sc1 lds
    s_waitcnt vmcnt(8)
    s_barrier
    s_add_u32 m0, s51, 114688
    s_add_u32 s53, s57, 28672
    buffer_load_dwordx4 v4, s[28:31], s53 offen sc1 lds
    buffer_load_dwordx4 v4, s[28:31], s53 offen offset:1024 sc1 lds
    s_waitcnt vmcnt(8)
    s_barrier
    s_waitcnt vmcnt(6)
    s_barrier
    s_waitcnt vmcnt(4)
    s_barrier
    s_waitcnt vmcnt(2)
    s_barrier
    s_waitcnt vmcnt(0)
    s_barrier
    s_add_u32 m0, s52, 65536
    s_mov_b32 s54, 0
    buffer_load_dwordx4 v5, s[40:43], s54 offen lds
    s_add_u32 m0, s52, 66560
    s_mov_b32 s54, 8192
    buffer_load_dwordx4 v5, s[40:43], s54 offen lds
    s_add_u32 m0, s52, 73728
    s_mov_b32 s54, 65536
    buffer_load_dwordx4 v5, s[40:43], s54 offen lds
    s_add_u32 m0, s52, 74752
    s_mov_b32 s54, 73728
    buffer_load_dwordx4 v5, s[40:43], s54 offen lds
    s_add_u32 m0, s52, 81920
    s_mov_b32 s54, 131072
    buffer_load_dwordx4 v5, s[40:43], s54 offen lds
    s_add_u32 m0, s52, 82944
    s_mov_b32 s54, 139264
    buffer_load_dwordx4 v5, s[40:43], s54 offen lds
    s_add_u32 m0, s52, 90112
    s_mov_b32 s54, 196608
    buffer_load_dwordx4 v5, s[40:43], s54 offen lds
    s_add_u32 m0, s52, 91136
    s_mov_b32 s54, 204800
    buffer_load_dwordx4 v5, s[40:43], s54 offen lds
    s_lshl_b32 s57, s49, 1
    s_add_u32 s57, s57, s45
    s_mul_i32 s57, s57, 112
    s_lshl_b32 s55, s46, 1
    s_add_u32 s57, s57, s55
    s_lshl_b32 s57, s57, 10
    s_add_u32 s57, s57, 12582912
    s_lshl_b32 s51, s45, 12
    s_lshl_b32 s55, s46, 11
    s_add_u32 s51, s51, s55
    s_barrier
    s_add_u32 m0, s51, 106496
    s_add_u32 s53, s57, 0
    buffer_load_dwordx4 v4, s[28:31], s53 offen sc1 lds
    buffer_load_dwordx4 v4, s[28:31], s53 offen offset:1024 sc1 lds
    s_add_u32 m0, s51, 114688
    s_add_u32 s53, s57, 4096
    buffer_load_dwordx4 v4, s[28:31], s53 offen sc1 lds
    buffer_load_dwordx4 v4, s[28:31], s53 offen offset:1024 sc1 lds
    s_add_u32 m0, s51, 122880
    s_add_u32 s53, s57, 8192
    buffer_load_dwordx4 v4, s[28:31], s53 offen sc1 lds
    buffer_load_dwordx4 v4, s[28:31], s53 offen offset:1024 sc1 lds
    s_add_u32 m0, s51, 131072
    s_add_u32 s53, s57, 12288
    buffer_load_dwordx4 v4, s[28:31], s53 offen sc1 lds
    buffer_load_dwordx4 v4, s[28:31], s53 offen offset:1024 sc1 lds
    s_waitcnt vmcnt(6)
    s_barrier
    s_add_u32 m0, s51, 139264
    s_add_u32 s53, s57, 16384
    buffer_load_dwordx4 v4, s[28:31], s53 offen sc1 lds
    buffer_load_dwordx4 v4, s[28:31], s53 offen offset:1024 sc1 lds
    s_add_u32 m0, s51, 147456
    s_add_u32 s53, s57, 20480
    buffer_load_dwordx4 v4, s[28:31], s53 offen sc1 lds
    buffer_load_dwordx4 v4, s[28:31], s53 offen offset:1024 sc1 lds
    s_add_u32 m0, s52, 98304
    s_mov_b32 s54, 262144
    buffer_load_dwordx4 v5, s[40:43], s54 offen lds
    s_add_u32 m0, s52, 99328
    s_mov_b32 s54, 270336
    buffer_load_dwordx4 v5, s[40:43], s54 offen lds
    s_waitcnt vmcnt(10)
    s_barrier
    s_add_u32 m0, s51, 106496
    s_add_u32 s53, s57, 24576
    buffer_load_dwordx4 v4, s[28:31], s53 offen sc1 lds
    buffer_load_dwordx4 v4, s[28:31], s53 offen offset:1024 sc1 lds
    s_add_u32 m0, s52, 0
    s_mov_b32 s54, 327680
    buffer_load_dwordx4 v5, s[40:43], s54 offen lds
    s_add_u32 m0, s52, 1024
    s_mov_b32 s54, 335872
    buffer_load_dwordx4 v5, s[40:43], s54 offen lds
    s_waitcnt vmcnt(12)
    s_barrier
    s_add_u32 m0, s51, 114688
    s_add_u32 s53, s57, 28672
    buffer_load_dwordx4 v4, s[28:31], s53 offen sc1 lds
    buffer_load_dwordx4 v4, s[28:31], s53 offen offset:1024 sc1 lds
    s_add_u32 m0, s52, 8192
    s_mov_b32 s54, 393216
    buffer_load_dwordx4 v5, s[40:43], s54 offen lds
    s_add_u32 m0, s52, 9216
    s_mov_b32 s54, 401408
    buffer_load_dwordx4 v5, s[40:43], s54 offen lds
    s_waitcnt vmcnt(14)
    s_barrier
    s_add_u32 m0, s51, 122880
    s_add_u32 s53, s57, 32768
    buffer_load_dwordx4 v4, s[28:31], s53 offen sc1 lds
    buffer_load_dwordx4 v4, s[28:31], s53 offen offset:1024 sc1 lds
    s_add_u32 m0, s52, 16384
    s_mov_b32 s54, 458752
    buffer_load_dwordx4 v5, s[40:43], s54 offen lds
    s_add_u32 m0, s52, 17408
    s_mov_b32 s54, 466944
    buffer_load_dwordx4 v5, s[40:43], s54 offen lds
    s_waitcnt vmcnt(12)
    s_barrier
    s_add_u32 m0, s51, 131072
    s_add_u32 s53, s57, 36864
    buffer_load_dwordx4 v4, s[28:31], s53 offen sc1 lds
    buffer_load_dwordx4 v4, s[28:31], s53 offen offset:1024 sc1 lds
    s_add_u32 m0, s52, 24576
    s_mov_b32 s54, 524288
    buffer_load_dwordx4 v5, s[40:43], s54 offen lds
    s_add_u32 m0, s52, 25600
    s_mov_b32 s54, 532480
    buffer_load_dwordx4 v5, s[40:43], s54 offen lds
    s_waitcnt vmcnt(12)
    s_barrier
    s_add_u32 m0, s51, 139264
    s_add_u32 s53, s57, 40960
    buffer_load_dwordx4 v4, s[28:31], s53 offen sc1 lds
    buffer_load_dwordx4 v4, s[28:31], s53 offen offset:1024 sc1 lds
    s_add_u32 m0, s52, 32768
    s_mov_b32 s54, 589824
    buffer_load_dwordx4 v5, s[40:43], s54 offen lds
    s_add_u32 m0, s52, 33792
    s_mov_b32 s54, 598016
    buffer_load_dwordx4 v5, s[40:43], s54 offen lds
    s_waitcnt vmcnt(12)
    s_barrier
    s_add_u32 m0, s51, 147456
    s_add_u32 s53, s57, 45056
    buffer_load_dwordx4 v4, s[28:31], s53 offen sc1 lds
    buffer_load_dwordx4 v4, s[28:31], s53 offen offset:1024 sc1 lds
    s_add_u32 m0, s52, 40960
    s_mov_b32 s54, 655360
    buffer_load_dwordx4 v5, s[40:43], s54 offen lds
    s_add_u32 m0, s52, 41984
    s_mov_b32 s54, 663552
    buffer_load_dwordx4 v5, s[40:43], s54 offen lds
    s_waitcnt vmcnt(12)
    s_barrier
    s_add_u32 m0, s51, 106496
    s_add_u32 s53, s57, 49152
    buffer_load_dwordx4 v4, s[28:31], s53 offen sc1 lds
    buffer_load_dwordx4 v4, s[28:31], s53 offen offset:1024 sc1 lds
    s_add_u32 m0, s52, 49152
    s_mov_b32 s54, 720896
    buffer_load_dwordx4 v5, s[40:43], s54 offen lds
    s_add_u32 m0, s52, 50176
    s_mov_b32 s54, 729088
    buffer_load_dwordx4 v5, s[40:43], s54 offen lds
    s_waitcnt vmcnt(12)
    s_barrier
    s_add_u32 m0, s51, 114688
    s_add_u32 s53, s57, 53248
    buffer_load_dwordx4 v4, s[28:31], s53 offen sc1 lds
    buffer_load_dwordx4 v4, s[28:31], s53 offen offset:1024 sc1 lds
    s_add_u32 m0, s52, 57344
    s_mov_b32 s54, 786432
    buffer_load_dwordx4 v5, s[40:43], s54 offen lds
    s_add_u32 m0, s52, 58368
    s_mov_b32 s54, 794624
    buffer_load_dwordx4 v5, s[40:43], s54 offen lds
    s_waitcnt vmcnt(12)
    s_barrier
    s_add_u32 m0, s51, 122880
    s_add_u32 s53, s57, 57344
    buffer_load_dwordx4 v4, s[28:31], s53 offen sc1 lds
    buffer_load_dwordx4 v4, s[28:31], s53 offen offset:1024 sc1 lds
    s_add_u32 m0, s52, 65536
    s_mov_b32 s54, 851968
    buffer_load_dwordx4 v5, s[40:43], s54 offen lds
    s_add_u32 m0, s52, 66560
    s_mov_b32 s54, 860160
    buffer_load_dwordx4 v5, s[40:43], s54 offen lds
    s_waitcnt vmcnt(12)
    s_barrier
    s_add_u32 m0, s51, 131072
    s_add_u32 s53, s57, 61440
    buffer_load_dwordx4 v4, s[28:31], s53 offen sc1 lds
    buffer_load_dwordx4 v4, s[28:31], s53 offen offset:1024 sc1 lds
    s_add_u32 m0, s52, 73728
    s_mov_b32 s54, 917504
    buffer_load_dwordx4 v5, s[40:43], s54 offen lds
    s_add_u32 m0, s52, 74752
    s_mov_b32 s54, 925696
    buffer_load_dwordx4 v5, s[40:43], s54 offen lds
    s_waitcnt vmcnt(12)
    s_barrier
    s_add_u32 m0, s51, 139264
    s_add_u32 s53, s57, 65536
    buffer_load_dwordx4 v4, s[28:31], s53 offen sc1 lds
    buffer_load_dwordx4 v4, s[28:31], s53 offen offset:1024 sc1 lds
    s_add_u32 m0, s52, 81920
    s_mov_b32 s54, 983040
    buffer_load_dwordx4 v5, s[40:43], s54 offen lds
    s_add_u32 m0, s52, 82944
    s_mov_b32 s54, 991232
    buffer_load_dwordx4 v5, s[40:43], s54 offen lds
    s_waitcnt vmcnt(12)
    s_barrier
    s_add_u32 m0, s51, 147456
    s_add_u32 s53, s57, 69632
    buffer_load_dwordx4 v4, s[28:31], s53 offen sc1 lds
    buffer_load_dwordx4 v4, s[28:31], s53 offen offset:1024 sc1 lds
    s_add_u32 m0, s52, 90112
    s_mov_b32 s54, 1048576
    buffer_load_dwordx4 v5, s[40:43], s54 offen lds
    s_add_u32 m0, s52, 91136
    s_mov_b32 s54, 1056768
    buffer_load_dwordx4 v5, s[40:43], s54 offen lds
    s_waitcnt vmcnt(12)
    s_barrier
    s_add_u32 m0, s51, 106496
    s_add_u32 s53, s57, 73728
    buffer_load_dwordx4 v4, s[28:31], s53 offen sc1 lds
    buffer_load_dwordx4 v4, s[28:31], s53 offen offset:1024 sc1 lds
    s_add_u32 m0, s52, 98304
    s_mov_b32 s54, 1114112
    buffer_load_dwordx4 v5, s[40:43], s54 offen lds
    s_add_u32 m0, s52, 99328
    s_mov_b32 s54, 1122304
    buffer_load_dwordx4 v5, s[40:43], s54 offen lds
    s_waitcnt vmcnt(12)
    s_barrier
    s_add_u32 m0, s51, 114688
    s_add_u32 s53, s57, 77824
    buffer_load_dwordx4 v4, s[28:31], s53 offen sc1 lds
    buffer_load_dwordx4 v4, s[28:31], s53 offen offset:1024 sc1 lds
    s_add_u32 m0, s52, 0
    s_mov_b32 s54, 1179648
    buffer_load_dwordx4 v5, s[40:43], s54 offen lds
    s_add_u32 m0, s52, 1024
    s_mov_b32 s54, 1187840
    buffer_load_dwordx4 v5, s[40:43], s54 offen lds
    s_waitcnt vmcnt(12)
    s_barrier
    s_add_u32 m0, s51, 122880
    s_add_u32 s53, s57, 81920
    buffer_load_dwordx4 v4, s[28:31], s53 offen sc1 lds
    buffer_load_dwordx4 v4, s[28:31], s53 offen offset:1024 sc1 lds
    s_add_u32 m0, s52, 8192
    s_mov_b32 s54, 1245184
    buffer_load_dwordx4 v5, s[40:43], s54 offen lds
    s_add_u32 m0, s52, 9216
    s_mov_b32 s54, 1253376
    buffer_load_dwordx4 v5, s[40:43], s54 offen lds
    s_waitcnt vmcnt(12)
    s_barrier
    s_add_u32 m0, s51, 131072
    s_add_u32 s53, s57, 86016
    buffer_load_dwordx4 v4, s[28:31], s53 offen sc1 lds
    buffer_load_dwordx4 v4, s[28:31], s53 offen offset:1024 sc1 lds
    s_add_u32 m0, s52, 16384
    s_mov_b32 s54, 1310720
    buffer_load_dwordx4 v5, s[40:43], s54 offen lds
    s_add_u32 m0, s52, 17408
    s_mov_b32 s54, 1318912
    buffer_load_dwordx4 v5, s[40:43], s54 offen lds
    s_waitcnt vmcnt(12)
    s_barrier
    s_add_u32 m0, s51, 139264
    s_add_u32 s53, s57, 90112
    buffer_load_dwordx4 v4, s[28:31], s53 offen sc1 lds
    buffer_load_dwordx4 v4, s[28:31], s53 offen offset:1024 sc1 lds
    s_add_u32 m0, s52, 24576
    s_mov_b32 s54, 1376256
    buffer_load_dwordx4 v5, s[40:43], s54 offen lds
    s_add_u32 m0, s52, 25600
    s_mov_b32 s54, 1384448
    buffer_load_dwordx4 v5, s[40:43], s54 offen lds
    s_waitcnt vmcnt(12)
    s_barrier
    s_add_u32 m0, s51, 147456
    s_add_u32 s53, s57, 94208
    buffer_load_dwordx4 v4, s[28:31], s53 offen sc1 lds
    buffer_load_dwordx4 v4, s[28:31], s53 offen offset:1024 sc1 lds
    s_add_u32 m0, s52, 32768
    s_mov_b32 s54, 1441792
    buffer_load_dwordx4 v5, s[40:43], s54 offen lds
    s_add_u32 m0, s52, 33792
    s_mov_b32 s54, 1449984
    buffer_load_dwordx4 v5, s[40:43], s54 offen lds
    s_waitcnt vmcnt(12)
    s_barrier
    s_add_u32 m0, s51, 106496
    s_add_u32 s53, s57, 98304
    buffer_load_dwordx4 v4, s[28:31], s53 offen sc1 lds
    buffer_load_dwordx4 v4, s[28:31], s53 offen offset:1024 sc1 lds
    s_add_u32 m0, s52, 40960
    s_mov_b32 s54, 1507328
    buffer_load_dwordx4 v5, s[40:43], s54 offen lds
    s_add_u32 m0, s52, 41984
    s_mov_b32 s54, 1515520
    buffer_load_dwordx4 v5, s[40:43], s54 offen lds
    s_waitcnt vmcnt(12)
    s_barrier
    s_add_u32 m0, s51, 114688
    s_add_u32 s53, s57, 102400
    buffer_load_dwordx4 v4, s[28:31], s53 offen sc1 lds
    buffer_load_dwordx4 v4, s[28:31], s53 offen offset:1024 sc1 lds
    s_add_u32 m0, s52, 49152
    s_mov_b32 s54, 1572864
    buffer_load_dwordx4 v5, s[40:43], s54 offen lds
    s_add_u32 m0, s52, 50176
    s_mov_b32 s54, 1581056
    buffer_load_dwordx4 v5, s[40:43], s54 offen lds
    s_waitcnt vmcnt(12)
    s_barrier
    s_add_u32 m0, s51, 122880
    s_add_u32 s53, s57, 106496
    buffer_load_dwordx4 v4, s[28:31], s53 offen sc1 lds
    buffer_load_dwordx4 v4, s[28:31], s53 offen offset:1024 sc1 lds
    s_add_u32 m0, s52, 57344
    s_mov_b32 s54, 1638400
    buffer_load_dwordx4 v5, s[40:43], s54 offen lds
    s_add_u32 m0, s52, 58368
    s_mov_b32 s54, 1646592
    buffer_load_dwordx4 v5, s[40:43], s54 offen lds
    s_waitcnt vmcnt(12)
    s_barrier
    s_add_u32 m0, s51, 131072
    s_add_u32 s53, s57, 110592
    buffer_load_dwordx4 v4, s[28:31], s53 offen sc1 lds
    buffer_load_dwordx4 v4, s[28:31], s53 offen offset:1024 sc1 lds
    s_add_u32 m0, s52, 65536
    s_mov_b32 s54, 1703936
    buffer_load_dwordx4 v5, s[40:43], s54 offen lds
    s_add_u32 m0, s52, 66560
    s_mov_b32 s54, 1712128
    buffer_load_dwordx4 v5, s[40:43], s54 offen lds
    s_waitcnt vmcnt(12)
    s_barrier
    s_add_u32 m0, s52, 73728
    s_mov_b32 s54, 1769472
    buffer_load_dwordx4 v5, s[40:43], s54 offen lds
    s_add_u32 m0, s52, 74752
    s_mov_b32 s54, 1777664
    buffer_load_dwordx4 v5, s[40:43], s54 offen lds
    s_waitcnt vmcnt(10)
    s_barrier
    s_waitcnt vmcnt(6)
    s_barrier
    s_waitcnt vmcnt(2)
    s_barrier
    s_waitcnt vmcnt(0)
    s_barrier
    s_endpgm
L_t_end:
    s_endpgm
    s_endpgm
    s_endpgm
    s_endpgm
    s_endpgm
    s_endpgm
    s_endpgm
    s_endpgm
    s_endpgm
    s_endpgm
    s_endpgm
    s_endpgm
    s_endpgm
    s_endpgm
    s_endpgm
    s_endpgm
    s_endpgm
    s_endpgm
    s_endpgm
    s_endpgm
    s_endpgm
    s_endpgm
    s_endpgm
    s_endpgm
    s_endpgm
    s_endpgm
    s_endpgm
    s_endpgm
    s_endpgm
    s_endpgm
    s_endpgm
    s_endpgm
    s_endpgm
    s_endpgm
    s_endpgm
    s_endpgm
    s_endpgm
    s_endpgm
    s_endpgm
    s_endpgm
    s_endpgm
    s_endpgm
    s_endpgm
    s_endpgm
    s_endpgm
    s_endpgm
    s_endpgm
    s_endpgm
    s_endpgm
    s_endpgm
    s_endpgm
    s_endpgm
    s_endpgm
    s_endpgm
    s_endpgm
    s_endpgm
    s_endpgm
    s_endpgm
    s_endpgm
    s_endpgm
    s_endpgm
    s_endpgm
    s_endpgm
    s_endpgm
    s_endpgm
    s_endpgm
    s_endpgm
    s_endpgm
    s_endpgm
    s_endpgm
    s_endpgm
    s_endpgm
    s_endpgm
    s_endpgm
    s_endpgm
    s_endpgm
    s_endpgm
    s_endpgm
    s_endpgm
    s_endpgm
    s_endpgm
    s_endpgm
    s_endpgm
    s_endpgm
    s_endpgm
    s_endpgm
    s_endpgm
    s_endpgm
    s_endpgm
    s_endpgm
    s_endpgm
    s_endpgm
    s_endpgm
    s_endpgm
    s_endpgm
    s_endpgm
    s_endpgm
    s_endpgm
    s_endpgm
    s_endpgm
    s_endpgm
    s_endpgm
    s_endpgm
    s_endpgm
    s_endpgm
    s_endpgm
    s_endpgm
    s_endpgm
    s_endpgm
    s_endpgm
    s_endpgm
    s_endpgm
    s_endpgm
    s_endpgm
    s_endpgm
    s_endpgm
    s_endpgm
    s_endpgm
    s_endpgm
    s_endpgm
    s_endpgm
    s_endpgm
    s_endpgm
    s_endpgm
    s_endpgm
    s_endpgm
    s_endpgm
    s_endpgm
    s_endpgm
    s_endpgm
    s_endpgm
    s_endpgm
    s_endpgm
    s_endpgm
    s_endpgm
    s_endpgm
    s_endpgm
    s_endpgm
    s_endpgm
    s_endpgm
    s_endpgm
    s_endpgm
    s_endpgm
    s_endpgm
    s_endpgm
    s_endpgm
    s_endpgm
    s_endpgm
    s_endpgm
    s_endpgm
    s_endpgm
    s_endpgm
    s_endpgm
    s_endpgm
    s_endpgm
    s_endpgm
    s_endpgm
    s_endpgm
    s_endpgm
    s_endpgm
    s_endpgm
    s_endpgm
    s_endpgm
    s_endpgm
    s_endpgm
    s_endpgm
    s_endpgm
    s_endpgm
    s_endpgm
    s_endpgm
    s_endpgm
    s_endpgm
    s_endpgm
    s_endpgm
    s_endpgm
    s_endpgm
    s_endpgm
    s_endpgm
    s_endpgm
    s_endpgm
    s_endpgm
    s_endpgm
    s_endpgm
    s_endpgm
    s_endpgm
    s_endpgm
    s_endpgm
    s_endpgm
    s_endpgm
    s_endpgm
    s_endpgm
    s_endpgm
    s_endpgm
    s_endpgm
    s_endpgm
    s_endpgm
    s_endpgm
    s_endpgm
    s_endpgm
    s_endpgm
    s_endpgm
    s_endpgm
    s_endpgm
    s_endpgm
    s_endpgm
    s_endpgm
    s_endpgm
    s_endpgm
    s_endpgm
    s_endpgm
    s_endpgm
    s_endpgm
    s_endpgm
    s_endpgm
    s_endpgm
    s_endpgm
    s_endpgm
    s_endpgm
    s_endpgm
    s_endpgm
    s_endpgm
    s_endpgm
    s_endpgm
    s_endpgm
    s_endpgm
    s_endpgm
    s_endpgm
    s_endpgm
    s_endpgm
    s_endpgm
    s_endpgm
    s_endpgm
    s_endpgm
    s_endpgm
    s_endpgm
    s_endpgm
    s_endpgm
    s_endpgm
    s_endpgm
    s_endpgm
    s_endpgm
    s_endpgm
    s_endpgm
    s_endpgm
    s_endpgm
    s_endpgm
    s_endpgm
    s_endpgm
    s_endpgm
    s_endpgm
    s_endpgm
    s_endpgm
    s_endpgm
    s_endpgm
    s_endpgm
    s_endpgm
    s_endpgm
    s_endpgm
    s_endpgm
    s_endpgm
    s_endpgm
    s_endpgm
    s_endpgm
    s_endpgm
    s_endpgm
    s_endpgm
    s_endpgm
    s_endpgm
    s_endpgm
    s_endpgm
    s_endpgm
    s_endpgm
    s_endpgm
    s_endpgm
    s_endpgm
    s_endpgm
    s_endpgm
    s_endpgm
    s_endpgm
    s_endpgm
    s_endpgm
    s_endpgm
    s_endpgm
    s_endpgm
    s_endpgm
    s_endpgm
    s_endpgm
    s_endpgm
    s_endpgm
    s_endpgm
    s_endpgm
    s_endpgm
    s_endpgm
    s_endpgm
    s_endpgm
    s_endpgm
    s_endpgm
    s_endpgm
    s_endpgm
    s_endpgm
    s_endpgm
    s_endpgm
    s_endpgm
    s_endpgm
    s_endpgm
    s_endpgm
    s_endpgm
    s_endpgm
    s_endpgm
    s_endpgm
    s_endpgm
    s_endpgm
    s_endpgm
    s_endpgm
    s_endpgm
    s_endpgm
    s_endpgm
    s_endpgm
    s_endpgm
    s_endpgm
    s_endpgm
    s_endpgm
    s_endpgm
    s_endpgm
    s_endpgm
    s_endpgm
    s_endpgm
    s_endpgm
    s_endpgm
    s_endpgm
    s_endpgm
    s_endpgm
    s_endpgm
    s_endpgm
    s_endpgm
    s_endpgm
    s_endpgm
    s_endpgm
    s_endpgm
    s_endpgm
    s_endpgm
    s_endpgm
    s_endpgm
    s_endpgm
    s_endpgm
    s_endpgm
    s_endpgm
    s_endpgm
    s_endpgm
    s_endpgm
    s_endpgm
    s_endpgm
    s_endpgm
    s_endpgm
    s_endpgm
    s_endpgm
    s_endpgm
    s_endpgm
    s_endpgm
    s_endpgm
    s_endpgm
    s_endpgm
    s_endpgm
    s_endpgm
    s_endpgm
    s_endpgm
    s_endpgm
    s_endpgm
    s_endpgm
    s_endpgm
    s_endpgm
    s_endpgm
    s_endpgm
    s_endpgm
    s_endpgm
    s_endpgm
    s_endpgm
    s_endpgm
    s_endpgm
    s_endpgm
    s_endpgm
    s_endpgm
    s_endpgm
    s_endpgm
    s_endpgm
    s_endpgm
    s_endpgm
    s_endpgm
    s_endpgm
    s_endpgm
    s_endpgm
    s_endpgm
    s_endpgm
    s_endpgm
    s_endpgm
    s_endpgm
    s_endpgm
    s_endpgm
    s_endpgm
    s_endpgm
    s_endpgm
    s_endpgm
    s_endpgm
    s_endpgm
    s_endpgm
    s_endpgm
    s_endpgm
    s_endpgm
    s_endpgm
    s_endpgm
    s_endpgm
    s_endpgm
    s_endpgm
    s_endpgm
    s_endpgm
    s_endpgm
    s_endpgm
    s_endpgm
    s_endpgm
    s_endpgm
    s_endpgm
    s_endpgm
    s_endpgm
    s_endpgm
    s_endpgm
    s_endpgm
    s_endpgm
    s_endpgm
    s_endpgm
    s_endpgm
    s_endpgm
    s_endpgm
    s_endpgm
    s_endpgm
    s_endpgm
    s_endpgm
    s_endpgm
    s_endpgm
    s_endpgm
    s_endpgm
    s_endpgm
    s_endpgm
    s_endpgm
    s_endpgm
    s_endpgm
    s_endpgm
    s_endpgm
    s_endpgm
    s_endpgm
    s_endpgm
    s_endpgm
    s_endpgm
    s_endpgm
    s_endpgm
    s_endpgm
    s_endpgm
    s_endpgm
    s_endpgm
    s_endpgm
    s_endpgm
    s_endpgm
    s_endpgm
    s_endpgm
    s_endpgm
    s_endpgm
    s_endpgm
    s_endpgm
    s_endpgm
    s_endpgm
    s_endpgm
    s_endpgm
    s_endpgm
    s_endpgm
    s_endpgm
    s_endpgm
    s_endpgm
    s_endpgm
    s_endpgm
    s_endpgm
    s_endpgm
    s_endpgm
    s_endpgm
    s_endpgm
    s_endpgm
    s_endpgm
    s_endpgm
    s_endpgm
    s_endpgm
    s_endpgm
    s_endpgm
    s_endpgm
    s_endpgm
    s_endpgm
    s_endpgm
    s_endpgm
    s_endpgm
    s_endpgm
    s_endpgm
    s_endpgm
    s_endpgm
    s_endpgm
    s_endpgm
    s_endpgm
    s_endpgm
    s_endpgm
    s_endpgm
    s_endpgm
    s_endpgm
    s_endpgm
    s_endpgm
    s_endpgm
    s_endpgm
    s_endpgm
    s_endpgm
    s_endpgm
    s_endpgm
    s_endpgm
    s_endpgm
    s_endpgm
    s_endpgm
    s_endpgm
    s_endpgm
    s_endpgm
    s_endpgm
    s_endpgm
    s_endpgm
    s_endpgm
    s_endpgm
    s_endpgm
    s_endpgm
    s_endpgm
    s_endpgm
    s_endpgm
    s_endpgm
    s_endpgm
    s_endpgm
    s_endpgm
    s_endpgm
    s_endpgm
    s_endpgm
    s_endpgm
    s_endpgm
    s_endpgm
    s_endpgm
    s_endpgm
    s_endpgm
    s_endpgm
    s_endpgm
    s_endpgm
    s_endpgm
    s_endpgm
    s_endpgm
    s_endpgm
    s_endpgm
    s_endpgm
    s_endpgm
    s_endpgm
    s_endpgm
    s_endpgm
    s_endpgm
    s_endpgm
    s_endpgm
    s_endpgm
    s_endpgm
    s_endpgm
    s_endpgm
    s_endpgm
    s_endpgm
    s_endpgm
    s_endpgm
    s_endpgm
    s_endpgm
    s_endpgm
    s_endpgm
    s_endpgm
    s_endpgm
    s_endpgm
    s_endpgm
    s_endpgm
    s_endpgm
    s_endpgm
    s_endpgm
    s_endpgm
    s_endpgm
    s_endpgm
    s_endpgm
    s_endpgm
    s_endpgm
    s_endpgm
    s_endpgm
    s_endpgm
    s_endpgm
    s_endpgm
    s_endpgm
    s_endpgm
    s_endpgm
    s_endpgm
    s_endpgm
    s_endpgm
    s_endpgm
    s_endpgm
    s_endpgm
    s_endpgm
    s_endpgm
    s_endpgm
    s_endpgm
    s_endpgm
    s_endpgm
    s_endpgm
    s_endpgm
    s_endpgm
    s_endpgm
    s_endpgm
    s_endpgm
    s_endpgm
    s_endpgm
    s_endpgm
    s_endpgm
    s_endpgm
    s_endpgm
    s_endpgm
.section .rodata,"a"
.p2align 6
.amdhsa_kernel sequential_preLN__mha_block__dense_activation_gelu__prompt_kernel
  .amdhsa_next_free_vgpr 240
  .amdhsa_next_free_sgpr 102
  .amdhsa_accum_offset 240
  .amdhsa_group_segment_fixed_size 0
  .amdhsa_kernarg_size 88
  .amdhsa_user_sgpr_count 2
  .amdhsa_user_sgpr_kernarg_segment_ptr 1
  .amdhsa_system_sgpr_workgroup_id_x 1
.end_amdhsa_kernel
```
